```python
import torch

def _softmax(x, axis=-1):
    return torch.softmax(x, dim=axis)
def _gelu(x):
    return torch.nn.functional.gelu(x, approximate="tanh")
def _silu(x):
    return torch.nn.functional.silu(x)
def _sigmoid(x):
    return torch.sigmoid(x)
def _layernorm(x, axis=-1, eps=1e-5):
    m = x.mean(dim=axis, keepdim=True)
    v = x.var(dim=axis, keepdim=True, unbiased=False)
    return (x - m) / torch.sqrt(v + eps)
def _scatter_add(tgt, idx, src, axis=0):
    return tgt.clone().index_add_(axis, idx, src)
def _segment_sum(src, seg, n):
    out = torch.zeros((n,) + src.shape[1:], dtype=src.dtype)
    return out.index_add_(0, seg, src)
def _pad(x, pw):
    flat = tuple(v for pair in reversed(pw) for v in pair)
    return torch.nn.functional.pad(x, flat)

kernel_name = 'gated_mix__linear_kernel_hedgehog__sliding_local_dilated__prompt'

def setup_inputs():

    _w = (lambda a: (lambda t: t.to(torch.bfloat16) if t.is_floating_point() else t)(torch.as_tensor(a)))
    def _A_setup():
        B, S, D, H = 1, 2048, 640, 32
        Dh = D // H
        return {
            "x": _w((lambda *s: torch.randn(*s, dtype=torch.bfloat16) * 0.05)(B, S, D)),
            "wqkv": _w((lambda *s: torch.randn(*s, dtype=torch.bfloat16) * 1.6)(D, 3 * D)),
            "w_phi": _w((lambda *s: torch.randn(*s, dtype=torch.bfloat16) * 1.6)(H, Dh, Dh) * (Dh ** -0.5)),
            "wo": _w((lambda *s: torch.randn(*s, dtype=torch.bfloat16) * 0.1)(D, D)),
        }
    _A_in = _A_setup()

    def _B_setup():
        B, S, D = 1, 2048, 640
        return {
            "x": _w((lambda *s: torch.randn(*s, dtype=torch.bfloat16) * 0.05)(B, S, D)),
            "wqkv": _w((lambda *s: torch.randn(*s, dtype=torch.bfloat16) * 0.8)(D, 3 * D)),
            "wo": _w((lambda *s: torch.randn(*s, dtype=torch.bfloat16) * 0.05)(D, D)),
        }
    _B_in = _B_setup()

    return {
        "A_x": _A_in["x"],
        "A_wqkv": _A_in["wqkv"],
        "A_w_phi": _A_in["w_phi"],
        "A_wo": _A_in["wo"],
        "B_x": _B_in["x"],
        "B_wqkv": _B_in["wqkv"],
        "B_wo": _B_in["wo"],
        "gate_w": _w((lambda *s: torch.randn(*s, dtype=torch.bfloat16) * 0.05)(640) * 16.0),
    }

def reference(A_x, A_wqkv, A_w_phi, A_wo, B_x, B_wqkv, B_wo, gate_w):
    def _A_ref(x, wqkv, w_phi, wo):
        B, S, D = x.shape
        H = 32; Dh = D // H
        qkv = (lambda x, *d: x.permute(*d))((x @ wqkv).reshape(B, S, 3, H, Dh), 2, 0, 3, 1, 4)
        q, k, v = qkv[0], qkv[1], qkv[2]
        pq = torch.einsum("bhsd,hdf->bhsf", q, w_phi)
        pk = torch.einsum("bhsd,hdf->bhsf", k, w_phi)
        phi_q = torch.concatenate([_softmax(pq, axis=-1), _softmax(-pq, axis=-1)], axis=-1)
        phi_k = torch.concatenate([_softmax(pk, axis=-1), _softmax(-pk, axis=-1)], axis=-1)
        kv = torch.einsum("bhsf,bhsd->bhfd", phi_k, v)
        z  = torch.einsum("bhsf->bhf", phi_k)
        num = torch.einsum("bhqf,bhfd->bhqd", phi_q, kv)
        den = torch.einsum("bhqf,bhf->bhq", phi_q, z)[..., None] + 1e-6
        o = num / den
        return (lambda x, *d: x.permute(*d))(o, 0, 2, 1, 3).reshape(B, S, D) @ wo

    def _B_ref(x, wqkv, wo):
        B, S, D = x.shape
        H = 32; Dh = D // H
        W, dil = 8, 2
        qkv = (lambda x, *d: x.permute(*d))((x @ wqkv).reshape(B, S, 3, H, Dh), 2, 0, 3, 1, 4)
        q, k, v = qkv[0], qkv[1], qkv[2]
        scale = Dh ** -0.5
        pos = torch.arange(S)
        off = torch.arange(W) * dil
        idx = pos[:, None] - off[None, :]
        mask = idx >= 0
        idx_c = torch.where(mask, idx, 0).reshape(-1)
        kg = k[:, :, idx_c, :].reshape(B, H, S, W, Dh)
        vg = v[:, :, idx_c, :].reshape(B, H, S, W, Dh)
        logits = torch.einsum("bhsd,bhswd->bhsw", q, kg) * scale
        logits = torch.where(mask[None, None, :, :], logits, -1e9)
        attn = _softmax(logits, axis=-1)
        o = torch.einsum("bhsw,bhswd->bhsd", attn, vg)
        return (lambda x, *d: x.permute(*d))(o, 0, 2, 1, 3).reshape(B, S, D) @ wo

    x = A_x
    g = _sigmoid((x * gate_w).sum(-1, keepdims=True))
    a = _A_ref(x, A_wqkv, A_w_phi, A_wo)
    b = _B_ref(x, B_wqkv, B_wo)
    return g * a + (1 - g) * b
```

```asm
; @launch grid=(256,1,1) block=(256,1,1) lds=163840
.amdgcn_target "amdgcn-amd-amdhsa--gfx950"
.text
.globl gated_mix__linear_kernel_hedgehog__sliding_local_dilated__prompt_kernel
.p2align 8
.type gated_mix__linear_kernel_hedgehog__sliding_local_dilated__prompt_kernel,@function
gated_mix__linear_kernel_hedgehog__sliding_local_dilated__prompt_kernel:
    s_cmp_ge_u32 s2, 256
    s_cbranch_scc1 L_k1_end
    s_load_dwordx16 s[64:79], s[0:1], 0
    s_load_dwordx4 s[80:83], s[0:1], 64
    s_load_dwordx2 s[84:85], s[0:1], 80
    s_and_b32 s28, s2, 7
    s_lshr_b32 s29, s2, 3
    s_lshr_b32 s20, s28, 2
    s_lshl_b32 s20, s20, 3
    s_lshr_b32 s30, s29, 2
    s_add_u32 s20, s20, s30
    s_and_b32 s21, s28, 3
    s_lshl_b32 s21, s21, 2
    s_and_b32 s30, s29, 3
    s_add_u32 s21, s21, s30
    s_lshr_b32 s3, s21, 3
    s_and_b32 s21, s21, 7
    v_and_b32 v1, 63, v0
    v_lshrrev_b32 v2, 6, v0
    s_nop 0
    v_readfirstlane_b32 s27, v2
    v_lshrrev_b32 v2, 4, v1
    v_and_b32 v3, 15, v1
    s_lshl_b32 s28, s20, 7
    s_lshl_b32 s29, s27, 5
    s_add_u32 s28, s28, s29
    v_lshrrev_b32 v14, 3, v1
    v_add_u32 v4, s28, v14
    v_mul_u32_u24 v4, 1280, v4
    v_lshrrev_b32 v14, 1, v14
    v_and_b32 v15, 7, v1
    v_xor_b32 v14, v14, v15
    v_lshl_add_u32 v4, v14, 4, v4
    s_lshr_b32 s28, s27, 1
    s_mul_i32 s24, s28, 122880
    s_and_b32 s28, s27, 1
    s_add_u32 s28, s28, 1
    s_mul_i32 s28, s28, 1280
    s_add_u32 s24, s24, s28
    s_mul_i32 s28, s21, 160
    s_add_u32 s24, s24, s28
    s_mov_b32 s25, s28
    s_lshr_b32 s29, s2, 3
    s_lshr_b32 s86, s29, 2
    s_and_b32 s29, s29, 3
    s_lshl_b32 s29, s29, 1
    s_add_u32 s86, s86, s29
    s_cmp_ge_u32 s86, 10
    s_cselect_b32 s29, 10, 0
    s_sub_u32 s86, s86, s29
    s_lshl_b32 s87, s86, 1
    s_add_u32 s87, s87, s27
    s_cmp_ge_u32 s87, 20
    s_cselect_b32 s29, 20, 0
    s_sub_u32 s87, s87, s29
    s_mul_i32 s26, s27, 5120
    v_add_u32 v16, 0, v1
    v_mul_u32_u24 v14, 0x199a, v16
    v_lshrrev_b32 v14, 16, v14
    v_mul_u32_u24 v15, 10, v14
    v_sub_u32 v15, v16, v15
    v_lshrrev_b32 v16, 4, v14
    v_bfe_u32 v17, v14, 2, 2
    v_and_b32 v18, 3, v14
    v_lshlrev_b32 v17, 3, v17
    v_lshl_add_u32 v17, v16, 2, v17
    v_add_u32 v17, v17, v18
    v_mul_u32_u24 v17, 3840, v17
    v_lshl_add_u32 v5, v15, 4, v17
    v_add_u32 v16, 64, v1
    v_mul_u32_u24 v14, 0x199a, v16
    v_lshrrev_b32 v14, 16, v14
    v_mul_u32_u24 v15, 10, v14
    v_sub_u32 v15, v16, v15
    v_lshrrev_b32 v16, 4, v14
    v_bfe_u32 v17, v14, 2, 2
    v_and_b32 v18, 3, v14
    v_lshlrev_b32 v17, 3, v17
    v_lshl_add_u32 v17, v16, 2, v17
    v_add_u32 v17, v17, v18
    v_mul_u32_u24 v17, 3840, v17
    v_lshl_add_u32 v6, v15, 4, v17
    v_add_u32 v16, 128, v1
    v_mul_u32_u24 v14, 0x199a, v16
    v_lshrrev_b32 v14, 16, v14
    v_mul_u32_u24 v15, 10, v14
    v_sub_u32 v15, v16, v15
    v_lshrrev_b32 v16, 4, v14
    v_bfe_u32 v17, v14, 2, 2
    v_and_b32 v18, 3, v14
    v_lshlrev_b32 v17, 3, v17
    v_lshl_add_u32 v17, v16, 2, v17
    v_add_u32 v17, v17, v18
    v_mul_u32_u24 v17, 3840, v17
    v_lshl_add_u32 v7, v15, 4, v17
    v_add_u32 v16, 192, v1
    v_mul_u32_u24 v14, 0x199a, v16
    v_lshrrev_b32 v14, 16, v14
    v_mul_u32_u24 v15, 10, v14
    v_sub_u32 v15, v16, v15
    v_lshrrev_b32 v16, 4, v14
    v_bfe_u32 v17, v14, 2, 2
    v_and_b32 v18, 3, v14
    v_lshlrev_b32 v17, 3, v17
    v_lshl_add_u32 v17, v16, 2, v17
    v_add_u32 v17, v17, v18
    v_mul_u32_u24 v17, 3840, v17
    v_lshl_add_u32 v8, v15, 4, v17
    v_add_u32 v16, 256, v1
    v_mul_u32_u24 v14, 0x199a, v16
    v_lshrrev_b32 v14, 16, v14
    v_mul_u32_u24 v15, 10, v14
    v_sub_u32 v15, v16, v15
    v_lshrrev_b32 v16, 4, v14
    v_bfe_u32 v17, v14, 2, 2
    v_and_b32 v18, 3, v14
    v_lshlrev_b32 v17, 3, v17
    v_lshl_add_u32 v17, v16, 2, v17
    v_add_u32 v17, v17, v18
    v_mul_u32_u24 v17, 3840, v17
    v_lshl_add_u32 v9, v15, 4, v17
    s_mul_i32 s23, s27, 12288
    s_add_u32 s23, s23, 102400
    v_xor_b32 v240, 64, v4
    s_waitcnt lgkmcnt(0)
    s_mov_b32 s4, s64
    s_mov_b32 s5, s65
    s_mov_b32 s6, 0x280000
    s_mov_b32 s7, 0x00020000
    s_cmp_eq_u32 s3, 0
    s_cselect_b32 s8, s66, s74
    s_cselect_b32 s9, s67, s75
    s_mov_b32 s10, 2457600
    s_mov_b32 s11, 0x00020000
    s_mov_b32 s12, s84
    s_mov_b32 s13, s85
    s_mov_b32 s14, 0x10000000
    s_mov_b32 s15, 0x00020000
    s_mov_b32 s16, s82
    s_mov_b32 s17, s83
    s_mov_b32 s18, 0x100
    s_mov_b32 s19, 0x00020000
    s_or_b32 s28, s3, s27
    s_cmp_lg_u32 s28, 0
    s_cbranch_scc1 L_nz
    v_mov_b32 v16, 0
    v_mov_b32 v17, 0
    v_mov_b32 v18, 0
    v_mov_b32 v19, 0
    v_lshlrev_b32 v15, 4, v1
    s_lshl_b32 s28, s21, 14
    s_lshl_b32 s29, s20, 10
    s_add_u32 s28, s28, s29
    buffer_store_dwordx4 v[16:19], v15, s[12:15], s28 offen sc0 sc1
    s_nop 1
L_nz:
    v_mov_b32 v241, v1
    v_mov_b32 v1, v240
    s_add_u32 s29, s86, 0
    s_cmp_ge_u32 s29, 10
    s_cselect_b32 s101, 10, 0
    s_sub_u32 s29, s29, s101
    s_lshl_b32 s29, s29, 7
    s_add_u32 m0, s23, 0
    s_add_u32 s28, s29, 0
    buffer_load_dwordx4 v4, s[4:7], s28 offen lds
    s_add_u32 m0, s23, 1024
    s_add_u32 s28, s29, 10240
    buffer_load_dwordx4 v1, s[4:7], s28 offen lds
    s_add_u32 m0, s23, 2048
    s_add_u32 s28, s29, 20480
    buffer_load_dwordx4 v4, s[4:7], s28 offen lds
    s_add_u32 m0, s23, 3072
    s_add_u32 s28, s29, 30720
    buffer_load_dwordx4 v1, s[4:7], s28 offen lds
    s_add_u32 s28, s86, 0
    s_cmp_ge_u32 s28, 10
    s_cselect_b32 s101, 10, 0
    s_sub_u32 s28, s28, s101
    s_mul_i32 s28, s28, 245760
    s_add_u32 s28, s28, s24
    s_add_u32 m0, s26, 0
    s_nop 0
    buffer_load_dwordx4 v5, s[8:11], s28 offen lds
    s_add_u32 m0, s26, 1024
    s_nop 0
    buffer_load_dwordx4 v6, s[8:11], s28 offen lds
    s_add_u32 m0, s26, 2048
    s_nop 0
    buffer_load_dwordx4 v7, s[8:11], s28 offen lds
    s_add_u32 m0, s26, 3072
    s_nop 0
    buffer_load_dwordx4 v8, s[8:11], s28 offen lds
    s_add_u32 m0, s26, 4096
    s_nop 0
    buffer_load_dwordx4 v9, s[8:11], s28 offen lds
    s_add_u32 s29, s86, 1
    s_cmp_ge_u32 s29, 10
    s_cselect_b32 s101, 10, 0
    s_sub_u32 s29, s29, s101
    s_lshl_b32 s29, s29, 7
    s_add_u32 m0, s23, 4096
    s_add_u32 s28, s29, 0
    buffer_load_dwordx4 v4, s[4:7], s28 offen lds
    s_add_u32 m0, s23, 5120
    s_add_u32 s28, s29, 10240
    buffer_load_dwordx4 v1, s[4:7], s28 offen lds
    s_add_u32 m0, s23, 6144
    s_add_u32 s28, s29, 20480
    buffer_load_dwordx4 v4, s[4:7], s28 offen lds
    s_add_u32 m0, s23, 7168
    s_add_u32 s28, s29, 30720
    buffer_load_dwordx4 v1, s[4:7], s28 offen lds
    s_add_u32 s28, s86, 1
    s_cmp_ge_u32 s28, 10
    s_cselect_b32 s101, 10, 0
    s_sub_u32 s28, s28, s101
    s_mul_i32 s28, s28, 245760
    s_add_u32 s28, s28, s24
    s_add_u32 m0, s26, 20480
    s_nop 0
    buffer_load_dwordx4 v5, s[8:11], s28 offen lds
    s_add_u32 m0, s26, 21504
    s_nop 0
    buffer_load_dwordx4 v6, s[8:11], s28 offen lds
    s_add_u32 m0, s26, 22528
    s_nop 0
    buffer_load_dwordx4 v7, s[8:11], s28 offen lds
    s_add_u32 m0, s26, 23552
    s_nop 0
    buffer_load_dwordx4 v8, s[8:11], s28 offen lds
    s_add_u32 m0, s26, 24576
    s_nop 0
    buffer_load_dwordx4 v9, s[8:11], s28 offen lds
    s_add_u32 s29, s86, 2
    s_cmp_ge_u32 s29, 10
    s_cselect_b32 s101, 10, 0
    s_sub_u32 s29, s29, s101
    s_lshl_b32 s29, s29, 7
    s_add_u32 m0, s23, 8192
    s_add_u32 s28, s29, 0
    buffer_load_dwordx4 v4, s[4:7], s28 offen lds
    s_add_u32 m0, s23, 9216
    s_add_u32 s28, s29, 10240
    buffer_load_dwordx4 v1, s[4:7], s28 offen lds
    s_add_u32 m0, s23, 10240
    s_add_u32 s28, s29, 20480
    buffer_load_dwordx4 v4, s[4:7], s28 offen lds
    s_add_u32 m0, s23, 11264
    s_add_u32 s28, s29, 30720
    buffer_load_dwordx4 v1, s[4:7], s28 offen lds
    s_add_u32 s28, s86, 2
    s_cmp_ge_u32 s28, 10
    s_cselect_b32 s101, 10, 0
    s_sub_u32 s28, s28, s101
    s_mul_i32 s28, s28, 245760
    s_add_u32 s28, s28, s24
    s_add_u32 m0, s26, 40960
    s_nop 0
    buffer_load_dwordx4 v5, s[8:11], s28 offen lds
    s_add_u32 m0, s26, 41984
    s_nop 0
    buffer_load_dwordx4 v6, s[8:11], s28 offen lds
    s_add_u32 m0, s26, 43008
    s_nop 0
    buffer_load_dwordx4 v7, s[8:11], s28 offen lds
    s_add_u32 m0, s26, 44032
    s_nop 0
    buffer_load_dwordx4 v8, s[8:11], s28 offen lds
    s_add_u32 m0, s26, 45056
    s_nop 0
    buffer_load_dwordx4 v9, s[8:11], s28 offen lds
    s_add_u32 s28, s86, 3
    s_cmp_ge_u32 s28, 10
    s_cselect_b32 s101, 10, 0
    s_sub_u32 s28, s28, s101
    s_mul_i32 s28, s28, 245760
    s_add_u32 s28, s28, s24
    s_add_u32 m0, s26, 61440
    s_nop 0
    buffer_load_dwordx4 v5, s[8:11], s28 offen lds
    s_add_u32 m0, s26, 62464
    s_nop 0
    buffer_load_dwordx4 v6, s[8:11], s28 offen lds
    s_add_u32 m0, s26, 63488
    s_nop 0
    buffer_load_dwordx4 v7, s[8:11], s28 offen lds
    s_add_u32 m0, s26, 64512
    s_nop 0
    buffer_load_dwordx4 v8, s[8:11], s28 offen lds
    s_add_u32 m0, s26, 65536
    s_nop 0
    buffer_load_dwordx4 v9, s[8:11], s28 offen lds
    v_mov_b32 v1, v241
    v_lshrrev_b32 v16, 2, v3
    v_and_b32 v17, 3, v3
    v_lshl_add_u32 v16, v2, 2, v16
    v_mul_u32_u24 v16, 160, v16
    v_lshl_add_u32 v10, v17, 3, v16
    v_add_u32 v11, 61440, v10
    v_mul_u32_u24 v17, 40, v17
    v_add_u32 v12, v16, v17
    v_add_u32 v13, 61440, v12
    s_mov_b32 s31, 0x3fb8aa3b
    s_mov_b32 s62, s31
    s_mov_b32 s63, s31
    s_cmp_eq_u32 s3, 0
    s_cbranch_scc0 L_k1_B
    s_mov_b32 s32, s68
    s_mov_b32 s33, s69
    s_mov_b32 s34, 0x6400
    s_mov_b32 s35, 0x00020000
    s_mul_i32 s28, s21, 3200
    v_lshlrev_b32 v15, 4, v0
    buffer_load_dwordx4 v[16:19], v15, s[32:35], s28 offen
    v_mov_b32 v20, 0
    v_mov_b32 v21, 0
    v_mov_b32 v22, 0
    v_mov_b32 v23, 0
    v_add_u32 v24, 154880, v15
    v_cmp_gt_u32 vcc, 128, v0
    s_nop 0
    s_and_saveexec_b64 s[28:29], vcc
    ds_write_b128 v24, v[20:23]
    s_mov_b64 exec, s[28:29]
    s_waitcnt vmcnt(0)
    v_add_u32 v24, 151552, v15
    v_cmp_gt_u32 vcc, 200, v0
    s_nop 0
    s_and_saveexec_b64 s[28:29], vcc
    ds_write_b128 v24, v[16:19]
    s_mov_b64 exec, s[28:29]
    v_lshrrev_b32 v16, 1, v3
    v_xor_b32 v16, v16, v2
    v_lshlrev_b32 v17, 7, v3
    v_add_u32 v17, s23, v17
    v_lshl_add_u32 v14, v16, 4, v17
    v_xor_b32 v15, 64, v14
    v_xor_b32 v1, 64, v4
    ds_read_b128 a[0:3], v14 offset:0
    ds_read_b128 a[4:7], v14 offset:2048
    ds_read_b128 a[8:11], v15 offset:0
    ds_read_b128 a[12:15], v15 offset:2048
    s_waitcnt lgkmcnt(0)
    s_barrier
    s_add_u32 s29, s86, 3
    s_cmp_ge_u32 s29, 10
    s_cselect_b32 s101, 10, 0
    s_sub_u32 s29, s29, s101
    s_lshl_b32 s29, s29, 7
    s_add_u32 m0, s23, 0
    s_add_u32 s28, s29, 0
    buffer_load_dwordx4 v4, s[4:7], s28 offen lds
    s_add_u32 m0, s23, 1024
    s_add_u32 s28, s29, 10240
    buffer_load_dwordx4 v1, s[4:7], s28 offen lds
    s_add_u32 m0, s23, 2048
    s_add_u32 s28, s29, 20480
    buffer_load_dwordx4 v4, s[4:7], s28 offen lds
    s_add_u32 m0, s23, 3072
    s_add_u32 s28, s29, 30720
    buffer_load_dwordx4 v1, s[4:7], s28 offen lds
    v_mov_b32 v16, v14
    s_cmp_lg_u32 s27, 0
    s_cbranch_scc1 L_sz
    v_mov_b32 v14, 1
    s_lshl_b32 s28, s21, 2
    s_mov_b64 exec, 1
    buffer_atomic_add v14, off, s[16:19], s28 offset:0
    s_mov_b64 exec, -1
    s_nop 0
L_sz:
    v_mov_b32 v14, v16
    ds_read_b64_tr_b16 v[16:17], v12 offset:0
    ds_read_b64_tr_b16 v[18:19], v12 offset:2560
    ds_read_b64_tr_b16 v[20:21], v12 offset:8
    ds_read_b64_tr_b16 v[22:23], v12 offset:2568
    ds_read_b64_tr_b16 v[24:25], v12 offset:16
    ds_read_b64_tr_b16 v[26:27], v12 offset:2576
    ds_read_b64_tr_b16 v[28:29], v12 offset:24
    ds_read_b64_tr_b16 v[30:31], v12 offset:2584
    ds_read_b64_tr_b16 v[32:33], v12 offset:32
    ds_read_b64_tr_b16 v[34:35], v12 offset:2592
    ds_read_b64_tr_b16 v[36:37], v10 offset:5120
    ds_read_b64_tr_b16 v[38:39], v10 offset:7680
    ds_read_b64_tr_b16 v[40:41], v10 offset:5152
    ds_read_b64_tr_b16 v[42:43], v10 offset:7712
    ds_read_b64_tr_b16 v[44:45], v10 offset:5184
    ds_read_b64_tr_b16 v[46:47], v10 offset:7744
    ds_read_b64_tr_b16 v[48:49], v10 offset:5216
    ds_read_b64_tr_b16 v[50:51], v10 offset:7776
    ds_read_b64_tr_b16 v[52:53], v10 offset:5248
    ds_read_b64_tr_b16 v[54:55], v10 offset:7808
    s_waitcnt lgkmcnt(0)
    v_mfma_f32_16x16x32_bf16 v[96:99], v[16:19], a[0:3], 0
    ds_read_b64_tr_b16 v[56:57], v12 offset:10240
    ds_read_b64_tr_b16 v[58:59], v12 offset:12800
    v_mfma_f32_16x16x32_bf16 v[116:119], v[16:19], a[4:7], 0
    ds_read_b64_tr_b16 v[60:61], v12 offset:10248
    ds_read_b64_tr_b16 v[62:63], v12 offset:12808
    v_mfma_f32_16x16x32_bf16 v[100:103], v[20:23], a[0:3], 0
    ds_read_b64_tr_b16 v[64:65], v12 offset:10256
    ds_read_b64_tr_b16 v[66:67], v12 offset:12816
    v_mfma_f32_16x16x32_bf16 v[120:123], v[20:23], a[4:7], 0
    ds_read_b64_tr_b16 v[68:69], v12 offset:10264
    ds_read_b64_tr_b16 v[70:71], v12 offset:12824
    v_mfma_f32_16x16x32_bf16 v[104:107], v[24:27], a[0:3], 0
    ds_read_b64_tr_b16 v[72:73], v12 offset:10272
    ds_read_b64_tr_b16 v[74:75], v12 offset:12832
    v_mfma_f32_16x16x32_bf16 v[124:127], v[24:27], a[4:7], 0
    ds_read_b64_tr_b16 v[76:77], v10 offset:15360
    ds_read_b64_tr_b16 v[78:79], v10 offset:17920
    v_mfma_f32_16x16x32_bf16 v[108:111], v[28:31], a[0:3], 0
    ds_read_b64_tr_b16 v[80:81], v10 offset:15392
    ds_read_b64_tr_b16 v[82:83], v10 offset:17952
    v_mfma_f32_16x16x32_bf16 v[128:131], v[28:31], a[4:7], 0
    ds_read_b64_tr_b16 v[84:85], v10 offset:15424
    ds_read_b64_tr_b16 v[86:87], v10 offset:17984
    v_mfma_f32_16x16x32_bf16 v[112:115], v[32:35], a[0:3], 0
    ds_read_b64_tr_b16 v[88:89], v10 offset:15456
    ds_read_b64_tr_b16 v[90:91], v10 offset:18016
    v_mfma_f32_16x16x32_bf16 v[132:135], v[32:35], a[4:7], 0
    ds_read_b64_tr_b16 v[92:93], v10 offset:15488
    ds_read_b64_tr_b16 v[94:95], v10 offset:18048
    v_mfma_f32_16x16x32_bf16 v[136:139], a[0:3], v[36:39], 0
    v_mfma_f32_16x16x32_bf16 v[156:159], a[4:7], v[36:39], 0
    v_mfma_f32_16x16x32_bf16 v[140:143], a[0:3], v[40:43], 0
    v_mfma_f32_16x16x32_bf16 v[160:163], a[4:7], v[40:43], 0
    v_mfma_f32_16x16x32_bf16 v[144:147], a[0:3], v[44:47], 0
    v_mfma_f32_16x16x32_bf16 v[164:167], a[4:7], v[44:47], 0
    v_mfma_f32_16x16x32_bf16 v[148:151], a[0:3], v[48:51], 0
    v_mfma_f32_16x16x32_bf16 v[168:171], a[4:7], v[48:51], 0
    v_mfma_f32_16x16x32_bf16 v[152:155], a[0:3], v[52:55], 0
    v_mfma_f32_16x16x32_bf16 v[172:175], a[4:7], v[52:55], 0
    s_waitcnt lgkmcnt(0)
    s_barrier
    s_add_u32 s28, s86, 4
    s_cmp_ge_u32 s28, 10
    s_cselect_b32 s101, 10, 0
    s_sub_u32 s28, s28, s101
    s_mul_i32 s28, s28, 245760
    s_add_u32 s28, s28, s24
    s_add_u32 m0, s26, 81920
    s_nop 0
    buffer_load_dwordx4 v5, s[8:11], s28 offen lds
    s_add_u32 m0, s26, 82944
    s_nop 0
    buffer_load_dwordx4 v6, s[8:11], s28 offen lds
    s_add_u32 m0, s26, 83968
    s_nop 0
    buffer_load_dwordx4 v7, s[8:11], s28 offen lds
    s_add_u32 m0, s26, 84992
    s_nop 0
    buffer_load_dwordx4 v8, s[8:11], s28 offen lds
    s_add_u32 m0, s26, 86016
    s_nop 0
    buffer_load_dwordx4 v9, s[8:11], s28 offen lds
    v_mfma_f32_16x16x32_bf16 v[96:99], v[56:59], a[8:11], v[96:99]
    ds_read_b128 a[16:19], v14 offset:4096
    ds_read_b128 a[20:23], v14 offset:6144
    v_mfma_f32_16x16x32_bf16 v[116:119], v[56:59], a[12:15], v[116:119]
    ds_read_b128 a[24:27], v15 offset:4096
    ds_read_b128 a[28:31], v15 offset:6144
    v_mfma_f32_16x16x32_bf16 v[100:103], v[60:63], a[8:11], v[100:103]
    ds_read_b64_tr_b16 v[16:17], v12 offset:20480
    ds_read_b64_tr_b16 v[18:19], v12 offset:23040
    v_mfma_f32_16x16x32_bf16 v[120:123], v[60:63], a[12:15], v[120:123]
    ds_read_b64_tr_b16 v[20:21], v12 offset:20488
    ds_read_b64_tr_b16 v[22:23], v12 offset:23048
    v_mfma_f32_16x16x32_bf16 v[104:107], v[64:67], a[8:11], v[104:107]
    ds_read_b64_tr_b16 v[24:25], v12 offset:20496
    ds_read_b64_tr_b16 v[26:27], v12 offset:23056
    v_mfma_f32_16x16x32_bf16 v[124:127], v[64:67], a[12:15], v[124:127]
    ds_read_b64_tr_b16 v[28:29], v12 offset:20504
    ds_read_b64_tr_b16 v[30:31], v12 offset:23064
    v_mfma_f32_16x16x32_bf16 v[108:111], v[68:71], a[8:11], v[108:111]
    ds_read_b64_tr_b16 v[32:33], v12 offset:20512
    ds_read_b64_tr_b16 v[34:35], v12 offset:23072
    v_mfma_f32_16x16x32_bf16 v[128:131], v[68:71], a[12:15], v[128:131]
    ds_read_b64_tr_b16 v[36:37], v10 offset:25600
    ds_read_b64_tr_b16 v[38:39], v10 offset:28160
    v_mfma_f32_16x16x32_bf16 v[112:115], v[72:75], a[8:11], v[112:115]
    ds_read_b64_tr_b16 v[40:41], v10 offset:25632
    ds_read_b64_tr_b16 v[42:43], v10 offset:28192
    v_mfma_f32_16x16x32_bf16 v[132:135], v[72:75], a[12:15], v[132:135]
    ds_read_b64_tr_b16 v[44:45], v10 offset:25664
    ds_read_b64_tr_b16 v[46:47], v10 offset:28224
    v_mfma_f32_16x16x32_bf16 v[136:139], a[8:11], v[76:79], v[136:139]
    ds_read_b64_tr_b16 v[48:49], v10 offset:25696
    ds_read_b64_tr_b16 v[50:51], v10 offset:28256
    v_mfma_f32_16x16x32_bf16 v[156:159], a[12:15], v[76:79], v[156:159]
    ds_read_b64_tr_b16 v[52:53], v10 offset:25728
    ds_read_b64_tr_b16 v[54:55], v10 offset:28288
    v_mfma_f32_16x16x32_bf16 v[140:143], a[8:11], v[80:83], v[140:143]
    v_mfma_f32_16x16x32_bf16 v[160:163], a[12:15], v[80:83], v[160:163]
    v_mfma_f32_16x16x32_bf16 v[144:147], a[8:11], v[84:87], v[144:147]
    v_mfma_f32_16x16x32_bf16 v[164:167], a[12:15], v[84:87], v[164:167]
    v_mfma_f32_16x16x32_bf16 v[148:151], a[8:11], v[88:91], v[148:151]
    v_mfma_f32_16x16x32_bf16 v[168:171], a[12:15], v[88:91], v[168:171]
    v_mfma_f32_16x16x32_bf16 v[152:155], a[8:11], v[92:95], v[152:155]
    v_mfma_f32_16x16x32_bf16 v[172:175], a[12:15], v[92:95], v[172:175]
    s_waitcnt lgkmcnt(0)
    s_add_u32 s29, s86, 4
    s_cmp_ge_u32 s29, 10
    s_cselect_b32 s101, 10, 0
    s_sub_u32 s29, s29, s101
    s_lshl_b32 s29, s29, 7
    s_add_u32 m0, s23, 4096
    s_add_u32 s28, s29, 0
    buffer_load_dwordx4 v4, s[4:7], s28 offen lds
    s_add_u32 m0, s23, 5120
    s_add_u32 s28, s29, 10240
    buffer_load_dwordx4 v1, s[4:7], s28 offen lds
    s_add_u32 m0, s23, 6144
    s_add_u32 s28, s29, 20480
    buffer_load_dwordx4 v4, s[4:7], s28 offen lds
    s_add_u32 m0, s23, 7168
    s_add_u32 s28, s29, 30720
    buffer_load_dwordx4 v1, s[4:7], s28 offen lds
    v_mfma_f32_16x16x32_bf16 v[96:99], v[16:19], a[16:19], v[96:99]
    ds_read_b64_tr_b16 v[56:57], v12 offset:30720
    ds_read_b64_tr_b16 v[58:59], v12 offset:33280
    v_mfma_f32_16x16x32_bf16 v[116:119], v[16:19], a[20:23], v[116:119]
    ds_read_b64_tr_b16 v[60:61], v12 offset:30728
    ds_read_b64_tr_b16 v[62:63], v12 offset:33288
    v_mfma_f32_16x16x32_bf16 v[100:103], v[20:23], a[16:19], v[100:103]
    ds_read_b64_tr_b16 v[64:65], v12 offset:30736
    ds_read_b64_tr_b16 v[66:67], v12 offset:33296
    v_mfma_f32_16x16x32_bf16 v[120:123], v[20:23], a[20:23], v[120:123]
    ds_read_b64_tr_b16 v[68:69], v12 offset:30744
    ds_read_b64_tr_b16 v[70:71], v12 offset:33304
    v_mfma_f32_16x16x32_bf16 v[104:107], v[24:27], a[16:19], v[104:107]
    ds_read_b64_tr_b16 v[72:73], v12 offset:30752
    ds_read_b64_tr_b16 v[74:75], v12 offset:33312
    v_mfma_f32_16x16x32_bf16 v[124:127], v[24:27], a[20:23], v[124:127]
    ds_read_b64_tr_b16 v[76:77], v10 offset:35840
    ds_read_b64_tr_b16 v[78:79], v10 offset:38400
    v_mfma_f32_16x16x32_bf16 v[108:111], v[28:31], a[16:19], v[108:111]
    ds_read_b64_tr_b16 v[80:81], v10 offset:35872
    ds_read_b64_tr_b16 v[82:83], v10 offset:38432
    v_mfma_f32_16x16x32_bf16 v[128:131], v[28:31], a[20:23], v[128:131]
    ds_read_b64_tr_b16 v[84:85], v10 offset:35904
    ds_read_b64_tr_b16 v[86:87], v10 offset:38464
    v_mfma_f32_16x16x32_bf16 v[112:115], v[32:35], a[16:19], v[112:115]
    ds_read_b64_tr_b16 v[88:89], v10 offset:35936
    ds_read_b64_tr_b16 v[90:91], v10 offset:38496
    v_mfma_f32_16x16x32_bf16 v[132:135], v[32:35], a[20:23], v[132:135]
    ds_read_b64_tr_b16 v[92:93], v10 offset:35968
    ds_read_b64_tr_b16 v[94:95], v10 offset:38528
    v_mfma_f32_16x16x32_bf16 v[136:139], a[16:19], v[36:39], v[136:139]
    v_mfma_f32_16x16x32_bf16 v[156:159], a[20:23], v[36:39], v[156:159]
    v_mfma_f32_16x16x32_bf16 v[140:143], a[16:19], v[40:43], v[140:143]
    v_mfma_f32_16x16x32_bf16 v[160:163], a[20:23], v[40:43], v[160:163]
    v_mfma_f32_16x16x32_bf16 v[144:147], a[16:19], v[44:47], v[144:147]
    v_mfma_f32_16x16x32_bf16 v[164:167], a[20:23], v[44:47], v[164:167]
    v_mfma_f32_16x16x32_bf16 v[148:151], a[16:19], v[48:51], v[148:151]
    v_mfma_f32_16x16x32_bf16 v[168:171], a[20:23], v[48:51], v[168:171]
    v_mfma_f32_16x16x32_bf16 v[152:155], a[16:19], v[52:55], v[152:155]
    v_mfma_f32_16x16x32_bf16 v[172:175], a[20:23], v[52:55], v[172:175]
    s_waitcnt lgkmcnt(0)
    s_barrier
    s_add_u32 s28, s86, 5
    s_cmp_ge_u32 s28, 10
    s_cselect_b32 s101, 10, 0
    s_sub_u32 s28, s28, s101
    s_mul_i32 s28, s28, 245760
    s_add_u32 s28, s28, s24
    s_add_u32 m0, s26, 0
    s_nop 0
    buffer_load_dwordx4 v5, s[8:11], s28 offen lds
    s_add_u32 m0, s26, 1024
    s_nop 0
    buffer_load_dwordx4 v6, s[8:11], s28 offen lds
    s_add_u32 m0, s26, 2048
    s_nop 0
    buffer_load_dwordx4 v7, s[8:11], s28 offen lds
    s_add_u32 m0, s26, 3072
    s_nop 0
    buffer_load_dwordx4 v8, s[8:11], s28 offen lds
    s_add_u32 m0, s26, 4096
    s_nop 0
    buffer_load_dwordx4 v9, s[8:11], s28 offen lds
    v_mfma_f32_16x16x32_bf16 v[96:99], v[56:59], a[24:27], v[96:99]
    ds_read_b128 a[32:35], v14 offset:8192
    ds_read_b128 a[36:39], v14 offset:10240
    v_mfma_f32_16x16x32_bf16 v[116:119], v[56:59], a[28:31], v[116:119]
    ds_read_b128 a[40:43], v15 offset:8192
    ds_read_b128 a[44:47], v15 offset:10240
    v_mfma_f32_16x16x32_bf16 v[100:103], v[60:63], a[24:27], v[100:103]
    ds_read_b64_tr_b16 v[16:17], v12 offset:40960
    ds_read_b64_tr_b16 v[18:19], v12 offset:43520
    v_mfma_f32_16x16x32_bf16 v[120:123], v[60:63], a[28:31], v[120:123]
    ds_read_b64_tr_b16 v[20:21], v12 offset:40968
    ds_read_b64_tr_b16 v[22:23], v12 offset:43528
    v_mfma_f32_16x16x32_bf16 v[104:107], v[64:67], a[24:27], v[104:107]
    ds_read_b64_tr_b16 v[24:25], v12 offset:40976
    ds_read_b64_tr_b16 v[26:27], v12 offset:43536
    v_mfma_f32_16x16x32_bf16 v[124:127], v[64:67], a[28:31], v[124:127]
    ds_read_b64_tr_b16 v[28:29], v12 offset:40984
    ds_read_b64_tr_b16 v[30:31], v12 offset:43544
    v_mfma_f32_16x16x32_bf16 v[108:111], v[68:71], a[24:27], v[108:111]
    ds_read_b64_tr_b16 v[32:33], v12 offset:40992
    ds_read_b64_tr_b16 v[34:35], v12 offset:43552
    v_mfma_f32_16x16x32_bf16 v[128:131], v[68:71], a[28:31], v[128:131]
    ds_read_b64_tr_b16 v[36:37], v10 offset:46080
    ds_read_b64_tr_b16 v[38:39], v10 offset:48640
    v_mfma_f32_16x16x32_bf16 v[112:115], v[72:75], a[24:27], v[112:115]
    ds_read_b64_tr_b16 v[40:41], v10 offset:46112
    ds_read_b64_tr_b16 v[42:43], v10 offset:48672
    v_mfma_f32_16x16x32_bf16 v[132:135], v[72:75], a[28:31], v[132:135]
    ds_read_b64_tr_b16 v[44:45], v10 offset:46144
    ds_read_b64_tr_b16 v[46:47], v10 offset:48704
    v_mfma_f32_16x16x32_bf16 v[136:139], a[24:27], v[76:79], v[136:139]
    ds_read_b64_tr_b16 v[48:49], v10 offset:46176
    ds_read_b64_tr_b16 v[50:51], v10 offset:48736
    v_mfma_f32_16x16x32_bf16 v[156:159], a[28:31], v[76:79], v[156:159]
    ds_read_b64_tr_b16 v[52:53], v10 offset:46208
    ds_read_b64_tr_b16 v[54:55], v10 offset:48768
    v_mfma_f32_16x16x32_bf16 v[140:143], a[24:27], v[80:83], v[140:143]
    v_mfma_f32_16x16x32_bf16 v[160:163], a[28:31], v[80:83], v[160:163]
    v_mfma_f32_16x16x32_bf16 v[144:147], a[24:27], v[84:87], v[144:147]
    v_mfma_f32_16x16x32_bf16 v[164:167], a[28:31], v[84:87], v[164:167]
    v_mfma_f32_16x16x32_bf16 v[148:151], a[24:27], v[88:91], v[148:151]
    v_mfma_f32_16x16x32_bf16 v[168:171], a[28:31], v[88:91], v[168:171]
    v_mfma_f32_16x16x32_bf16 v[152:155], a[24:27], v[92:95], v[152:155]
    v_mfma_f32_16x16x32_bf16 v[172:175], a[28:31], v[92:95], v[172:175]
    s_waitcnt lgkmcnt(0)
    s_add_u32 s29, s86, 5
    s_cmp_ge_u32 s29, 10
    s_cselect_b32 s101, 10, 0
    s_sub_u32 s29, s29, s101
    s_lshl_b32 s29, s29, 7
    s_add_u32 m0, s23, 8192
    s_add_u32 s28, s29, 0
    buffer_load_dwordx4 v4, s[4:7], s28 offen lds
    s_add_u32 m0, s23, 9216
    s_add_u32 s28, s29, 10240
    buffer_load_dwordx4 v1, s[4:7], s28 offen lds
    s_add_u32 m0, s23, 10240
    s_add_u32 s28, s29, 20480
    buffer_load_dwordx4 v4, s[4:7], s28 offen lds
    s_add_u32 m0, s23, 11264
    s_add_u32 s28, s29, 30720
    buffer_load_dwordx4 v1, s[4:7], s28 offen lds
    v_mfma_f32_16x16x32_bf16 v[96:99], v[16:19], a[32:35], v[96:99]
    ds_read_b64_tr_b16 v[56:57], v12 offset:51200
    ds_read_b64_tr_b16 v[58:59], v12 offset:53760
    v_mfma_f32_16x16x32_bf16 v[116:119], v[16:19], a[36:39], v[116:119]
    ds_read_b64_tr_b16 v[60:61], v12 offset:51208
    ds_read_b64_tr_b16 v[62:63], v12 offset:53768
    v_mfma_f32_16x16x32_bf16 v[100:103], v[20:23], a[32:35], v[100:103]
    ds_read_b64_tr_b16 v[64:65], v12 offset:51216
    ds_read_b64_tr_b16 v[66:67], v12 offset:53776
    v_mfma_f32_16x16x32_bf16 v[120:123], v[20:23], a[36:39], v[120:123]
    ds_read_b64_tr_b16 v[68:69], v12 offset:51224
    ds_read_b64_tr_b16 v[70:71], v12 offset:53784
    v_mfma_f32_16x16x32_bf16 v[104:107], v[24:27], a[32:35], v[104:107]
    ds_read_b64_tr_b16 v[72:73], v12 offset:51232
    ds_read_b64_tr_b16 v[74:75], v12 offset:53792
    v_mfma_f32_16x16x32_bf16 v[124:127], v[24:27], a[36:39], v[124:127]
    ds_read_b64_tr_b16 v[76:77], v10 offset:56320
    ds_read_b64_tr_b16 v[78:79], v10 offset:58880
    v_mfma_f32_16x16x32_bf16 v[108:111], v[28:31], a[32:35], v[108:111]
    ds_read_b64_tr_b16 v[80:81], v10 offset:56352
    ds_read_b64_tr_b16 v[82:83], v10 offset:58912
    v_mfma_f32_16x16x32_bf16 v[128:131], v[28:31], a[36:39], v[128:131]
    ds_read_b64_tr_b16 v[84:85], v10 offset:56384
    ds_read_b64_tr_b16 v[86:87], v10 offset:58944
    v_mfma_f32_16x16x32_bf16 v[112:115], v[32:35], a[32:35], v[112:115]
    ds_read_b64_tr_b16 v[88:89], v10 offset:56416
    ds_read_b64_tr_b16 v[90:91], v10 offset:58976
    v_mfma_f32_16x16x32_bf16 v[132:135], v[32:35], a[36:39], v[132:135]
    ds_read_b64_tr_b16 v[92:93], v10 offset:56448
    ds_read_b64_tr_b16 v[94:95], v10 offset:59008
    v_mfma_f32_16x16x32_bf16 v[136:139], a[32:35], v[36:39], v[136:139]
    v_mfma_f32_16x16x32_bf16 v[156:159], a[36:39], v[36:39], v[156:159]
    v_mfma_f32_16x16x32_bf16 v[140:143], a[32:35], v[40:43], v[140:143]
    v_mfma_f32_16x16x32_bf16 v[160:163], a[36:39], v[40:43], v[160:163]
    v_mfma_f32_16x16x32_bf16 v[144:147], a[32:35], v[44:47], v[144:147]
    v_mfma_f32_16x16x32_bf16 v[164:167], a[36:39], v[44:47], v[164:167]
    v_mfma_f32_16x16x32_bf16 v[148:151], a[32:35], v[48:51], v[148:151]
    v_mfma_f32_16x16x32_bf16 v[168:171], a[36:39], v[48:51], v[168:171]
    v_mfma_f32_16x16x32_bf16 v[152:155], a[32:35], v[52:55], v[152:155]
    v_mfma_f32_16x16x32_bf16 v[172:175], a[36:39], v[52:55], v[172:175]
    s_waitcnt lgkmcnt(0)
    s_waitcnt vmcnt(18)
    s_barrier
    s_add_u32 s28, s86, 6
    s_cmp_ge_u32 s28, 10
    s_cselect_b32 s101, 10, 0
    s_sub_u32 s28, s28, s101
    s_mul_i32 s28, s28, 245760
    s_add_u32 s28, s28, s24
    s_add_u32 m0, s26, 20480
    s_nop 0
    buffer_load_dwordx4 v5, s[8:11], s28 offen lds
    s_add_u32 m0, s26, 21504
    s_nop 0
    buffer_load_dwordx4 v6, s[8:11], s28 offen lds
    s_add_u32 m0, s26, 22528
    s_nop 0
    buffer_load_dwordx4 v7, s[8:11], s28 offen lds
    s_add_u32 m0, s26, 23552
    s_nop 0
    buffer_load_dwordx4 v8, s[8:11], s28 offen lds
    s_add_u32 m0, s26, 24576
    s_nop 0
    buffer_load_dwordx4 v9, s[8:11], s28 offen lds
    v_mfma_f32_16x16x32_bf16 v[96:99], v[56:59], a[40:43], v[96:99]
    ds_read_b128 a[48:51], v14 offset:0
    ds_read_b128 a[52:55], v14 offset:2048
    v_mfma_f32_16x16x32_bf16 v[116:119], v[56:59], a[44:47], v[116:119]
    ds_read_b128 a[56:59], v15 offset:0
    ds_read_b128 a[60:63], v15 offset:2048
    v_mfma_f32_16x16x32_bf16 v[100:103], v[60:63], a[40:43], v[100:103]
    ds_read_b64_tr_b16 v[16:17], v13 offset:0
    ds_read_b64_tr_b16 v[18:19], v13 offset:2560
    v_mfma_f32_16x16x32_bf16 v[120:123], v[60:63], a[44:47], v[120:123]
    ds_read_b64_tr_b16 v[20:21], v13 offset:8
    ds_read_b64_tr_b16 v[22:23], v13 offset:2568
    v_mfma_f32_16x16x32_bf16 v[104:107], v[64:67], a[40:43], v[104:107]
    ds_read_b64_tr_b16 v[24:25], v13 offset:16
    ds_read_b64_tr_b16 v[26:27], v13 offset:2576
    v_mfma_f32_16x16x32_bf16 v[124:127], v[64:67], a[44:47], v[124:127]
    ds_read_b64_tr_b16 v[28:29], v13 offset:24
    ds_read_b64_tr_b16 v[30:31], v13 offset:2584
    v_mfma_f32_16x16x32_bf16 v[108:111], v[68:71], a[40:43], v[108:111]
    ds_read_b64_tr_b16 v[32:33], v13 offset:32
    ds_read_b64_tr_b16 v[34:35], v13 offset:2592
    v_mfma_f32_16x16x32_bf16 v[128:131], v[68:71], a[44:47], v[128:131]
    ds_read_b64_tr_b16 v[36:37], v11 offset:5120
    ds_read_b64_tr_b16 v[38:39], v11 offset:7680
    v_mfma_f32_16x16x32_bf16 v[112:115], v[72:75], a[40:43], v[112:115]
    ds_read_b64_tr_b16 v[40:41], v11 offset:5152
    ds_read_b64_tr_b16 v[42:43], v11 offset:7712
    v_mfma_f32_16x16x32_bf16 v[132:135], v[72:75], a[44:47], v[132:135]
    ds_read_b64_tr_b16 v[44:45], v11 offset:5184
    ds_read_b64_tr_b16 v[46:47], v11 offset:7744
    v_mfma_f32_16x16x32_bf16 v[136:139], a[40:43], v[76:79], v[136:139]
    ds_read_b64_tr_b16 v[48:49], v11 offset:5216
    ds_read_b64_tr_b16 v[50:51], v11 offset:7776
    v_mfma_f32_16x16x32_bf16 v[156:159], a[44:47], v[76:79], v[156:159]
    ds_read_b64_tr_b16 v[52:53], v11 offset:5248
    ds_read_b64_tr_b16 v[54:55], v11 offset:7808
    v_mfma_f32_16x16x32_bf16 v[140:143], a[40:43], v[80:83], v[140:143]
    v_mfma_f32_16x16x32_bf16 v[160:163], a[44:47], v[80:83], v[160:163]
    v_mfma_f32_16x16x32_bf16 v[144:147], a[40:43], v[84:87], v[144:147]
    v_mfma_f32_16x16x32_bf16 v[164:167], a[44:47], v[84:87], v[164:167]
    v_mfma_f32_16x16x32_bf16 v[148:151], a[40:43], v[88:91], v[148:151]
    v_mfma_f32_16x16x32_bf16 v[168:171], a[44:47], v[88:91], v[168:171]
    v_mfma_f32_16x16x32_bf16 v[152:155], a[40:43], v[92:95], v[152:155]
    v_mfma_f32_16x16x32_bf16 v[172:175], a[44:47], v[92:95], v[172:175]
    s_waitcnt lgkmcnt(0)
    s_add_u32 s29, s86, 6
    s_cmp_ge_u32 s29, 10
    s_cselect_b32 s101, 10, 0
    s_sub_u32 s29, s29, s101
    s_lshl_b32 s29, s29, 7
    s_add_u32 m0, s23, 0
    s_add_u32 s28, s29, 0
    buffer_load_dwordx4 v4, s[4:7], s28 offen lds
    s_add_u32 m0, s23, 1024
    s_add_u32 s28, s29, 10240
    buffer_load_dwordx4 v1, s[4:7], s28 offen lds
    s_add_u32 m0, s23, 2048
    s_add_u32 s28, s29, 20480
    buffer_load_dwordx4 v4, s[4:7], s28 offen lds
    s_add_u32 m0, s23, 3072
    s_add_u32 s28, s29, 30720
    buffer_load_dwordx4 v1, s[4:7], s28 offen lds
    v_mfma_f32_16x16x32_bf16 v[96:99], v[16:19], a[48:51], v[96:99]
    ds_read_b64_tr_b16 v[56:57], v13 offset:10240
    ds_read_b64_tr_b16 v[58:59], v13 offset:12800
    v_mfma_f32_16x16x32_bf16 v[116:119], v[16:19], a[52:55], v[116:119]
    ds_read_b64_tr_b16 v[60:61], v13 offset:10248
    ds_read_b64_tr_b16 v[62:63], v13 offset:12808
    v_mfma_f32_16x16x32_bf16 v[100:103], v[20:23], a[48:51], v[100:103]
    ds_read_b64_tr_b16 v[64:65], v13 offset:10256
    ds_read_b64_tr_b16 v[66:67], v13 offset:12816
    v_mfma_f32_16x16x32_bf16 v[120:123], v[20:23], a[52:55], v[120:123]
    ds_read_b64_tr_b16 v[68:69], v13 offset:10264
    ds_read_b64_tr_b16 v[70:71], v13 offset:12824
    v_mfma_f32_16x16x32_bf16 v[104:107], v[24:27], a[48:51], v[104:107]
    ds_read_b64_tr_b16 v[72:73], v13 offset:10272
    ds_read_b64_tr_b16 v[74:75], v13 offset:12832
    v_mfma_f32_16x16x32_bf16 v[124:127], v[24:27], a[52:55], v[124:127]
    ds_read_b64_tr_b16 v[76:77], v11 offset:15360
    ds_read_b64_tr_b16 v[78:79], v11 offset:17920
    v_mfma_f32_16x16x32_bf16 v[108:111], v[28:31], a[48:51], v[108:111]
    ds_read_b64_tr_b16 v[80:81], v11 offset:15392
    ds_read_b64_tr_b16 v[82:83], v11 offset:17952
    v_mfma_f32_16x16x32_bf16 v[128:131], v[28:31], a[52:55], v[128:131]
    ds_read_b64_tr_b16 v[84:85], v11 offset:15424
    ds_read_b64_tr_b16 v[86:87], v11 offset:17984
    v_mfma_f32_16x16x32_bf16 v[112:115], v[32:35], a[48:51], v[112:115]
    ds_read_b64_tr_b16 v[88:89], v11 offset:15456
    ds_read_b64_tr_b16 v[90:91], v11 offset:18016
    v_mfma_f32_16x16x32_bf16 v[132:135], v[32:35], a[52:55], v[132:135]
    ds_read_b64_tr_b16 v[92:93], v11 offset:15488
    ds_read_b64_tr_b16 v[94:95], v11 offset:18048
    v_mfma_f32_16x16x32_bf16 v[136:139], a[48:51], v[36:39], v[136:139]
    v_mfma_f32_16x16x32_bf16 v[156:159], a[52:55], v[36:39], v[156:159]
    v_mfma_f32_16x16x32_bf16 v[140:143], a[48:51], v[40:43], v[140:143]
    v_mfma_f32_16x16x32_bf16 v[160:163], a[52:55], v[40:43], v[160:163]
    v_mfma_f32_16x16x32_bf16 v[144:147], a[48:51], v[44:47], v[144:147]
    v_mfma_f32_16x16x32_bf16 v[164:167], a[52:55], v[44:47], v[164:167]
    v_mfma_f32_16x16x32_bf16 v[148:151], a[48:51], v[48:51], v[148:151]
    v_mfma_f32_16x16x32_bf16 v[168:171], a[52:55], v[48:51], v[168:171]
    v_mfma_f32_16x16x32_bf16 v[152:155], a[48:51], v[52:55], v[152:155]
    v_mfma_f32_16x16x32_bf16 v[172:175], a[52:55], v[52:55], v[172:175]
    s_waitcnt lgkmcnt(0)
    s_waitcnt vmcnt(18)
    s_barrier
    s_add_u32 s28, s86, 7
    s_cmp_ge_u32 s28, 10
    s_cselect_b32 s101, 10, 0
    s_sub_u32 s28, s28, s101
    s_mul_i32 s28, s28, 245760
    s_add_u32 s28, s28, s24
    s_add_u32 m0, s26, 40960
    s_nop 0
    buffer_load_dwordx4 v5, s[8:11], s28 offen lds
    s_add_u32 m0, s26, 41984
    s_nop 0
    buffer_load_dwordx4 v6, s[8:11], s28 offen lds
    s_add_u32 m0, s26, 43008
    s_nop 0
    buffer_load_dwordx4 v7, s[8:11], s28 offen lds
    s_add_u32 m0, s26, 44032
    s_nop 0
    buffer_load_dwordx4 v8, s[8:11], s28 offen lds
    s_add_u32 m0, s26, 45056
    s_nop 0
    buffer_load_dwordx4 v9, s[8:11], s28 offen lds
    v_mfma_f32_16x16x32_bf16 v[96:99], v[56:59], a[56:59], v[96:99]
    ds_read_b128 a[64:67], v14 offset:4096
    ds_read_b128 a[68:71], v14 offset:6144
    v_mfma_f32_16x16x32_bf16 v[116:119], v[56:59], a[60:63], v[116:119]
    ds_read_b128 a[72:75], v15 offset:4096
    ds_read_b128 a[76:79], v15 offset:6144
    v_mfma_f32_16x16x32_bf16 v[100:103], v[60:63], a[56:59], v[100:103]
    ds_read_b64_tr_b16 v[16:17], v13 offset:20480
    ds_read_b64_tr_b16 v[18:19], v13 offset:23040
    v_mfma_f32_16x16x32_bf16 v[120:123], v[60:63], a[60:63], v[120:123]
    ds_read_b64_tr_b16 v[20:21], v13 offset:20488
    ds_read_b64_tr_b16 v[22:23], v13 offset:23048
    v_mfma_f32_16x16x32_bf16 v[104:107], v[64:67], a[56:59], v[104:107]
    ds_read_b64_tr_b16 v[24:25], v13 offset:20496
    ds_read_b64_tr_b16 v[26:27], v13 offset:23056
    v_mfma_f32_16x16x32_bf16 v[124:127], v[64:67], a[60:63], v[124:127]
    ds_read_b64_tr_b16 v[28:29], v13 offset:20504
    ds_read_b64_tr_b16 v[30:31], v13 offset:23064
    v_mfma_f32_16x16x32_bf16 v[108:111], v[68:71], a[56:59], v[108:111]
    ds_read_b64_tr_b16 v[32:33], v13 offset:20512
    ds_read_b64_tr_b16 v[34:35], v13 offset:23072
    v_mfma_f32_16x16x32_bf16 v[128:131], v[68:71], a[60:63], v[128:131]
    ds_read_b64_tr_b16 v[36:37], v11 offset:25600
    ds_read_b64_tr_b16 v[38:39], v11 offset:28160
    v_mfma_f32_16x16x32_bf16 v[112:115], v[72:75], a[56:59], v[112:115]
    ds_read_b64_tr_b16 v[40:41], v11 offset:25632
    ds_read_b64_tr_b16 v[42:43], v11 offset:28192
    v_mfma_f32_16x16x32_bf16 v[132:135], v[72:75], a[60:63], v[132:135]
    ds_read_b64_tr_b16 v[44:45], v11 offset:25664
    ds_read_b64_tr_b16 v[46:47], v11 offset:28224
    v_mfma_f32_16x16x32_bf16 v[136:139], a[56:59], v[76:79], v[136:139]
    ds_read_b64_tr_b16 v[48:49], v11 offset:25696
    ds_read_b64_tr_b16 v[50:51], v11 offset:28256
    v_mfma_f32_16x16x32_bf16 v[156:159], a[60:63], v[76:79], v[156:159]
    ds_read_b64_tr_b16 v[52:53], v11 offset:25728
    ds_read_b64_tr_b16 v[54:55], v11 offset:28288
    v_mfma_f32_16x16x32_bf16 v[140:143], a[56:59], v[80:83], v[140:143]
    v_mfma_f32_16x16x32_bf16 v[160:163], a[60:63], v[80:83], v[160:163]
    v_mfma_f32_16x16x32_bf16 v[144:147], a[56:59], v[84:87], v[144:147]
    v_mfma_f32_16x16x32_bf16 v[164:167], a[60:63], v[84:87], v[164:167]
    v_mfma_f32_16x16x32_bf16 v[148:151], a[56:59], v[88:91], v[148:151]
    v_mfma_f32_16x16x32_bf16 v[168:171], a[60:63], v[88:91], v[168:171]
    v_mfma_f32_16x16x32_bf16 v[152:155], a[56:59], v[92:95], v[152:155]
    v_mfma_f32_16x16x32_bf16 v[172:175], a[60:63], v[92:95], v[172:175]
    s_waitcnt lgkmcnt(0)
    s_add_u32 s29, s86, 7
    s_cmp_ge_u32 s29, 10
    s_cselect_b32 s101, 10, 0
    s_sub_u32 s29, s29, s101
    s_lshl_b32 s29, s29, 7
    s_add_u32 m0, s23, 4096
    s_add_u32 s28, s29, 0
    buffer_load_dwordx4 v4, s[4:7], s28 offen lds
    s_add_u32 m0, s23, 5120
    s_add_u32 s28, s29, 10240
    buffer_load_dwordx4 v1, s[4:7], s28 offen lds
    s_add_u32 m0, s23, 6144
    s_add_u32 s28, s29, 20480
    buffer_load_dwordx4 v4, s[4:7], s28 offen lds
    s_add_u32 m0, s23, 7168
    s_add_u32 s28, s29, 30720
    buffer_load_dwordx4 v1, s[4:7], s28 offen lds
    v_mfma_f32_16x16x32_bf16 v[96:99], v[16:19], a[64:67], v[96:99]
    ds_read_b64_tr_b16 v[56:57], v13 offset:30720
    ds_read_b64_tr_b16 v[58:59], v13 offset:33280
    v_mfma_f32_16x16x32_bf16 v[116:119], v[16:19], a[68:71], v[116:119]
    ds_read_b64_tr_b16 v[60:61], v13 offset:30728
    ds_read_b64_tr_b16 v[62:63], v13 offset:33288
    v_mfma_f32_16x16x32_bf16 v[100:103], v[20:23], a[64:67], v[100:103]
    ds_read_b64_tr_b16 v[64:65], v13 offset:30736
    ds_read_b64_tr_b16 v[66:67], v13 offset:33296
    v_mfma_f32_16x16x32_bf16 v[120:123], v[20:23], a[68:71], v[120:123]
    ds_read_b64_tr_b16 v[68:69], v13 offset:30744
    ds_read_b64_tr_b16 v[70:71], v13 offset:33304
    v_mfma_f32_16x16x32_bf16 v[104:107], v[24:27], a[64:67], v[104:107]
    ds_read_b64_tr_b16 v[72:73], v13 offset:30752
    ds_read_b64_tr_b16 v[74:75], v13 offset:33312
    v_mfma_f32_16x16x32_bf16 v[124:127], v[24:27], a[68:71], v[124:127]
    ds_read_b64_tr_b16 v[76:77], v11 offset:35840
    ds_read_b64_tr_b16 v[78:79], v11 offset:38400
    v_mfma_f32_16x16x32_bf16 v[108:111], v[28:31], a[64:67], v[108:111]
    ds_read_b64_tr_b16 v[80:81], v11 offset:35872
    ds_read_b64_tr_b16 v[82:83], v11 offset:38432
    v_mfma_f32_16x16x32_bf16 v[128:131], v[28:31], a[68:71], v[128:131]
    ds_read_b64_tr_b16 v[84:85], v11 offset:35904
    ds_read_b64_tr_b16 v[86:87], v11 offset:38464
    v_mfma_f32_16x16x32_bf16 v[112:115], v[32:35], a[64:67], v[112:115]
    ds_read_b64_tr_b16 v[88:89], v11 offset:35936
    ds_read_b64_tr_b16 v[90:91], v11 offset:38496
    v_mfma_f32_16x16x32_bf16 v[132:135], v[32:35], a[68:71], v[132:135]
    ds_read_b64_tr_b16 v[92:93], v11 offset:35968
    ds_read_b64_tr_b16 v[94:95], v11 offset:38528
    v_mfma_f32_16x16x32_bf16 v[136:139], a[64:67], v[36:39], v[136:139]
    v_mfma_f32_16x16x32_bf16 v[156:159], a[68:71], v[36:39], v[156:159]
    v_mfma_f32_16x16x32_bf16 v[140:143], a[64:67], v[40:43], v[140:143]
    v_mfma_f32_16x16x32_bf16 v[160:163], a[68:71], v[40:43], v[160:163]
    v_mfma_f32_16x16x32_bf16 v[144:147], a[64:67], v[44:47], v[144:147]
    v_mfma_f32_16x16x32_bf16 v[164:167], a[68:71], v[44:47], v[164:167]
    v_mfma_f32_16x16x32_bf16 v[148:151], a[64:67], v[48:51], v[148:151]
    v_mfma_f32_16x16x32_bf16 v[168:171], a[68:71], v[48:51], v[168:171]
    v_mfma_f32_16x16x32_bf16 v[152:155], a[64:67], v[52:55], v[152:155]
    v_mfma_f32_16x16x32_bf16 v[172:175], a[68:71], v[52:55], v[172:175]
    s_waitcnt lgkmcnt(0)
    s_waitcnt vmcnt(18)
    s_barrier
    s_add_u32 s28, s86, 8
    s_cmp_ge_u32 s28, 10
    s_cselect_b32 s101, 10, 0
    s_sub_u32 s28, s28, s101
    s_mul_i32 s28, s28, 245760
    s_add_u32 s28, s28, s24
    s_add_u32 m0, s26, 61440
    s_nop 0
    buffer_load_dwordx4 v5, s[8:11], s28 offen lds
    s_add_u32 m0, s26, 62464
    s_nop 0
    buffer_load_dwordx4 v6, s[8:11], s28 offen lds
    s_add_u32 m0, s26, 63488
    s_nop 0
    buffer_load_dwordx4 v7, s[8:11], s28 offen lds
    s_add_u32 m0, s26, 64512
    s_nop 0
    buffer_load_dwordx4 v8, s[8:11], s28 offen lds
    s_add_u32 m0, s26, 65536
    s_nop 0
    buffer_load_dwordx4 v9, s[8:11], s28 offen lds
    v_mfma_f32_16x16x32_bf16 v[96:99], v[56:59], a[72:75], v[96:99]
    ds_read_b128 a[80:83], v14 offset:8192
    ds_read_b128 a[84:87], v14 offset:10240
    v_mfma_f32_16x16x32_bf16 v[116:119], v[56:59], a[76:79], v[116:119]
    ds_read_b128 a[88:91], v15 offset:8192
    ds_read_b128 a[92:95], v15 offset:10240
    v_mfma_f32_16x16x32_bf16 v[100:103], v[60:63], a[72:75], v[100:103]
    ds_read_b64_tr_b16 v[16:17], v12 offset:0
    ds_read_b64_tr_b16 v[18:19], v12 offset:2560
    v_mfma_f32_16x16x32_bf16 v[120:123], v[60:63], a[76:79], v[120:123]
    ds_read_b64_tr_b16 v[20:21], v12 offset:8
    ds_read_b64_tr_b16 v[22:23], v12 offset:2568
    v_mfma_f32_16x16x32_bf16 v[104:107], v[64:67], a[72:75], v[104:107]
    ds_read_b64_tr_b16 v[24:25], v12 offset:16
    ds_read_b64_tr_b16 v[26:27], v12 offset:2576
    v_mfma_f32_16x16x32_bf16 v[124:127], v[64:67], a[76:79], v[124:127]
    ds_read_b64_tr_b16 v[28:29], v12 offset:24
    ds_read_b64_tr_b16 v[30:31], v12 offset:2584
    v_mfma_f32_16x16x32_bf16 v[108:111], v[68:71], a[72:75], v[108:111]
    ds_read_b64_tr_b16 v[32:33], v12 offset:32
    ds_read_b64_tr_b16 v[34:35], v12 offset:2592
    v_mfma_f32_16x16x32_bf16 v[128:131], v[68:71], a[76:79], v[128:131]
    ds_read_b64_tr_b16 v[36:37], v10 offset:5120
    ds_read_b64_tr_b16 v[38:39], v10 offset:7680
    v_mfma_f32_16x16x32_bf16 v[112:115], v[72:75], a[72:75], v[112:115]
    ds_read_b64_tr_b16 v[40:41], v10 offset:5152
    ds_read_b64_tr_b16 v[42:43], v10 offset:7712
    v_mfma_f32_16x16x32_bf16 v[132:135], v[72:75], a[76:79], v[132:135]
    ds_read_b64_tr_b16 v[44:45], v10 offset:5184
    ds_read_b64_tr_b16 v[46:47], v10 offset:7744
    v_mfma_f32_16x16x32_bf16 v[136:139], a[72:75], v[76:79], v[136:139]
    ds_read_b64_tr_b16 v[48:49], v10 offset:5216
    ds_read_b64_tr_b16 v[50:51], v10 offset:7776
    v_mfma_f32_16x16x32_bf16 v[156:159], a[76:79], v[76:79], v[156:159]
    ds_read_b64_tr_b16 v[52:53], v10 offset:5248
    ds_read_b64_tr_b16 v[54:55], v10 offset:7808
    v_mfma_f32_16x16x32_bf16 v[140:143], a[72:75], v[80:83], v[140:143]
    v_mfma_f32_16x16x32_bf16 v[160:163], a[76:79], v[80:83], v[160:163]
    v_mfma_f32_16x16x32_bf16 v[144:147], a[72:75], v[84:87], v[144:147]
    v_mfma_f32_16x16x32_bf16 v[164:167], a[76:79], v[84:87], v[164:167]
    v_mfma_f32_16x16x32_bf16 v[148:151], a[72:75], v[88:91], v[148:151]
    v_mfma_f32_16x16x32_bf16 v[168:171], a[76:79], v[88:91], v[168:171]
    v_mfma_f32_16x16x32_bf16 v[152:155], a[72:75], v[92:95], v[152:155]
    v_mfma_f32_16x16x32_bf16 v[172:175], a[76:79], v[92:95], v[172:175]
    s_waitcnt lgkmcnt(0)
    s_add_u32 s29, s86, 8
    s_cmp_ge_u32 s29, 10
    s_cselect_b32 s101, 10, 0
    s_sub_u32 s29, s29, s101
    s_lshl_b32 s29, s29, 7
    s_add_u32 m0, s23, 8192
    s_add_u32 s28, s29, 0
    buffer_load_dwordx4 v4, s[4:7], s28 offen lds
    s_add_u32 m0, s23, 9216
    s_add_u32 s28, s29, 10240
    buffer_load_dwordx4 v1, s[4:7], s28 offen lds
    s_add_u32 m0, s23, 10240
    s_add_u32 s28, s29, 20480
    buffer_load_dwordx4 v4, s[4:7], s28 offen lds
    s_add_u32 m0, s23, 11264
    s_add_u32 s28, s29, 30720
    buffer_load_dwordx4 v1, s[4:7], s28 offen lds
    v_mfma_f32_16x16x32_bf16 v[96:99], v[16:19], a[80:83], v[96:99]
    ds_read_b64_tr_b16 v[56:57], v12 offset:10240
    ds_read_b64_tr_b16 v[58:59], v12 offset:12800
    v_mfma_f32_16x16x32_bf16 v[116:119], v[16:19], a[84:87], v[116:119]
    ds_read_b64_tr_b16 v[60:61], v12 offset:10248
    ds_read_b64_tr_b16 v[62:63], v12 offset:12808
    v_mfma_f32_16x16x32_bf16 v[100:103], v[20:23], a[80:83], v[100:103]
    ds_read_b64_tr_b16 v[64:65], v12 offset:10256
    ds_read_b64_tr_b16 v[66:67], v12 offset:12816
    v_mfma_f32_16x16x32_bf16 v[120:123], v[20:23], a[84:87], v[120:123]
    ds_read_b64_tr_b16 v[68:69], v12 offset:10264
    ds_read_b64_tr_b16 v[70:71], v12 offset:12824
    v_mfma_f32_16x16x32_bf16 v[104:107], v[24:27], a[80:83], v[104:107]
    ds_read_b64_tr_b16 v[72:73], v12 offset:10272
    ds_read_b64_tr_b16 v[74:75], v12 offset:12832
    v_mfma_f32_16x16x32_bf16 v[124:127], v[24:27], a[84:87], v[124:127]
    ds_read_b64_tr_b16 v[76:77], v10 offset:15360
    ds_read_b64_tr_b16 v[78:79], v10 offset:17920
    v_mfma_f32_16x16x32_bf16 v[108:111], v[28:31], a[80:83], v[108:111]
    ds_read_b64_tr_b16 v[80:81], v10 offset:15392
    ds_read_b64_tr_b16 v[82:83], v10 offset:17952
    v_mfma_f32_16x16x32_bf16 v[128:131], v[28:31], a[84:87], v[128:131]
    ds_read_b64_tr_b16 v[84:85], v10 offset:15424
    ds_read_b64_tr_b16 v[86:87], v10 offset:17984
    v_mfma_f32_16x16x32_bf16 v[112:115], v[32:35], a[80:83], v[112:115]
    ds_read_b64_tr_b16 v[88:89], v10 offset:15456
    ds_read_b64_tr_b16 v[90:91], v10 offset:18016
    v_mfma_f32_16x16x32_bf16 v[132:135], v[32:35], a[84:87], v[132:135]
    ds_read_b64_tr_b16 v[92:93], v10 offset:15488
    ds_read_b64_tr_b16 v[94:95], v10 offset:18048
    v_mfma_f32_16x16x32_bf16 v[136:139], a[80:83], v[36:39], v[136:139]
    v_mfma_f32_16x16x32_bf16 v[156:159], a[84:87], v[36:39], v[156:159]
    v_mfma_f32_16x16x32_bf16 v[140:143], a[80:83], v[40:43], v[140:143]
    v_mfma_f32_16x16x32_bf16 v[160:163], a[84:87], v[40:43], v[160:163]
    v_mfma_f32_16x16x32_bf16 v[144:147], a[80:83], v[44:47], v[144:147]
    v_mfma_f32_16x16x32_bf16 v[164:167], a[84:87], v[44:47], v[164:167]
    v_mfma_f32_16x16x32_bf16 v[148:151], a[80:83], v[48:51], v[148:151]
    v_mfma_f32_16x16x32_bf16 v[168:171], a[84:87], v[48:51], v[168:171]
    v_mfma_f32_16x16x32_bf16 v[152:155], a[80:83], v[52:55], v[152:155]
    v_mfma_f32_16x16x32_bf16 v[172:175], a[84:87], v[52:55], v[172:175]
    s_waitcnt lgkmcnt(0)
    s_waitcnt vmcnt(18)
    s_barrier
    s_add_u32 s28, s86, 9
    s_cmp_ge_u32 s28, 10
    s_cselect_b32 s101, 10, 0
    s_sub_u32 s28, s28, s101
    s_mul_i32 s28, s28, 245760
    s_add_u32 s28, s28, s24
    s_add_u32 m0, s26, 81920
    s_nop 0
    buffer_load_dwordx4 v5, s[8:11], s28 offen lds
    s_add_u32 m0, s26, 82944
    s_nop 0
    buffer_load_dwordx4 v6, s[8:11], s28 offen lds
    s_add_u32 m0, s26, 83968
    s_nop 0
    buffer_load_dwordx4 v7, s[8:11], s28 offen lds
    s_add_u32 m0, s26, 84992
    s_nop 0
    buffer_load_dwordx4 v8, s[8:11], s28 offen lds
    s_add_u32 m0, s26, 86016
    s_nop 0
    buffer_load_dwordx4 v9, s[8:11], s28 offen lds
    v_mfma_f32_16x16x32_bf16 v[96:99], v[56:59], a[88:91], v[96:99]
    ds_read_b128 a[96:99], v14 offset:0
    ds_read_b128 a[100:103], v14 offset:2048
    v_mfma_f32_16x16x32_bf16 v[116:119], v[56:59], a[92:95], v[116:119]
    ds_read_b128 a[104:107], v15 offset:0
    ds_read_b128 a[108:111], v15 offset:2048
    v_mfma_f32_16x16x32_bf16 v[100:103], v[60:63], a[88:91], v[100:103]
    ds_read_b64_tr_b16 v[16:17], v12 offset:20480
    ds_read_b64_tr_b16 v[18:19], v12 offset:23040
    v_mfma_f32_16x16x32_bf16 v[120:123], v[60:63], a[92:95], v[120:123]
    ds_read_b64_tr_b16 v[20:21], v12 offset:20488
    ds_read_b64_tr_b16 v[22:23], v12 offset:23048
    v_mfma_f32_16x16x32_bf16 v[104:107], v[64:67], a[88:91], v[104:107]
    ds_read_b64_tr_b16 v[24:25], v12 offset:20496
    ds_read_b64_tr_b16 v[26:27], v12 offset:23056
    v_mfma_f32_16x16x32_bf16 v[124:127], v[64:67], a[92:95], v[124:127]
    ds_read_b64_tr_b16 v[28:29], v12 offset:20504
    ds_read_b64_tr_b16 v[30:31], v12 offset:23064
    v_mfma_f32_16x16x32_bf16 v[108:111], v[68:71], a[88:91], v[108:111]
    ds_read_b64_tr_b16 v[32:33], v12 offset:20512
    ds_read_b64_tr_b16 v[34:35], v12 offset:23072
    v_mfma_f32_16x16x32_bf16 v[128:131], v[68:71], a[92:95], v[128:131]
    ds_read_b64_tr_b16 v[36:37], v10 offset:25600
    ds_read_b64_tr_b16 v[38:39], v10 offset:28160
    v_mfma_f32_16x16x32_bf16 v[112:115], v[72:75], a[88:91], v[112:115]
    ds_read_b64_tr_b16 v[40:41], v10 offset:25632
    ds_read_b64_tr_b16 v[42:43], v10 offset:28192
    v_mfma_f32_16x16x32_bf16 v[132:135], v[72:75], a[92:95], v[132:135]
    ds_read_b64_tr_b16 v[44:45], v10 offset:25664
    ds_read_b64_tr_b16 v[46:47], v10 offset:28224
    v_mfma_f32_16x16x32_bf16 v[136:139], a[88:91], v[76:79], v[136:139]
    ds_read_b64_tr_b16 v[48:49], v10 offset:25696
    ds_read_b64_tr_b16 v[50:51], v10 offset:28256
    v_mfma_f32_16x16x32_bf16 v[156:159], a[92:95], v[76:79], v[156:159]
    ds_read_b64_tr_b16 v[52:53], v10 offset:25728
    ds_read_b64_tr_b16 v[54:55], v10 offset:28288
    v_mfma_f32_16x16x32_bf16 v[140:143], a[88:91], v[80:83], v[140:143]
    v_mfma_f32_16x16x32_bf16 v[160:163], a[92:95], v[80:83], v[160:163]
    v_mfma_f32_16x16x32_bf16 v[144:147], a[88:91], v[84:87], v[144:147]
    v_mfma_f32_16x16x32_bf16 v[164:167], a[92:95], v[84:87], v[164:167]
    v_mfma_f32_16x16x32_bf16 v[148:151], a[88:91], v[88:91], v[148:151]
    v_mfma_f32_16x16x32_bf16 v[168:171], a[92:95], v[88:91], v[168:171]
    v_mfma_f32_16x16x32_bf16 v[152:155], a[88:91], v[92:95], v[152:155]
    v_mfma_f32_16x16x32_bf16 v[172:175], a[92:95], v[92:95], v[172:175]
    s_waitcnt lgkmcnt(0)
    s_add_u32 s29, s86, 9
    s_cmp_ge_u32 s29, 10
    s_cselect_b32 s101, 10, 0
    s_sub_u32 s29, s29, s101
    s_lshl_b32 s29, s29, 7
    s_add_u32 m0, s23, 0
    s_add_u32 s28, s29, 0
    buffer_load_dwordx4 v4, s[4:7], s28 offen lds
    s_add_u32 m0, s23, 1024
    s_add_u32 s28, s29, 10240
    buffer_load_dwordx4 v1, s[4:7], s28 offen lds
    s_add_u32 m0, s23, 2048
    s_add_u32 s28, s29, 20480
    buffer_load_dwordx4 v4, s[4:7], s28 offen lds
    s_add_u32 m0, s23, 3072
    s_add_u32 s28, s29, 30720
    buffer_load_dwordx4 v1, s[4:7], s28 offen lds
    v_mfma_f32_16x16x32_bf16 v[96:99], v[16:19], a[96:99], v[96:99]
    ds_read_b64_tr_b16 v[56:57], v12 offset:30720
    ds_read_b64_tr_b16 v[58:59], v12 offset:33280
    v_mfma_f32_16x16x32_bf16 v[116:119], v[16:19], a[100:103], v[116:119]
    ds_read_b64_tr_b16 v[60:61], v12 offset:30728
    ds_read_b64_tr_b16 v[62:63], v12 offset:33288
    v_mfma_f32_16x16x32_bf16 v[100:103], v[20:23], a[96:99], v[100:103]
    ds_read_b64_tr_b16 v[64:65], v12 offset:30736
    ds_read_b64_tr_b16 v[66:67], v12 offset:33296
    v_mfma_f32_16x16x32_bf16 v[120:123], v[20:23], a[100:103], v[120:123]
    ds_read_b64_tr_b16 v[68:69], v12 offset:30744
    ds_read_b64_tr_b16 v[70:71], v12 offset:33304
    v_mfma_f32_16x16x32_bf16 v[104:107], v[24:27], a[96:99], v[104:107]
    ds_read_b64_tr_b16 v[72:73], v12 offset:30752
    ds_read_b64_tr_b16 v[74:75], v12 offset:33312
    v_mfma_f32_16x16x32_bf16 v[124:127], v[24:27], a[100:103], v[124:127]
    ds_read_b64_tr_b16 v[76:77], v10 offset:35840
    ds_read_b64_tr_b16 v[78:79], v10 offset:38400
    v_mfma_f32_16x16x32_bf16 v[108:111], v[28:31], a[96:99], v[108:111]
    ds_read_b64_tr_b16 v[80:81], v10 offset:35872
    ds_read_b64_tr_b16 v[82:83], v10 offset:38432
    v_mfma_f32_16x16x32_bf16 v[128:131], v[28:31], a[100:103], v[128:131]
    ds_read_b64_tr_b16 v[84:85], v10 offset:35904
    ds_read_b64_tr_b16 v[86:87], v10 offset:38464
    v_mfma_f32_16x16x32_bf16 v[112:115], v[32:35], a[96:99], v[112:115]
    ds_read_b64_tr_b16 v[88:89], v10 offset:35936
    ds_read_b64_tr_b16 v[90:91], v10 offset:38496
    v_mfma_f32_16x16x32_bf16 v[132:135], v[32:35], a[100:103], v[132:135]
    ds_read_b64_tr_b16 v[92:93], v10 offset:35968
    ds_read_b64_tr_b16 v[94:95], v10 offset:38528
    v_mfma_f32_16x16x32_bf16 v[136:139], a[96:99], v[36:39], v[136:139]
    v_mfma_f32_16x16x32_bf16 v[156:159], a[100:103], v[36:39], v[156:159]
    v_mfma_f32_16x16x32_bf16 v[140:143], a[96:99], v[40:43], v[140:143]
    v_mfma_f32_16x16x32_bf16 v[160:163], a[100:103], v[40:43], v[160:163]
    v_mfma_f32_16x16x32_bf16 v[144:147], a[96:99], v[44:47], v[144:147]
    v_mfma_f32_16x16x32_bf16 v[164:167], a[100:103], v[44:47], v[164:167]
    v_mfma_f32_16x16x32_bf16 v[148:151], a[96:99], v[48:51], v[148:151]
    v_mfma_f32_16x16x32_bf16 v[168:171], a[100:103], v[48:51], v[168:171]
    v_mfma_f32_16x16x32_bf16 v[152:155], a[96:99], v[52:55], v[152:155]
    v_mfma_f32_16x16x32_bf16 v[172:175], a[100:103], v[52:55], v[172:175]
    s_waitcnt lgkmcnt(0)
    s_waitcnt vmcnt(18)
    s_barrier
    s_add_u32 s28, s87, 0
    s_cmp_ge_u32 s28, 20
    s_cselect_b32 s101, 20, 0
    s_sub_u32 s28, s28, s101
    s_mul_i32 s28, s28, 122880
    s_add_u32 s28, s28, s25
    s_add_u32 m0, s26, 0
    s_nop 0
    buffer_load_dwordx4 v5, s[8:11], s28 offen lds
    s_add_u32 m0, s26, 1024
    s_nop 0
    buffer_load_dwordx4 v6, s[8:11], s28 offen lds
    s_add_u32 m0, s26, 2048
    s_nop 0
    buffer_load_dwordx4 v7, s[8:11], s28 offen lds
    s_add_u32 m0, s26, 3072
    s_nop 0
    buffer_load_dwordx4 v8, s[8:11], s28 offen lds
    s_add_u32 m0, s26, 4096
    s_nop 0
    buffer_load_dwordx4 v9, s[8:11], s28 offen lds
    v_mfma_f32_16x16x32_bf16 v[96:99], v[56:59], a[104:107], v[96:99]
    ds_read_b128 a[112:115], v14 offset:4096
    ds_read_b128 a[116:119], v14 offset:6144
    v_mfma_f32_16x16x32_bf16 v[116:119], v[56:59], a[108:111], v[116:119]
    ds_read_b128 a[120:123], v15 offset:4096
    ds_read_b128 a[124:127], v15 offset:6144
    v_mfma_f32_16x16x32_bf16 v[100:103], v[60:63], a[104:107], v[100:103]
    ds_read_b64_tr_b16 v[16:17], v12 offset:40960
    ds_read_b64_tr_b16 v[18:19], v12 offset:43520
    v_mfma_f32_16x16x32_bf16 v[120:123], v[60:63], a[108:111], v[120:123]
    ds_read_b64_tr_b16 v[20:21], v12 offset:40968
    ds_read_b64_tr_b16 v[22:23], v12 offset:43528
    v_mfma_f32_16x16x32_bf16 v[104:107], v[64:67], a[104:107], v[104:107]
    ds_read_b64_tr_b16 v[24:25], v12 offset:40976
    ds_read_b64_tr_b16 v[26:27], v12 offset:43536
    v_mfma_f32_16x16x32_bf16 v[124:127], v[64:67], a[108:111], v[124:127]
    ds_read_b64_tr_b16 v[28:29], v12 offset:40984
    ds_read_b64_tr_b16 v[30:31], v12 offset:43544
    v_mfma_f32_16x16x32_bf16 v[108:111], v[68:71], a[104:107], v[108:111]
    ds_read_b64_tr_b16 v[32:33], v12 offset:40992
    ds_read_b64_tr_b16 v[34:35], v12 offset:43552
    v_mfma_f32_16x16x32_bf16 v[128:131], v[68:71], a[108:111], v[128:131]
    ds_read_b64_tr_b16 v[36:37], v10 offset:46080
    ds_read_b64_tr_b16 v[38:39], v10 offset:48640
    v_mfma_f32_16x16x32_bf16 v[112:115], v[72:75], a[104:107], v[112:115]
    ds_read_b64_tr_b16 v[40:41], v10 offset:46112
    ds_read_b64_tr_b16 v[42:43], v10 offset:48672
    v_mfma_f32_16x16x32_bf16 v[132:135], v[72:75], a[108:111], v[132:135]
    ds_read_b64_tr_b16 v[44:45], v10 offset:46144
    ds_read_b64_tr_b16 v[46:47], v10 offset:48704
    v_mfma_f32_16x16x32_bf16 v[136:139], a[104:107], v[76:79], v[136:139]
    ds_read_b64_tr_b16 v[48:49], v10 offset:46176
    ds_read_b64_tr_b16 v[50:51], v10 offset:48736
    v_mfma_f32_16x16x32_bf16 v[156:159], a[108:111], v[76:79], v[156:159]
    ds_read_b64_tr_b16 v[52:53], v10 offset:46208
    ds_read_b64_tr_b16 v[54:55], v10 offset:48768
    v_mfma_f32_16x16x32_bf16 v[140:143], a[104:107], v[80:83], v[140:143]
    v_mfma_f32_16x16x32_bf16 v[160:163], a[108:111], v[80:83], v[160:163]
    v_mfma_f32_16x16x32_bf16 v[144:147], a[104:107], v[84:87], v[144:147]
    v_mfma_f32_16x16x32_bf16 v[164:167], a[108:111], v[84:87], v[164:167]
    v_mfma_f32_16x16x32_bf16 v[148:151], a[104:107], v[88:91], v[148:151]
    v_mfma_f32_16x16x32_bf16 v[168:171], a[108:111], v[88:91], v[168:171]
    v_mfma_f32_16x16x32_bf16 v[152:155], a[104:107], v[92:95], v[152:155]
    v_mfma_f32_16x16x32_bf16 v[172:175], a[108:111], v[92:95], v[172:175]
    s_waitcnt lgkmcnt(0)
    v_mfma_f32_16x16x32_bf16 v[96:99], v[16:19], a[112:115], v[96:99]
    ds_read_b64_tr_b16 v[56:57], v12 offset:51200
    ds_read_b64_tr_b16 v[58:59], v12 offset:53760
    v_mfma_f32_16x16x32_bf16 v[116:119], v[16:19], a[116:119], v[116:119]
    ds_read_b64_tr_b16 v[60:61], v12 offset:51208
    ds_read_b64_tr_b16 v[62:63], v12 offset:53768
    v_mfma_f32_16x16x32_bf16 v[100:103], v[20:23], a[112:115], v[100:103]
    ds_read_b64_tr_b16 v[64:65], v12 offset:51216
    ds_read_b64_tr_b16 v[66:67], v12 offset:53776
    v_mfma_f32_16x16x32_bf16 v[120:123], v[20:23], a[116:119], v[120:123]
    ds_read_b64_tr_b16 v[68:69], v12 offset:51224
    ds_read_b64_tr_b16 v[70:71], v12 offset:53784
    v_mfma_f32_16x16x32_bf16 v[104:107], v[24:27], a[112:115], v[104:107]
    ds_read_b64_tr_b16 v[72:73], v12 offset:51232
    ds_read_b64_tr_b16 v[74:75], v12 offset:53792
    v_mfma_f32_16x16x32_bf16 v[124:127], v[24:27], a[116:119], v[124:127]
    ds_read_b64_tr_b16 v[76:77], v10 offset:56320
    ds_read_b64_tr_b16 v[78:79], v10 offset:58880
    v_mfma_f32_16x16x32_bf16 v[108:111], v[28:31], a[112:115], v[108:111]
    ds_read_b64_tr_b16 v[80:81], v10 offset:56352
    ds_read_b64_tr_b16 v[82:83], v10 offset:58912
    v_mfma_f32_16x16x32_bf16 v[128:131], v[28:31], a[116:119], v[128:131]
    ds_read_b64_tr_b16 v[84:85], v10 offset:56384
    ds_read_b64_tr_b16 v[86:87], v10 offset:58944
    v_mfma_f32_16x16x32_bf16 v[112:115], v[32:35], a[112:115], v[112:115]
    ds_read_b64_tr_b16 v[88:89], v10 offset:56416
    ds_read_b64_tr_b16 v[90:91], v10 offset:58976
    v_mfma_f32_16x16x32_bf16 v[132:135], v[32:35], a[116:119], v[132:135]
    ds_read_b64_tr_b16 v[92:93], v10 offset:56448
    ds_read_b64_tr_b16 v[94:95], v10 offset:59008
    v_mfma_f32_16x16x32_bf16 v[136:139], a[112:115], v[36:39], v[136:139]
    v_mfma_f32_16x16x32_bf16 v[156:159], a[116:119], v[36:39], v[156:159]
    v_mfma_f32_16x16x32_bf16 v[140:143], a[112:115], v[40:43], v[140:143]
    v_mfma_f32_16x16x32_bf16 v[160:163], a[116:119], v[40:43], v[160:163]
    v_mfma_f32_16x16x32_bf16 v[144:147], a[112:115], v[44:47], v[144:147]
    v_mfma_f32_16x16x32_bf16 v[164:167], a[116:119], v[44:47], v[164:167]
    v_mfma_f32_16x16x32_bf16 v[148:151], a[112:115], v[48:51], v[148:151]
    v_mfma_f32_16x16x32_bf16 v[168:171], a[116:119], v[48:51], v[168:171]
    v_mfma_f32_16x16x32_bf16 v[152:155], a[112:115], v[52:55], v[152:155]
    v_mfma_f32_16x16x32_bf16 v[172:175], a[116:119], v[52:55], v[172:175]
    s_waitcnt lgkmcnt(0)
    s_waitcnt vmcnt(14)
    s_barrier
    s_add_u32 s28, s87, 4
    s_cmp_ge_u32 s28, 20
    s_cselect_b32 s101, 20, 0
    s_sub_u32 s28, s28, s101
    s_mul_i32 s28, s28, 122880
    s_add_u32 s28, s28, s25
    s_add_u32 m0, s26, 20480
    s_nop 0
    buffer_load_dwordx4 v5, s[8:11], s28 offen lds
    s_add_u32 m0, s26, 21504
    s_nop 0
    buffer_load_dwordx4 v6, s[8:11], s28 offen lds
    s_add_u32 m0, s26, 22528
    s_nop 0
    buffer_load_dwordx4 v7, s[8:11], s28 offen lds
    s_add_u32 m0, s26, 23552
    s_nop 0
    buffer_load_dwordx4 v8, s[8:11], s28 offen lds
    s_add_u32 m0, s26, 24576
    s_nop 0
    buffer_load_dwordx4 v9, s[8:11], s28 offen lds
    v_mfma_f32_16x16x32_bf16 v[96:99], v[56:59], a[120:123], v[96:99]
    ds_read_b128 a[128:131], v14 offset:8192
    ds_read_b128 a[132:135], v14 offset:10240
    v_mfma_f32_16x16x32_bf16 v[116:119], v[56:59], a[124:127], v[116:119]
    ds_read_b128 a[136:139], v15 offset:8192
    ds_read_b128 a[140:143], v15 offset:10240
    v_mfma_f32_16x16x32_bf16 v[100:103], v[60:63], a[120:123], v[100:103]
    ds_read_b64_tr_b16 v[16:17], v13 offset:0
    ds_read_b64_tr_b16 v[18:19], v13 offset:2560
    v_mfma_f32_16x16x32_bf16 v[120:123], v[60:63], a[124:127], v[120:123]
    ds_read_b64_tr_b16 v[20:21], v13 offset:8
    ds_read_b64_tr_b16 v[22:23], v13 offset:2568
    v_mfma_f32_16x16x32_bf16 v[104:107], v[64:67], a[120:123], v[104:107]
    ds_read_b64_tr_b16 v[24:25], v13 offset:16
    ds_read_b64_tr_b16 v[26:27], v13 offset:2576
    v_mfma_f32_16x16x32_bf16 v[124:127], v[64:67], a[124:127], v[124:127]
    ds_read_b64_tr_b16 v[28:29], v13 offset:24
    ds_read_b64_tr_b16 v[30:31], v13 offset:2584
    v_mfma_f32_16x16x32_bf16 v[108:111], v[68:71], a[120:123], v[108:111]
    ds_read_b64_tr_b16 v[32:33], v13 offset:32
    ds_read_b64_tr_b16 v[34:35], v13 offset:2592
    v_mfma_f32_16x16x32_bf16 v[128:131], v[68:71], a[124:127], v[128:131]
    ds_read_b64_tr_b16 v[36:37], v11 offset:5120
    ds_read_b64_tr_b16 v[38:39], v11 offset:7680
    v_mfma_f32_16x16x32_bf16 v[112:115], v[72:75], a[120:123], v[112:115]
    ds_read_b64_tr_b16 v[40:41], v11 offset:5152
    ds_read_b64_tr_b16 v[42:43], v11 offset:7712
    v_mfma_f32_16x16x32_bf16 v[132:135], v[72:75], a[124:127], v[132:135]
    ds_read_b64_tr_b16 v[44:45], v11 offset:5184
    ds_read_b64_tr_b16 v[46:47], v11 offset:7744
    v_mfma_f32_16x16x32_bf16 v[136:139], a[120:123], v[76:79], v[136:139]
    ds_read_b64_tr_b16 v[48:49], v11 offset:5216
    ds_read_b64_tr_b16 v[50:51], v11 offset:7776
    v_mfma_f32_16x16x32_bf16 v[156:159], a[124:127], v[76:79], v[156:159]
    ds_read_b64_tr_b16 v[52:53], v11 offset:5248
    ds_read_b64_tr_b16 v[54:55], v11 offset:7808
    v_mfma_f32_16x16x32_bf16 v[140:143], a[120:123], v[80:83], v[140:143]
    v_mfma_f32_16x16x32_bf16 v[160:163], a[124:127], v[80:83], v[160:163]
    v_mfma_f32_16x16x32_bf16 v[144:147], a[120:123], v[84:87], v[144:147]
    v_mfma_f32_16x16x32_bf16 v[164:167], a[124:127], v[84:87], v[164:167]
    v_mfma_f32_16x16x32_bf16 v[148:151], a[120:123], v[88:91], v[148:151]
    v_mfma_f32_16x16x32_bf16 v[168:171], a[124:127], v[88:91], v[168:171]
    v_mfma_f32_16x16x32_bf16 v[152:155], a[120:123], v[92:95], v[152:155]
    v_mfma_f32_16x16x32_bf16 v[172:175], a[124:127], v[92:95], v[172:175]
    s_waitcnt lgkmcnt(0)
    v_mfma_f32_16x16x32_bf16 v[96:99], v[16:19], a[128:131], v[96:99]
    ds_read_b64_tr_b16 v[56:57], v13 offset:10240
    ds_read_b64_tr_b16 v[58:59], v13 offset:12800
    v_mfma_f32_16x16x32_bf16 v[116:119], v[16:19], a[132:135], v[116:119]
    ds_read_b64_tr_b16 v[60:61], v13 offset:10248
    ds_read_b64_tr_b16 v[62:63], v13 offset:12808
    v_mfma_f32_16x16x32_bf16 v[100:103], v[20:23], a[128:131], v[100:103]
    ds_read_b64_tr_b16 v[64:65], v13 offset:10256
    ds_read_b64_tr_b16 v[66:67], v13 offset:12816
    v_mfma_f32_16x16x32_bf16 v[120:123], v[20:23], a[132:135], v[120:123]
    ds_read_b64_tr_b16 v[68:69], v13 offset:10264
    ds_read_b64_tr_b16 v[70:71], v13 offset:12824
    v_mfma_f32_16x16x32_bf16 v[104:107], v[24:27], a[128:131], v[104:107]
    ds_read_b64_tr_b16 v[72:73], v13 offset:10272
    ds_read_b64_tr_b16 v[74:75], v13 offset:12832
    v_mfma_f32_16x16x32_bf16 v[124:127], v[24:27], a[132:135], v[124:127]
    ds_read_b64_tr_b16 v[76:77], v11 offset:15360
    ds_read_b64_tr_b16 v[78:79], v11 offset:17920
    v_mfma_f32_16x16x32_bf16 v[108:111], v[28:31], a[128:131], v[108:111]
    ds_read_b64_tr_b16 v[80:81], v11 offset:15392
    ds_read_b64_tr_b16 v[82:83], v11 offset:17952
    v_mfma_f32_16x16x32_bf16 v[128:131], v[28:31], a[132:135], v[128:131]
    ds_read_b64_tr_b16 v[84:85], v11 offset:15424
    ds_read_b64_tr_b16 v[86:87], v11 offset:17984
    v_mfma_f32_16x16x32_bf16 v[112:115], v[32:35], a[128:131], v[112:115]
    ds_read_b64_tr_b16 v[88:89], v11 offset:15456
    ds_read_b64_tr_b16 v[90:91], v11 offset:18016
    v_mfma_f32_16x16x32_bf16 v[132:135], v[32:35], a[132:135], v[132:135]
    ds_read_b64_tr_b16 v[92:93], v11 offset:15488
    ds_read_b64_tr_b16 v[94:95], v11 offset:18048
    v_mfma_f32_16x16x32_bf16 v[136:139], a[128:131], v[36:39], v[136:139]
    v_mfma_f32_16x16x32_bf16 v[156:159], a[132:135], v[36:39], v[156:159]
    v_mfma_f32_16x16x32_bf16 v[140:143], a[128:131], v[40:43], v[140:143]
    v_mfma_f32_16x16x32_bf16 v[160:163], a[132:135], v[40:43], v[160:163]
    v_mfma_f32_16x16x32_bf16 v[144:147], a[128:131], v[44:47], v[144:147]
    v_mfma_f32_16x16x32_bf16 v[164:167], a[132:135], v[44:47], v[164:167]
    v_mfma_f32_16x16x32_bf16 v[148:151], a[128:131], v[48:51], v[148:151]
    v_mfma_f32_16x16x32_bf16 v[168:171], a[132:135], v[48:51], v[168:171]
    v_mfma_f32_16x16x32_bf16 v[152:155], a[128:131], v[52:55], v[152:155]
    v_mfma_f32_16x16x32_bf16 v[172:175], a[132:135], v[52:55], v[172:175]
    s_waitcnt lgkmcnt(0)
    s_waitcnt vmcnt(10)
    s_barrier
    s_add_u32 s28, s87, 8
    s_cmp_ge_u32 s28, 20
    s_cselect_b32 s101, 20, 0
    s_sub_u32 s28, s28, s101
    s_mul_i32 s28, s28, 122880
    s_add_u32 s28, s28, s25
    s_add_u32 m0, s26, 40960
    s_nop 0
    buffer_load_dwordx4 v5, s[8:11], s28 offen lds
    s_add_u32 m0, s26, 41984
    s_nop 0
    buffer_load_dwordx4 v6, s[8:11], s28 offen lds
    s_add_u32 m0, s26, 43008
    s_nop 0
    buffer_load_dwordx4 v7, s[8:11], s28 offen lds
    s_add_u32 m0, s26, 44032
    s_nop 0
    buffer_load_dwordx4 v8, s[8:11], s28 offen lds
    s_add_u32 m0, s26, 45056
    s_nop 0
    buffer_load_dwordx4 v9, s[8:11], s28 offen lds
    v_mfma_f32_16x16x32_bf16 v[96:99], v[56:59], a[136:139], v[96:99]
    ds_read_b128 a[144:147], v14 offset:0
    ds_read_b128 a[148:151], v14 offset:2048
    v_mfma_f32_16x16x32_bf16 v[116:119], v[56:59], a[140:143], v[116:119]
    ds_read_b128 a[152:155], v15 offset:0
    ds_read_b128 a[156:159], v15 offset:2048
    v_mfma_f32_16x16x32_bf16 v[100:103], v[60:63], a[136:139], v[100:103]
    ds_read_b64_tr_b16 v[16:17], v13 offset:20480
    ds_read_b64_tr_b16 v[18:19], v13 offset:23040
    v_mfma_f32_16x16x32_bf16 v[120:123], v[60:63], a[140:143], v[120:123]
    ds_read_b64_tr_b16 v[20:21], v13 offset:20488
    ds_read_b64_tr_b16 v[22:23], v13 offset:23048
    v_mfma_f32_16x16x32_bf16 v[104:107], v[64:67], a[136:139], v[104:107]
    ds_read_b64_tr_b16 v[24:25], v13 offset:20496
    ds_read_b64_tr_b16 v[26:27], v13 offset:23056
    v_mfma_f32_16x16x32_bf16 v[124:127], v[64:67], a[140:143], v[124:127]
    ds_read_b64_tr_b16 v[28:29], v13 offset:20504
    ds_read_b64_tr_b16 v[30:31], v13 offset:23064
    v_mfma_f32_16x16x32_bf16 v[108:111], v[68:71], a[136:139], v[108:111]
    ds_read_b64_tr_b16 v[32:33], v13 offset:20512
    ds_read_b64_tr_b16 v[34:35], v13 offset:23072
    v_mfma_f32_16x16x32_bf16 v[128:131], v[68:71], a[140:143], v[128:131]
    ds_read_b64_tr_b16 v[36:37], v11 offset:25600
    ds_read_b64_tr_b16 v[38:39], v11 offset:28160
    v_mfma_f32_16x16x32_bf16 v[112:115], v[72:75], a[136:139], v[112:115]
    ds_read_b64_tr_b16 v[40:41], v11 offset:25632
    ds_read_b64_tr_b16 v[42:43], v11 offset:28192
    v_mfma_f32_16x16x32_bf16 v[132:135], v[72:75], a[140:143], v[132:135]
    ds_read_b64_tr_b16 v[44:45], v11 offset:25664
    ds_read_b64_tr_b16 v[46:47], v11 offset:28224
    v_mfma_f32_16x16x32_bf16 v[136:139], a[136:139], v[76:79], v[136:139]
    ds_read_b64_tr_b16 v[48:49], v11 offset:25696
    ds_read_b64_tr_b16 v[50:51], v11 offset:28256
    v_mfma_f32_16x16x32_bf16 v[156:159], a[140:143], v[76:79], v[156:159]
    ds_read_b64_tr_b16 v[52:53], v11 offset:25728
    ds_read_b64_tr_b16 v[54:55], v11 offset:28288
    v_mfma_f32_16x16x32_bf16 v[140:143], a[136:139], v[80:83], v[140:143]
    v_mfma_f32_16x16x32_bf16 v[160:163], a[140:143], v[80:83], v[160:163]
    v_mfma_f32_16x16x32_bf16 v[144:147], a[136:139], v[84:87], v[144:147]
    v_mfma_f32_16x16x32_bf16 v[164:167], a[140:143], v[84:87], v[164:167]
    v_mfma_f32_16x16x32_bf16 v[148:151], a[136:139], v[88:91], v[148:151]
    v_mfma_f32_16x16x32_bf16 v[168:171], a[140:143], v[88:91], v[168:171]
    v_mfma_f32_16x16x32_bf16 v[152:155], a[136:139], v[92:95], v[152:155]
    v_mfma_f32_16x16x32_bf16 v[172:175], a[140:143], v[92:95], v[172:175]
    s_waitcnt lgkmcnt(0)
    v_mfma_f32_16x16x32_bf16 v[96:99], v[16:19], a[144:147], v[96:99]
    ds_read_b64_tr_b16 v[56:57], v13 offset:30720
    ds_read_b64_tr_b16 v[58:59], v13 offset:33280
    v_mfma_f32_16x16x32_bf16 v[116:119], v[16:19], a[148:151], v[116:119]
    ds_read_b64_tr_b16 v[60:61], v13 offset:30728
    ds_read_b64_tr_b16 v[62:63], v13 offset:33288
    v_mfma_f32_16x16x32_bf16 v[100:103], v[20:23], a[144:147], v[100:103]
    ds_read_b64_tr_b16 v[64:65], v13 offset:30736
    ds_read_b64_tr_b16 v[66:67], v13 offset:33296
    v_mfma_f32_16x16x32_bf16 v[120:123], v[20:23], a[148:151], v[120:123]
    ds_read_b64_tr_b16 v[68:69], v13 offset:30744
    ds_read_b64_tr_b16 v[70:71], v13 offset:33304
    v_mfma_f32_16x16x32_bf16 v[104:107], v[24:27], a[144:147], v[104:107]
    ds_read_b64_tr_b16 v[72:73], v13 offset:30752
    ds_read_b64_tr_b16 v[74:75], v13 offset:33312
    v_mfma_f32_16x16x32_bf16 v[124:127], v[24:27], a[148:151], v[124:127]
    ds_read_b64_tr_b16 v[76:77], v11 offset:35840
    ds_read_b64_tr_b16 v[78:79], v11 offset:38400
    v_mfma_f32_16x16x32_bf16 v[108:111], v[28:31], a[144:147], v[108:111]
    ds_read_b64_tr_b16 v[80:81], v11 offset:35872
    ds_read_b64_tr_b16 v[82:83], v11 offset:38432
    v_mfma_f32_16x16x32_bf16 v[128:131], v[28:31], a[148:151], v[128:131]
    ds_read_b64_tr_b16 v[84:85], v11 offset:35904
    ds_read_b64_tr_b16 v[86:87], v11 offset:38464
    v_mfma_f32_16x16x32_bf16 v[112:115], v[32:35], a[144:147], v[112:115]
    ds_read_b64_tr_b16 v[88:89], v11 offset:35936
    ds_read_b64_tr_b16 v[90:91], v11 offset:38496
    v_mfma_f32_16x16x32_bf16 v[132:135], v[32:35], a[148:151], v[132:135]
    ds_read_b64_tr_b16 v[92:93], v11 offset:35968
    ds_read_b64_tr_b16 v[94:95], v11 offset:38528
    v_mfma_f32_16x16x32_bf16 v[136:139], a[144:147], v[36:39], v[136:139]
    v_mfma_f32_16x16x32_bf16 v[156:159], a[148:151], v[36:39], v[156:159]
    v_mfma_f32_16x16x32_bf16 v[140:143], a[144:147], v[40:43], v[140:143]
    v_mfma_f32_16x16x32_bf16 v[160:163], a[148:151], v[40:43], v[160:163]
    v_mfma_f32_16x16x32_bf16 v[144:147], a[144:147], v[44:47], v[144:147]
    v_mfma_f32_16x16x32_bf16 v[164:167], a[148:151], v[44:47], v[164:167]
    v_mfma_f32_16x16x32_bf16 v[148:151], a[144:147], v[48:51], v[148:151]
    v_mfma_f32_16x16x32_bf16 v[168:171], a[148:151], v[48:51], v[168:171]
    v_mfma_f32_16x16x32_bf16 v[152:155], a[144:147], v[52:55], v[152:155]
    v_mfma_f32_16x16x32_bf16 v[172:175], a[148:151], v[52:55], v[172:175]
    s_waitcnt lgkmcnt(0)
    v_mfma_f32_16x16x32_bf16 v[96:99], v[56:59], a[152:155], v[96:99]
    v_mfma_f32_16x16x32_bf16 v[116:119], v[56:59], a[156:159], v[116:119]
    v_mfma_f32_16x16x32_bf16 v[100:103], v[60:63], a[152:155], v[100:103]
    v_mfma_f32_16x16x32_bf16 v[120:123], v[60:63], a[156:159], v[120:123]
    v_mfma_f32_16x16x32_bf16 v[104:107], v[64:67], a[152:155], v[104:107]
    v_mfma_f32_16x16x32_bf16 v[124:127], v[64:67], a[156:159], v[124:127]
    v_mfma_f32_16x16x32_bf16 v[108:111], v[68:71], a[152:155], v[108:111]
    v_mfma_f32_16x16x32_bf16 v[128:131], v[68:71], a[156:159], v[128:131]
    v_mfma_f32_16x16x32_bf16 v[112:115], v[72:75], a[152:155], v[112:115]
    v_mfma_f32_16x16x32_bf16 v[132:135], v[72:75], a[156:159], v[132:135]
    v_mfma_f32_16x16x32_bf16 v[136:139], a[152:155], v[76:79], v[136:139]
    v_mfma_f32_16x16x32_bf16 v[156:159], a[156:159], v[76:79], v[156:159]
    v_mfma_f32_16x16x32_bf16 v[140:143], a[152:155], v[80:83], v[140:143]
    v_mfma_f32_16x16x32_bf16 v[160:163], a[156:159], v[80:83], v[160:163]
    v_mfma_f32_16x16x32_bf16 v[144:147], a[152:155], v[84:87], v[144:147]
    v_mfma_f32_16x16x32_bf16 v[164:167], a[156:159], v[84:87], v[164:167]
    v_mfma_f32_16x16x32_bf16 v[148:151], a[152:155], v[88:91], v[148:151]
    v_mfma_f32_16x16x32_bf16 v[168:171], a[156:159], v[88:91], v[168:171]
    v_mfma_f32_16x16x32_bf16 v[152:155], a[152:155], v[92:95], v[152:155]
    v_mfma_f32_16x16x32_bf16 v[172:175], a[156:159], v[92:95], v[172:175]
    s_barrier
    s_add_u32 s28, s87, 12
    s_cmp_ge_u32 s28, 20
    s_cselect_b32 s101, 20, 0
    s_sub_u32 s28, s28, s101
    s_mul_i32 s28, s28, 122880
    s_add_u32 s28, s28, s25
    s_add_u32 m0, s26, 61440
    s_nop 0
    buffer_load_dwordx4 v5, s[8:11], s28 offen lds
    s_add_u32 m0, s26, 62464
    s_nop 0
    buffer_load_dwordx4 v6, s[8:11], s28 offen lds
    s_add_u32 m0, s26, 63488
    s_nop 0
    buffer_load_dwordx4 v7, s[8:11], s28 offen lds
    s_add_u32 m0, s26, 64512
    s_nop 0
    buffer_load_dwordx4 v8, s[8:11], s28 offen lds
    s_add_u32 m0, s26, 65536
    s_nop 0
    buffer_load_dwordx4 v9, s[8:11], s28 offen lds
    v_and_b32 v1, 63, v0
    s_lshr_b32 s28, s2, 3
    s_cmp_lt_u32 s28, 16
    s_cselect_b32 s96, s70, s76
    s_cselect_b32 s97, s71, s77
    s_mov_b32 s98, 819200
    s_mov_b32 s99, 0x00020000
    s_and_b32 s28, s28, 15
    s_mul_i32 s28, s28, 40
    s_mul_i32 s29, s27, 10
    s_add_u32 s28, s28, s29
    s_mul_i32 s28, s28, 1280
    s_and_b32 s29, s2, 1
    s_mul_i32 s29, s29, 640
    s_add_u32 s28, s28, s29
    v_lshlrev_b32 v14, 4, v1
    s_mov_b32 s100, -1
    s_mov_b32 s101, 0xff
    s_mov_b64 exec, s[100:101]
    buffer_load_dwordx4 a[240:243], v14, s[96:99], s28 offen
    s_add_u32 s28, s28, 1280
    buffer_load_dwordx4 a[240:243], v14, s[96:99], s28 offen
    s_add_u32 s28, s28, 1280
    buffer_load_dwordx4 a[240:243], v14, s[96:99], s28 offen
    s_add_u32 s28, s28, 1280
    buffer_load_dwordx4 a[240:243], v14, s[96:99], s28 offen
    s_add_u32 s28, s28, 1280
    buffer_load_dwordx4 a[240:243], v14, s[96:99], s28 offen
    s_add_u32 s28, s28, 1280
    buffer_load_dwordx4 a[240:243], v14, s[96:99], s28 offen
    s_add_u32 s28, s28, 1280
    buffer_load_dwordx4 a[240:243], v14, s[96:99], s28 offen
    s_add_u32 s28, s28, 1280
    buffer_load_dwordx4 a[240:243], v14, s[96:99], s28 offen
    s_add_u32 s28, s28, 1280
    buffer_load_dwordx4 a[240:243], v14, s[96:99], s28 offen
    s_add_u32 s28, s28, 1280
    buffer_load_dwordx4 a[240:243], v14, s[96:99], s28 offen
    s_add_u32 s28, s28, 1280
    s_mov_b64 exec, -1
    s_lshl_b32 s30, s21, 2
    buffer_load_dword a250, off, s[16:19], s30 sc1
    v_lshrrev_b32 v16, 2, v3
    v_and_b32 v17, 3, v3
    v_mul_u32_u24 v18, 800, v2
    v_mul_u32_u24 v16, 40, v16
    v_add_u32 v18, v18, v16
    v_add_u32 v18, 151552, v18
    v_mov_b32 v19, 154880
    v_cmp_eq_u32 vcc, v17, v2
    s_nop 1
    v_cndmask_b32 v14, v19, v18, vcc
    ds_read_b64_tr_b16 a[180:181], v14 offset:0
    ds_read_b64_tr_b16 a[182:183], v14 offset:160
    ds_read_b64_tr_b16 a[184:185], v14 offset:320
    ds_read_b64_tr_b16 a[186:187], v14 offset:480
    ds_read_b64_tr_b16 a[188:189], v14 offset:640
    v_accvgpr_write_b32 a190, 0
    v_accvgpr_write_b32 a191, 0
    ds_read_b64_tr_b16 a[192:193], v14 offset:8
    ds_read_b64_tr_b16 a[194:195], v14 offset:168
    ds_read_b64_tr_b16 a[196:197], v14 offset:328
    ds_read_b64_tr_b16 a[198:199], v14 offset:488
    ds_read_b64_tr_b16 a[200:201], v14 offset:648
    v_accvgpr_write_b32 a202, 0
    v_accvgpr_write_b32 a203, 0
    ds_read_b64_tr_b16 a[204:205], v14 offset:16
    ds_read_b64_tr_b16 a[206:207], v14 offset:176
    ds_read_b64_tr_b16 a[208:209], v14 offset:336
    ds_read_b64_tr_b16 a[210:211], v14 offset:496
    ds_read_b64_tr_b16 a[212:213], v14 offset:656
    v_accvgpr_write_b32 a214, 0
    v_accvgpr_write_b32 a215, 0
    ds_read_b64_tr_b16 a[216:217], v14 offset:24
    ds_read_b64_tr_b16 a[218:219], v14 offset:184
    ds_read_b64_tr_b16 a[220:221], v14 offset:344
    ds_read_b64_tr_b16 a[222:223], v14 offset:504
    ds_read_b64_tr_b16 a[224:225], v14 offset:664
    v_accvgpr_write_b32 a226, 0
    v_accvgpr_write_b32 a227, 0
    ds_read_b64_tr_b16 a[228:229], v14 offset:32
    ds_read_b64_tr_b16 a[230:231], v14 offset:192
    ds_read_b64_tr_b16 a[232:233], v14 offset:352
    ds_read_b64_tr_b16 a[234:235], v14 offset:512
    ds_read_b64_tr_b16 a[236:237], v14 offset:672
    v_accvgpr_write_b32 a238, 0
    v_accvgpr_write_b32 a239, 0
    v_lshlrev_b32 v15, 4, v1
    s_mul_i32 s28, s27, 5120
    s_add_u32 s28, s28, 81920
    v_add_u32 v15, s28, v15
    v_cvt_pk_bf16_f32 v16, v136, v137
    v_cvt_pk_bf16_f32 v17, v138, v139
    v_cvt_pk_bf16_f32 v18, v156, v157
    v_cvt_pk_bf16_f32 v19, v158, v159
    ds_write_b128 v15, v[16:19] offset:0
    v_cvt_pk_bf16_f32 v20, v140, v141
    v_cvt_pk_bf16_f32 v21, v142, v143
    v_cvt_pk_bf16_f32 v22, v160, v161
    v_cvt_pk_bf16_f32 v23, v162, v163
    ds_write_b128 v15, v[20:23] offset:1024
    v_cvt_pk_bf16_f32 v24, v144, v145
    v_cvt_pk_bf16_f32 v25, v146, v147
    v_cvt_pk_bf16_f32 v26, v164, v165
    v_cvt_pk_bf16_f32 v27, v166, v167
    ds_write_b128 v15, v[24:27] offset:2048
    v_cvt_pk_bf16_f32 v28, v148, v149
    v_cvt_pk_bf16_f32 v29, v150, v151
    v_cvt_pk_bf16_f32 v30, v168, v169
    v_cvt_pk_bf16_f32 v31, v170, v171
    ds_write_b128 v15, v[28:31] offset:3072
    v_cvt_pk_bf16_f32 v32, v152, v153
    v_cvt_pk_bf16_f32 v33, v154, v155
    v_cvt_pk_bf16_f32 v34, v172, v173
    v_cvt_pk_bf16_f32 v35, v174, v175
    ds_write_b128 v15, v[32:35] offset:4096
    s_waitcnt lgkmcnt(0)
    s_lshl_b32 s28, s27, 5
    v_add_u32 v15, s28, v3
    v_mul_u32_u24 v15, 352, v15
    v_mul_u32_u24 v16, 80, v2
    v_add_u32 v15, v15, v16
    v_add_u32 v15, 102400, v15
    v_cvt_pk_bf16_f32 v16, v96, v97
    v_cvt_pk_bf16_f32 v17, v98, v99
    v_cvt_pk_bf16_f32 v18, v100, v101
    v_cvt_pk_bf16_f32 v19, v102, v103
    v_cvt_pk_bf16_f32 v20, v104, v105
    v_cvt_pk_bf16_f32 v21, v106, v107
    v_cvt_pk_bf16_f32 v22, v108, v109
    v_cvt_pk_bf16_f32 v23, v110, v111
    v_cvt_pk_bf16_f32 v24, v112, v113
    v_cvt_pk_bf16_f32 v25, v114, v115
    v_mov_b32 v26, 0
    v_mov_b32 v27, 0
    v_mfma_f32_16x16x32_bf16 v[28:31], a[180:183], v[16:19], 0
    v_mfma_f32_16x16x32_bf16 v[32:35], a[192:195], v[16:19], 0
    v_mfma_f32_16x16x32_bf16 v[36:39], a[204:207], v[16:19], 0
    v_mfma_f32_16x16x32_bf16 v[40:43], a[216:219], v[16:19], 0
    v_mfma_f32_16x16x32_bf16 v[44:47], a[228:231], v[16:19], 0
    v_mfma_f32_16x16x32_bf16 v[28:31], a[184:187], v[20:23], v[28:31]
    v_mfma_f32_16x16x32_bf16 v[32:35], a[196:199], v[20:23], v[32:35]
    v_mfma_f32_16x16x32_bf16 v[36:39], a[208:211], v[20:23], v[36:39]
    v_mfma_f32_16x16x32_bf16 v[40:43], a[220:223], v[20:23], v[40:43]
    v_mfma_f32_16x16x32_bf16 v[44:47], a[232:235], v[20:23], v[44:47]
    v_mfma_f32_16x16x32_bf16 v[28:31], a[188:191], v[24:27], v[28:31]
    v_mfma_f32_16x16x32_bf16 v[32:35], a[200:203], v[24:27], v[32:35]
    v_mfma_f32_16x16x32_bf16 v[36:39], a[212:215], v[24:27], v[36:39]
    v_mfma_f32_16x16x32_bf16 v[40:43], a[224:227], v[24:27], v[40:43]
    v_mfma_f32_16x16x32_bf16 v[44:47], a[236:239], v[24:27], v[44:47]
    s_nop 3
    v_cvt_pk_bf16_f32 v16, v28, v29
    v_cvt_pk_bf16_f32 v17, v30, v31
    v_cvt_pk_bf16_f32 v18, v32, v33
    v_cvt_pk_bf16_f32 v19, v34, v35
    v_cvt_pk_bf16_f32 v20, v36, v37
    v_cvt_pk_bf16_f32 v21, v38, v39
    v_cvt_pk_bf16_f32 v22, v40, v41
    v_cvt_pk_bf16_f32 v23, v42, v43
    v_cvt_pk_bf16_f32 v24, v44, v45
    v_cvt_pk_bf16_f32 v25, v46, v47
    v_lshlrev_b32 v28, 16, v16
    v_and_b32 v29, 0xffff0000, v16
    v_lshlrev_b32 v30, 16, v17
    v_and_b32 v31, 0xffff0000, v17
    v_lshlrev_b32 v32, 16, v18
    v_and_b32 v33, 0xffff0000, v18
    v_lshlrev_b32 v34, 16, v19
    v_and_b32 v35, 0xffff0000, v19
    v_lshlrev_b32 v36, 16, v20
    v_and_b32 v37, 0xffff0000, v20
    v_lshlrev_b32 v38, 16, v21
    v_and_b32 v39, 0xffff0000, v21
    v_lshlrev_b32 v40, 16, v22
    v_and_b32 v41, 0xffff0000, v22
    v_lshlrev_b32 v42, 16, v23
    v_and_b32 v43, 0xffff0000, v23
    v_lshlrev_b32 v44, 16, v24
    v_and_b32 v45, 0xffff0000, v24
    v_lshlrev_b32 v46, 16, v25
    v_and_b32 v47, 0xffff0000, v25
    v_max3_f32 v68, v28, v29, v30
    v_min3_f32 v69, v28, v29, v30
    v_max3_f32 v68, v68, v31, v32
    v_min3_f32 v69, v69, v31, v32
    v_max3_f32 v68, v68, v33, v34
    v_min3_f32 v69, v69, v33, v34
    v_max3_f32 v68, v68, v35, v36
    v_min3_f32 v69, v69, v35, v36
    v_max3_f32 v68, v68, v37, v38
    v_min3_f32 v69, v69, v37, v38
    v_max3_f32 v68, v68, v39, v40
    v_min3_f32 v69, v69, v39, v40
    v_max3_f32 v68, v68, v41, v42
    v_min3_f32 v69, v69, v41, v42
    v_max3_f32 v68, v68, v43, v44
    v_min3_f32 v69, v69, v43, v44
    v_max3_f32 v68, v68, v45, v46
    v_min3_f32 v69, v69, v45, v46
    v_max_f32 v68, v68, v47
    v_min_f32 v69, v69, v47
    v_mul_f32 v68, s31, v68
    v_mul_f32 v69, s31, v69
    v_mov_b32 v73, v68
    v_mov_b32 v72, v68
    v_mov_b32 v75, v69
    v_mov_b32 v74, v69
    v_pk_fma_f32 v[48:49], v[28:29], s[62:63], v[74:75] neg_lo:[1,0,0] neg_hi:[1,0,0]
    v_pk_fma_f32 v[28:29], v[28:29], s[62:63], v[72:73] neg_lo:[0,0,1] neg_hi:[0,0,1]
    v_pk_fma_f32 v[50:51], v[30:31], s[62:63], v[74:75] neg_lo:[1,0,0] neg_hi:[1,0,0]
    v_pk_fma_f32 v[30:31], v[30:31], s[62:63], v[72:73] neg_lo:[0,0,1] neg_hi:[0,0,1]
    v_pk_fma_f32 v[52:53], v[32:33], s[62:63], v[74:75] neg_lo:[1,0,0] neg_hi:[1,0,0]
    v_pk_fma_f32 v[32:33], v[32:33], s[62:63], v[72:73] neg_lo:[0,0,1] neg_hi:[0,0,1]
    v_pk_fma_f32 v[54:55], v[34:35], s[62:63], v[74:75] neg_lo:[1,0,0] neg_hi:[1,0,0]
    v_pk_fma_f32 v[34:35], v[34:35], s[62:63], v[72:73] neg_lo:[0,0,1] neg_hi:[0,0,1]
    v_pk_fma_f32 v[56:57], v[36:37], s[62:63], v[74:75] neg_lo:[1,0,0] neg_hi:[1,0,0]
    v_pk_fma_f32 v[36:37], v[36:37], s[62:63], v[72:73] neg_lo:[0,0,1] neg_hi:[0,0,1]
    v_pk_fma_f32 v[58:59], v[38:39], s[62:63], v[74:75] neg_lo:[1,0,0] neg_hi:[1,0,0]
    v_pk_fma_f32 v[38:39], v[38:39], s[62:63], v[72:73] neg_lo:[0,0,1] neg_hi:[0,0,1]
    v_pk_fma_f32 v[60:61], v[40:41], s[62:63], v[74:75] neg_lo:[1,0,0] neg_hi:[1,0,0]
    v_pk_fma_f32 v[40:41], v[40:41], s[62:63], v[72:73] neg_lo:[0,0,1] neg_hi:[0,0,1]
    v_pk_fma_f32 v[62:63], v[42:43], s[62:63], v[74:75] neg_lo:[1,0,0] neg_hi:[1,0,0]
    v_pk_fma_f32 v[42:43], v[42:43], s[62:63], v[72:73] neg_lo:[0,0,1] neg_hi:[0,0,1]
    v_pk_fma_f32 v[64:65], v[44:45], s[62:63], v[74:75] neg_lo:[1,0,0] neg_hi:[1,0,0]
    v_pk_fma_f32 v[44:45], v[44:45], s[62:63], v[72:73] neg_lo:[0,0,1] neg_hi:[0,0,1]
    v_pk_fma_f32 v[66:67], v[46:47], s[62:63], v[74:75] neg_lo:[1,0,0] neg_hi:[1,0,0]
    v_pk_fma_f32 v[46:47], v[46:47], s[62:63], v[72:73] neg_lo:[0,0,1] neg_hi:[0,0,1]
    v_exp_f32 v28, v28
    v_exp_f32 v48, v48
    v_exp_f32 v29, v29
    v_exp_f32 v49, v49
    v_exp_f32 v30, v30
    v_exp_f32 v50, v50
    v_exp_f32 v31, v31
    v_exp_f32 v51, v51
    v_exp_f32 v32, v32
    v_exp_f32 v52, v52
    v_exp_f32 v33, v33
    v_exp_f32 v53, v53
    v_exp_f32 v34, v34
    v_exp_f32 v54, v54
    v_exp_f32 v35, v35
    v_exp_f32 v55, v55
    v_exp_f32 v36, v36
    v_exp_f32 v56, v56
    v_exp_f32 v37, v37
    v_exp_f32 v57, v57
    v_exp_f32 v38, v38
    v_exp_f32 v58, v58
    v_exp_f32 v39, v39
    v_exp_f32 v59, v59
    v_exp_f32 v40, v40
    v_exp_f32 v60, v60
    v_exp_f32 v41, v41
    v_exp_f32 v61, v61
    v_exp_f32 v42, v42
    v_exp_f32 v62, v62
    v_exp_f32 v43, v43
    v_exp_f32 v63, v63
    v_exp_f32 v44, v44
    v_exp_f32 v64, v64
    v_exp_f32 v45, v45
    v_exp_f32 v65, v65
    v_exp_f32 v46, v46
    v_exp_f32 v66, v66
    v_exp_f32 v47, v47
    v_exp_f32 v67, v67
    v_pk_add_f32 v[72:73], v[28:29], v[30:31]
    v_pk_add_f32 v[74:75], v[48:49], v[50:51]
    v_pk_add_f32 v[72:73], v[72:73], v[32:33]
    v_pk_add_f32 v[74:75], v[74:75], v[52:53]
    v_pk_add_f32 v[72:73], v[72:73], v[34:35]
    v_pk_add_f32 v[74:75], v[74:75], v[54:55]
    v_pk_add_f32 v[72:73], v[72:73], v[36:37]
    v_pk_add_f32 v[74:75], v[74:75], v[56:57]
    v_pk_add_f32 v[72:73], v[72:73], v[38:39]
    v_pk_add_f32 v[74:75], v[74:75], v[58:59]
    v_pk_add_f32 v[72:73], v[72:73], v[40:41]
    v_pk_add_f32 v[74:75], v[74:75], v[60:61]
    v_pk_add_f32 v[72:73], v[72:73], v[42:43]
    v_pk_add_f32 v[74:75], v[74:75], v[62:63]
    v_pk_add_f32 v[72:73], v[72:73], v[44:45]
    v_pk_add_f32 v[74:75], v[74:75], v[64:65]
    v_pk_add_f32 v[72:73], v[72:73], v[46:47]
    v_pk_add_f32 v[74:75], v[74:75], v[66:67]
    v_add_f32 v70, v72, v73
    v_add_f32 v71, v74, v75
    v_rcp_f32 v72, v70
    v_rcp_f32 v74, v71
    v_mov_b32 v73, v72
    v_mov_b32 v75, v74
    v_pk_mul_f32 v[28:29], v[28:29], v[72:73]
    v_pk_mul_f32 v[48:49], v[48:49], v[74:75]
    v_pk_mul_f32 v[30:31], v[30:31], v[72:73]
    v_pk_mul_f32 v[50:51], v[50:51], v[74:75]
    v_pk_mul_f32 v[32:33], v[32:33], v[72:73]
    v_pk_mul_f32 v[52:53], v[52:53], v[74:75]
    v_pk_mul_f32 v[34:35], v[34:35], v[72:73]
    v_pk_mul_f32 v[54:55], v[54:55], v[74:75]
    v_pk_mul_f32 v[36:37], v[36:37], v[72:73]
    v_pk_mul_f32 v[56:57], v[56:57], v[74:75]
    v_pk_mul_f32 v[38:39], v[38:39], v[72:73]
    v_pk_mul_f32 v[58:59], v[58:59], v[74:75]
    v_pk_mul_f32 v[40:41], v[40:41], v[72:73]
    v_pk_mul_f32 v[60:61], v[60:61], v[74:75]
    v_pk_mul_f32 v[42:43], v[42:43], v[72:73]
    v_pk_mul_f32 v[62:63], v[62:63], v[74:75]
    v_pk_mul_f32 v[44:45], v[44:45], v[72:73]
    v_pk_mul_f32 v[64:65], v[64:65], v[74:75]
    v_pk_mul_f32 v[46:47], v[46:47], v[72:73]
    v_pk_mul_f32 v[66:67], v[66:67], v[74:75]
    v_cvt_pk_bf16_f32 v136, v28, v29
    v_cvt_pk_bf16_f32 v146, v48, v49
    v_cvt_pk_bf16_f32 v137, v30, v31
    v_cvt_pk_bf16_f32 v147, v50, v51
    v_cvt_pk_bf16_f32 v138, v32, v33
    v_cvt_pk_bf16_f32 v148, v52, v53
    v_cvt_pk_bf16_f32 v139, v34, v35
    v_cvt_pk_bf16_f32 v149, v54, v55
    v_cvt_pk_bf16_f32 v140, v36, v37
    v_cvt_pk_bf16_f32 v150, v56, v57
    v_cvt_pk_bf16_f32 v141, v38, v39
    v_cvt_pk_bf16_f32 v151, v58, v59
    v_cvt_pk_bf16_f32 v142, v40, v41
    v_cvt_pk_bf16_f32 v152, v60, v61
    v_cvt_pk_bf16_f32 v143, v42, v43
    v_cvt_pk_bf16_f32 v153, v62, v63
    v_cvt_pk_bf16_f32 v144, v44, v45
    v_cvt_pk_bf16_f32 v154, v64, v65
    v_cvt_pk_bf16_f32 v145, v46, v47
    v_cvt_pk_bf16_f32 v155, v66, v67
    ds_write_b128 v15, v[136:139] offset:0
    ds_write_b128 v15, v[140:143] offset:16
    ds_write_b128 v15, v[144:147] offset:32
    ds_write_b128 v15, v[148:151] offset:48
    ds_write_b128 v15, v[152:155] offset:64
    v_cvt_pk_bf16_f32 v16, v116, v117
    v_cvt_pk_bf16_f32 v17, v118, v119
    v_cvt_pk_bf16_f32 v18, v120, v121
    v_cvt_pk_bf16_f32 v19, v122, v123
    v_cvt_pk_bf16_f32 v20, v124, v125
    v_cvt_pk_bf16_f32 v21, v126, v127
    v_cvt_pk_bf16_f32 v22, v128, v129
    v_cvt_pk_bf16_f32 v23, v130, v131
    v_cvt_pk_bf16_f32 v24, v132, v133
    v_cvt_pk_bf16_f32 v25, v134, v135
    v_mov_b32 v26, 0
    v_mov_b32 v27, 0
    v_mfma_f32_16x16x32_bf16 v[28:31], a[180:183], v[16:19], 0
    v_mfma_f32_16x16x32_bf16 v[32:35], a[192:195], v[16:19], 0
    v_mfma_f32_16x16x32_bf16 v[36:39], a[204:207], v[16:19], 0
    v_mfma_f32_16x16x32_bf16 v[40:43], a[216:219], v[16:19], 0
    v_mfma_f32_16x16x32_bf16 v[44:47], a[228:231], v[16:19], 0
    v_mfma_f32_16x16x32_bf16 v[28:31], a[184:187], v[20:23], v[28:31]
    v_mfma_f32_16x16x32_bf16 v[32:35], a[196:199], v[20:23], v[32:35]
    v_mfma_f32_16x16x32_bf16 v[36:39], a[208:211], v[20:23], v[36:39]
    v_mfma_f32_16x16x32_bf16 v[40:43], a[220:223], v[20:23], v[40:43]
    v_mfma_f32_16x16x32_bf16 v[44:47], a[232:235], v[20:23], v[44:47]
    v_mfma_f32_16x16x32_bf16 v[28:31], a[188:191], v[24:27], v[28:31]
    v_mfma_f32_16x16x32_bf16 v[32:35], a[200:203], v[24:27], v[32:35]
    v_mfma_f32_16x16x32_bf16 v[36:39], a[212:215], v[24:27], v[36:39]
    v_mfma_f32_16x16x32_bf16 v[40:43], a[224:227], v[24:27], v[40:43]
    v_mfma_f32_16x16x32_bf16 v[44:47], a[236:239], v[24:27], v[44:47]
    s_nop 3
    v_cvt_pk_bf16_f32 v16, v28, v29
    v_cvt_pk_bf16_f32 v17, v30, v31
    v_cvt_pk_bf16_f32 v18, v32, v33
    v_cvt_pk_bf16_f32 v19, v34, v35
    v_cvt_pk_bf16_f32 v20, v36, v37
    v_cvt_pk_bf16_f32 v21, v38, v39
    v_cvt_pk_bf16_f32 v22, v40, v41
    v_cvt_pk_bf16_f32 v23, v42, v43
    v_cvt_pk_bf16_f32 v24, v44, v45
    v_cvt_pk_bf16_f32 v25, v46, v47
    v_lshlrev_b32 v28, 16, v16
    v_and_b32 v29, 0xffff0000, v16
    v_lshlrev_b32 v30, 16, v17
    v_and_b32 v31, 0xffff0000, v17
    v_lshlrev_b32 v32, 16, v18
    v_and_b32 v33, 0xffff0000, v18
    v_lshlrev_b32 v34, 16, v19
    v_and_b32 v35, 0xffff0000, v19
    v_lshlrev_b32 v36, 16, v20
    v_and_b32 v37, 0xffff0000, v20
    v_lshlrev_b32 v38, 16, v21
    v_and_b32 v39, 0xffff0000, v21
    v_lshlrev_b32 v40, 16, v22
    v_and_b32 v41, 0xffff0000, v22
    v_lshlrev_b32 v42, 16, v23
    v_and_b32 v43, 0xffff0000, v23
    v_lshlrev_b32 v44, 16, v24
    v_and_b32 v45, 0xffff0000, v24
    v_lshlrev_b32 v46, 16, v25
    v_and_b32 v47, 0xffff0000, v25
    v_max3_f32 v68, v28, v29, v30
    v_min3_f32 v69, v28, v29, v30
    v_max3_f32 v68, v68, v31, v32
    v_min3_f32 v69, v69, v31, v32
    v_max3_f32 v68, v68, v33, v34
    v_min3_f32 v69, v69, v33, v34
    v_max3_f32 v68, v68, v35, v36
    v_min3_f32 v69, v69, v35, v36
    v_max3_f32 v68, v68, v37, v38
    v_min3_f32 v69, v69, v37, v38
    v_max3_f32 v68, v68, v39, v40
    v_min3_f32 v69, v69, v39, v40
    v_max3_f32 v68, v68, v41, v42
    v_min3_f32 v69, v69, v41, v42
    v_max3_f32 v68, v68, v43, v44
    v_min3_f32 v69, v69, v43, v44
    v_max3_f32 v68, v68, v45, v46
    v_min3_f32 v69, v69, v45, v46
    v_max_f32 v68, v68, v47
    v_min_f32 v69, v69, v47
    v_mul_f32 v68, s31, v68
    v_mul_f32 v69, s31, v69
    v_mov_b32 v73, v68
    v_mov_b32 v72, v68
    v_mov_b32 v75, v69
    v_mov_b32 v74, v69
    v_pk_fma_f32 v[48:49], v[28:29], s[62:63], v[74:75] neg_lo:[1,0,0] neg_hi:[1,0,0]
    v_pk_fma_f32 v[28:29], v[28:29], s[62:63], v[72:73] neg_lo:[0,0,1] neg_hi:[0,0,1]
    v_pk_fma_f32 v[50:51], v[30:31], s[62:63], v[74:75] neg_lo:[1,0,0] neg_hi:[1,0,0]
    v_pk_fma_f32 v[30:31], v[30:31], s[62:63], v[72:73] neg_lo:[0,0,1] neg_hi:[0,0,1]
    v_pk_fma_f32 v[52:53], v[32:33], s[62:63], v[74:75] neg_lo:[1,0,0] neg_hi:[1,0,0]
    v_pk_fma_f32 v[32:33], v[32:33], s[62:63], v[72:73] neg_lo:[0,0,1] neg_hi:[0,0,1]
    v_pk_fma_f32 v[54:55], v[34:35], s[62:63], v[74:75] neg_lo:[1,0,0] neg_hi:[1,0,0]
    v_pk_fma_f32 v[34:35], v[34:35], s[62:63], v[72:73] neg_lo:[0,0,1] neg_hi:[0,0,1]
    v_pk_fma_f32 v[56:57], v[36:37], s[62:63], v[74:75] neg_lo:[1,0,0] neg_hi:[1,0,0]
    v_pk_fma_f32 v[36:37], v[36:37], s[62:63], v[72:73] neg_lo:[0,0,1] neg_hi:[0,0,1]
    v_pk_fma_f32 v[58:59], v[38:39], s[62:63], v[74:75] neg_lo:[1,0,0] neg_hi:[1,0,0]
    v_pk_fma_f32 v[38:39], v[38:39], s[62:63], v[72:73] neg_lo:[0,0,1] neg_hi:[0,0,1]
    v_pk_fma_f32 v[60:61], v[40:41], s[62:63], v[74:75] neg_lo:[1,0,0] neg_hi:[1,0,0]
    v_pk_fma_f32 v[40:41], v[40:41], s[62:63], v[72:73] neg_lo:[0,0,1] neg_hi:[0,0,1]
    v_pk_fma_f32 v[62:63], v[42:43], s[62:63], v[74:75] neg_lo:[1,0,0] neg_hi:[1,0,0]
    v_pk_fma_f32 v[42:43], v[42:43], s[62:63], v[72:73] neg_lo:[0,0,1] neg_hi:[0,0,1]
    v_pk_fma_f32 v[64:65], v[44:45], s[62:63], v[74:75] neg_lo:[1,0,0] neg_hi:[1,0,0]
    v_pk_fma_f32 v[44:45], v[44:45], s[62:63], v[72:73] neg_lo:[0,0,1] neg_hi:[0,0,1]
    v_pk_fma_f32 v[66:67], v[46:47], s[62:63], v[74:75] neg_lo:[1,0,0] neg_hi:[1,0,0]
    v_pk_fma_f32 v[46:47], v[46:47], s[62:63], v[72:73] neg_lo:[0,0,1] neg_hi:[0,0,1]
    v_exp_f32 v28, v28
    v_exp_f32 v48, v48
    v_exp_f32 v29, v29
    v_exp_f32 v49, v49
    v_exp_f32 v30, v30
    v_exp_f32 v50, v50
    v_exp_f32 v31, v31
    v_exp_f32 v51, v51
    v_exp_f32 v32, v32
    v_exp_f32 v52, v52
    v_exp_f32 v33, v33
    v_exp_f32 v53, v53
    v_exp_f32 v34, v34
    v_exp_f32 v54, v54
    v_exp_f32 v35, v35
    v_exp_f32 v55, v55
    v_exp_f32 v36, v36
    v_exp_f32 v56, v56
    v_exp_f32 v37, v37
    v_exp_f32 v57, v57
    v_exp_f32 v38, v38
    v_exp_f32 v58, v58
    v_exp_f32 v39, v39
    v_exp_f32 v59, v59
    v_exp_f32 v40, v40
    v_exp_f32 v60, v60
    v_exp_f32 v41, v41
    v_exp_f32 v61, v61
    v_exp_f32 v42, v42
    v_exp_f32 v62, v62
    v_exp_f32 v43, v43
    v_exp_f32 v63, v63
    v_exp_f32 v44, v44
    v_exp_f32 v64, v64
    v_exp_f32 v45, v45
    v_exp_f32 v65, v65
    v_exp_f32 v46, v46
    v_exp_f32 v66, v66
    v_exp_f32 v47, v47
    v_exp_f32 v67, v67
    v_pk_add_f32 v[72:73], v[28:29], v[30:31]
    v_pk_add_f32 v[74:75], v[48:49], v[50:51]
    v_pk_add_f32 v[72:73], v[72:73], v[32:33]
    v_pk_add_f32 v[74:75], v[74:75], v[52:53]
    v_pk_add_f32 v[72:73], v[72:73], v[34:35]
    v_pk_add_f32 v[74:75], v[74:75], v[54:55]
    v_pk_add_f32 v[72:73], v[72:73], v[36:37]
    v_pk_add_f32 v[74:75], v[74:75], v[56:57]
    v_pk_add_f32 v[72:73], v[72:73], v[38:39]
    v_pk_add_f32 v[74:75], v[74:75], v[58:59]
    v_pk_add_f32 v[72:73], v[72:73], v[40:41]
    v_pk_add_f32 v[74:75], v[74:75], v[60:61]
    v_pk_add_f32 v[72:73], v[72:73], v[42:43]
    v_pk_add_f32 v[74:75], v[74:75], v[62:63]
    v_pk_add_f32 v[72:73], v[72:73], v[44:45]
    v_pk_add_f32 v[74:75], v[74:75], v[64:65]
    v_pk_add_f32 v[72:73], v[72:73], v[46:47]
    v_pk_add_f32 v[74:75], v[74:75], v[66:67]
    v_add_f32 v70, v72, v73
    v_add_f32 v71, v74, v75
    v_rcp_f32 v72, v70
    v_rcp_f32 v74, v71
    v_mov_b32 v73, v72
    v_mov_b32 v75, v74
    v_pk_mul_f32 v[28:29], v[28:29], v[72:73]
    v_pk_mul_f32 v[48:49], v[48:49], v[74:75]
    v_pk_mul_f32 v[30:31], v[30:31], v[72:73]
    v_pk_mul_f32 v[50:51], v[50:51], v[74:75]
    v_pk_mul_f32 v[32:33], v[32:33], v[72:73]
    v_pk_mul_f32 v[52:53], v[52:53], v[74:75]
    v_pk_mul_f32 v[34:35], v[34:35], v[72:73]
    v_pk_mul_f32 v[54:55], v[54:55], v[74:75]
    v_pk_mul_f32 v[36:37], v[36:37], v[72:73]
    v_pk_mul_f32 v[56:57], v[56:57], v[74:75]
    v_pk_mul_f32 v[38:39], v[38:39], v[72:73]
    v_pk_mul_f32 v[58:59], v[58:59], v[74:75]
    v_pk_mul_f32 v[40:41], v[40:41], v[72:73]
    v_pk_mul_f32 v[60:61], v[60:61], v[74:75]
    v_pk_mul_f32 v[42:43], v[42:43], v[72:73]
    v_pk_mul_f32 v[62:63], v[62:63], v[74:75]
    v_pk_mul_f32 v[44:45], v[44:45], v[72:73]
    v_pk_mul_f32 v[64:65], v[64:65], v[74:75]
    v_pk_mul_f32 v[46:47], v[46:47], v[72:73]
    v_pk_mul_f32 v[66:67], v[66:67], v[74:75]
    v_cvt_pk_bf16_f32 v156, v28, v29
    v_cvt_pk_bf16_f32 v166, v48, v49
    v_cvt_pk_bf16_f32 v157, v30, v31
    v_cvt_pk_bf16_f32 v167, v50, v51
    v_cvt_pk_bf16_f32 v158, v32, v33
    v_cvt_pk_bf16_f32 v168, v52, v53
    v_cvt_pk_bf16_f32 v159, v34, v35
    v_cvt_pk_bf16_f32 v169, v54, v55
    v_cvt_pk_bf16_f32 v160, v36, v37
    v_cvt_pk_bf16_f32 v170, v56, v57
    v_cvt_pk_bf16_f32 v161, v38, v39
    v_cvt_pk_bf16_f32 v171, v58, v59
    v_cvt_pk_bf16_f32 v162, v40, v41
    v_cvt_pk_bf16_f32 v172, v60, v61
    v_cvt_pk_bf16_f32 v163, v42, v43
    v_cvt_pk_bf16_f32 v173, v62, v63
    v_cvt_pk_bf16_f32 v164, v44, v45
    v_cvt_pk_bf16_f32 v174, v64, v65
    v_cvt_pk_bf16_f32 v165, v46, v47
    v_cvt_pk_bf16_f32 v175, v66, v67
    ds_write_b128 v15, v[156:159] offset:5632
    ds_write_b128 v15, v[160:163] offset:5648
    ds_write_b128 v15, v[164:167] offset:5664
    ds_write_b128 v15, v[168:171] offset:5680
    ds_write_b128 v15, v[172:175] offset:5696
    s_waitcnt lgkmcnt(0)
    s_barrier
    v_lshrrev_b32 v16, 2, v3
    v_and_b32 v17, 3, v3
    v_lshl_add_u32 v16, v2, 2, v16
    v_mul_u32_u24 v16, 352, v16
    v_lshl_add_u32 v16, v17, 3, v16
    s_mul_i32 s28, s27, 80
    s_add_u32 s28, s28, 102400
    v_add_u32 v16, s28, v16
    v_lshlrev_b32 v17, 4, v1
    s_lshl_b32 s28, s27, 10
    s_add_u32 s28, s28, 81920
    v_add_u32 v17, s28, v17
    v_mov_b32 v20, 0x3f803f80
    v_mov_b32 v21, 0x3f803f80
    v_mov_b32 v22, 0x3f803f80
    v_mov_b32 v23, 0x3f803f80
    ds_read_b64_tr_b16 v[24:25], v16 offset:0
    ds_read_b64_tr_b16 v[26:27], v16 offset:5632
    ds_read_b64_tr_b16 v[28:29], v16 offset:32
    ds_read_b64_tr_b16 v[30:31], v16 offset:5664
    ds_read_b64_tr_b16 v[32:33], v16 offset:64
    ds_read_b64_tr_b16 v[34:35], v16 offset:5696
    ds_read_b128 v[36:39], v17 offset:0
    ds_read_b128 v[40:43], v17 offset:1024
    s_waitcnt lgkmcnt(0)
    v_mfma_f32_16x16x32_bf16 v[96:99], v[36:39], v[24:27], 0
    v_mfma_f32_16x16x32_bf16 v[100:103], v[40:43], v[24:27], 0
    v_mfma_f32_16x16x32_bf16 v[104:107], v[20:23], v[24:27], 0
    v_mfma_f32_16x16x32_bf16 v[108:111], v[36:39], v[28:31], 0
    v_mfma_f32_16x16x32_bf16 v[112:115], v[40:43], v[28:31], 0
    v_mfma_f32_16x16x32_bf16 v[116:119], v[20:23], v[28:31], 0
    v_mfma_f32_16x16x32_bf16 v[120:123], v[36:39], v[32:35], 0
    v_mfma_f32_16x16x32_bf16 v[124:127], v[40:43], v[32:35], 0
    v_mfma_f32_16x16x32_bf16 v[128:131], v[20:23], v[32:35], 0
    ds_read_b64_tr_b16 v[44:45], v16 offset:11264
    ds_read_b64_tr_b16 v[46:47], v16 offset:16896
    ds_read_b64_tr_b16 v[48:49], v16 offset:11296
    ds_read_b64_tr_b16 v[50:51], v16 offset:16928
    ds_read_b64_tr_b16 v[52:53], v16 offset:11328
    ds_read_b64_tr_b16 v[54:55], v16 offset:16960
    ds_read_b128 v[56:59], v17 offset:5120
    ds_read_b128 v[60:63], v17 offset:6144
    s_waitcnt lgkmcnt(0)
    v_mfma_f32_16x16x32_bf16 v[96:99], v[56:59], v[44:47], v[96:99]
    v_mfma_f32_16x16x32_bf16 v[100:103], v[60:63], v[44:47], v[100:103]
    v_mfma_f32_16x16x32_bf16 v[104:107], v[20:23], v[44:47], v[104:107]
    v_mfma_f32_16x16x32_bf16 v[108:111], v[56:59], v[48:51], v[108:111]
    v_mfma_f32_16x16x32_bf16 v[112:115], v[60:63], v[48:51], v[112:115]
    v_mfma_f32_16x16x32_bf16 v[116:119], v[20:23], v[48:51], v[116:119]
    v_mfma_f32_16x16x32_bf16 v[120:123], v[56:59], v[52:55], v[120:123]
    v_mfma_f32_16x16x32_bf16 v[124:127], v[60:63], v[52:55], v[124:127]
    v_mfma_f32_16x16x32_bf16 v[128:131], v[20:23], v[52:55], v[128:131]
    ds_read_b64_tr_b16 v[24:25], v16 offset:22528
    ds_read_b64_tr_b16 v[26:27], v16 offset:28160
    ds_read_b64_tr_b16 v[28:29], v16 offset:22560
    ds_read_b64_tr_b16 v[30:31], v16 offset:28192
    ds_read_b64_tr_b16 v[32:33], v16 offset:22592
    ds_read_b64_tr_b16 v[34:35], v16 offset:28224
    ds_read_b128 v[36:39], v17 offset:10240
    ds_read_b128 v[40:43], v17 offset:11264
    s_waitcnt lgkmcnt(0)
    v_mfma_f32_16x16x32_bf16 v[96:99], v[36:39], v[24:27], v[96:99]
    v_mfma_f32_16x16x32_bf16 v[100:103], v[40:43], v[24:27], v[100:103]
    v_mfma_f32_16x16x32_bf16 v[104:107], v[20:23], v[24:27], v[104:107]
    v_mfma_f32_16x16x32_bf16 v[108:111], v[36:39], v[28:31], v[108:111]
    v_mfma_f32_16x16x32_bf16 v[112:115], v[40:43], v[28:31], v[112:115]
    v_mfma_f32_16x16x32_bf16 v[116:119], v[20:23], v[28:31], v[116:119]
    v_mfma_f32_16x16x32_bf16 v[120:123], v[36:39], v[32:35], v[120:123]
    v_mfma_f32_16x16x32_bf16 v[124:127], v[40:43], v[32:35], v[124:127]
    v_mfma_f32_16x16x32_bf16 v[128:131], v[20:23], v[32:35], v[128:131]
    ds_read_b64_tr_b16 v[44:45], v16 offset:33792
    ds_read_b64_tr_b16 v[46:47], v16 offset:39424
    ds_read_b64_tr_b16 v[48:49], v16 offset:33824
    ds_read_b64_tr_b16 v[50:51], v16 offset:39456
    ds_read_b64_tr_b16 v[52:53], v16 offset:33856
    ds_read_b64_tr_b16 v[54:55], v16 offset:39488
    ds_read_b128 v[56:59], v17 offset:15360
    ds_read_b128 v[60:63], v17 offset:16384
    s_waitcnt lgkmcnt(0)
    v_mfma_f32_16x16x32_bf16 v[96:99], v[56:59], v[44:47], v[96:99]
    v_mfma_f32_16x16x32_bf16 v[100:103], v[60:63], v[44:47], v[100:103]
    v_mfma_f32_16x16x32_bf16 v[104:107], v[20:23], v[44:47], v[104:107]
    v_mfma_f32_16x16x32_bf16 v[108:111], v[56:59], v[48:51], v[108:111]
    v_mfma_f32_16x16x32_bf16 v[112:115], v[60:63], v[48:51], v[112:115]
    v_mfma_f32_16x16x32_bf16 v[116:119], v[20:23], v[48:51], v[116:119]
    v_mfma_f32_16x16x32_bf16 v[120:123], v[56:59], v[52:55], v[120:123]
    v_mfma_f32_16x16x32_bf16 v[124:127], v[60:63], v[52:55], v[124:127]
    v_mfma_f32_16x16x32_bf16 v[128:131], v[20:23], v[52:55], v[128:131]
    s_waitcnt vmcnt(0)
    v_accvgpr_read_b32 v15, a250
    s_nop 0
    v_readfirstlane_b32 s28, v15
    s_nop 0
    s_cmp_ge_u32 s28, 16
    s_cbranch_scc1 L_pz_ok
    s_mov_b32 s29, 0x20000
    s_nop 0
L_pz:
    buffer_load_dword v15, off, s[16:19], s30 offset:0 sc1
    s_waitcnt vmcnt(0)
    v_readfirstlane_b32 s28, v15
    s_nop 0
    s_cmp_ge_u32 s28, 16
    s_cbranch_scc1 L_pz_done
    s_sleep 4
    s_sub_u32 s29, s29, 1
    s_cmp_lg_u32 s29, 0
    s_cbranch_scc1 L_pz
    s_nop 0
L_pz_done:
L_pz_ok:
    v_mul_u32_u24 v15, 640, v2
    v_lshl_add_u32 v15, v3, 2, v15
    s_lshl_b32 s28, s21, 14
    s_mul_i32 s29, s27, 2720
    s_add_u32 s28, s28, s29
    v_cmp_ge_u32 s[32:33], v2, s27
    v_cmp_le_u32 s[34:35], v2, s27
    v_cmp_gt_u32 s[36:37], 8, v3
    s_nop 0
    s_and_b64 s[38:39], s[32:33], s[36:37]
    s_and_b64 s[40:41], s[34:35], s[36:37]
    s_mov_b64 exec, s[32:33]
    buffer_atomic_add_f32 v96, v15, s[12:15], s28 offen offset:0
    buffer_atomic_add_f32 v97, v15, s[12:15], s28 offen offset:160
    buffer_atomic_add_f32 v98, v15, s[12:15], s28 offen offset:320
    buffer_atomic_add_f32 v99, v15, s[12:15], s28 offen offset:480
    s_mov_b64 exec, s[32:33]
    buffer_atomic_add_f32 v108, v15, s[12:15], s28 offen offset:64
    buffer_atomic_add_f32 v109, v15, s[12:15], s28 offen offset:224
    buffer_atomic_add_f32 v110, v15, s[12:15], s28 offen offset:384
    buffer_atomic_add_f32 v111, v15, s[12:15], s28 offen offset:544
    s_mov_b64 exec, s[38:39]
    buffer_atomic_add_f32 v120, v15, s[12:15], s28 offen offset:128
    buffer_atomic_add_f32 v121, v15, s[12:15], s28 offen offset:288
    buffer_atomic_add_f32 v122, v15, s[12:15], s28 offen offset:448
    buffer_atomic_add_f32 v123, v15, s[12:15], s28 offen offset:608
    s_mov_b64 exec, s[34:35]
    buffer_atomic_add_f32 v100, v15, s[12:15], s28 offen offset:2560
    buffer_atomic_add_f32 v101, v15, s[12:15], s28 offen offset:2720
    buffer_atomic_add_f32 v102, v15, s[12:15], s28 offen offset:2880
    buffer_atomic_add_f32 v103, v15, s[12:15], s28 offen offset:3040
    s_mov_b64 exec, s[34:35]
    buffer_atomic_add_f32 v112, v15, s[12:15], s28 offen offset:2624
    buffer_atomic_add_f32 v113, v15, s[12:15], s28 offen offset:2784
    buffer_atomic_add_f32 v114, v15, s[12:15], s28 offen offset:2944
    buffer_atomic_add_f32 v115, v15, s[12:15], s28 offen offset:3104
    s_mov_b64 exec, s[40:41]
    buffer_atomic_add_f32 v124, v15, s[12:15], s28 offen offset:2688
    buffer_atomic_add_f32 v125, v15, s[12:15], s28 offen offset:2848
    buffer_atomic_add_f32 v126, v15, s[12:15], s28 offen offset:3008
    buffer_atomic_add_f32 v127, v15, s[12:15], s28 offen offset:3168
    s_lshl_b32 s28, s21, 14
    s_mul_i32 s29, s27, 3360
    s_add_u32 s28, s28, s29
    s_mov_b64 exec, 0xffff
    buffer_atomic_add_f32 v104, v15, s[12:15], s28 offen offset:3200
    s_mov_b64 exec, 0xffff
    buffer_atomic_add_f32 v116, v15, s[12:15], s28 offen offset:3264
    s_mov_b64 exec, 0xff
    buffer_atomic_add_f32 v128, v15, s[12:15], s28 offen offset:3328
    s_mov_b64 exec, -1
    s_barrier
    ds_read_b64_tr_b16 v[76:77], v12 offset:0
    ds_read_b64_tr_b16 v[78:79], v12 offset:2560
    ds_read_b64_tr_b16 v[80:81], v12 offset:8
    ds_read_b64_tr_b16 v[82:83], v12 offset:2568
    ds_read_b64_tr_b16 v[84:85], v12 offset:16
    ds_read_b64_tr_b16 v[86:87], v12 offset:2576
    ds_read_b64_tr_b16 v[88:89], v12 offset:24
    ds_read_b64_tr_b16 v[90:91], v12 offset:2584
    ds_read_b64_tr_b16 v[92:93], v12 offset:32
    ds_read_b64_tr_b16 v[94:95], v12 offset:2592
    ds_read_b64_tr_b16 v[216:217], v12 offset:5120
    ds_read_b64_tr_b16 v[218:219], v12 offset:7680
    ds_read_b64_tr_b16 v[220:221], v12 offset:5128
    ds_read_b64_tr_b16 v[222:223], v12 offset:7688
    ds_read_b64_tr_b16 v[224:225], v12 offset:5136
    ds_read_b64_tr_b16 v[226:227], v12 offset:7696
    ds_read_b64_tr_b16 v[228:229], v12 offset:5144
    ds_read_b64_tr_b16 v[230:231], v12 offset:7704
    ds_read_b64_tr_b16 v[232:233], v12 offset:5152
    ds_read_b64_tr_b16 v[234:235], v12 offset:7712
    s_waitcnt lgkmcnt(10)
    v_mfma_f32_16x16x32_bf16 v[176:179], v[76:79], a[0:3], 0
    ds_read_b64_tr_b16 v[236:237], v12 offset:10240
    ds_read_b64_tr_b16 v[238:239], v12 offset:12800
    v_mfma_f32_16x16x32_bf16 v[196:199], v[76:79], a[4:7], 0
    ds_read_b64_tr_b16 v[240:241], v12 offset:10248
    ds_read_b64_tr_b16 v[242:243], v12 offset:12808
    v_mfma_f32_16x16x32_bf16 v[180:183], v[80:83], a[0:3], 0
    ds_read_b64_tr_b16 v[244:245], v12 offset:10256
    ds_read_b64_tr_b16 v[246:247], v12 offset:12816
    v_mfma_f32_16x16x32_bf16 v[200:203], v[80:83], a[4:7], 0
    ds_read_b64_tr_b16 v[248:249], v12 offset:10264
    ds_read_b64_tr_b16 v[250:251], v12 offset:12824
    v_mfma_f32_16x16x32_bf16 v[184:187], v[84:87], a[0:3], 0
    ds_read_b64_tr_b16 v[252:253], v12 offset:10272
    ds_read_b64_tr_b16 v[254:255], v12 offset:12832
    v_mfma_f32_16x16x32_bf16 v[204:207], v[84:87], a[4:7], 0
    v_mfma_f32_16x16x32_bf16 v[188:191], v[88:91], a[0:3], 0
    v_mfma_f32_16x16x32_bf16 v[208:211], v[88:91], a[4:7], 0
    v_mfma_f32_16x16x32_bf16 v[192:195], v[92:95], a[0:3], 0
    v_mfma_f32_16x16x32_bf16 v[212:215], v[92:95], a[4:7], 0
    s_waitcnt lgkmcnt(10)
    v_mfma_f32_16x16x32_bf16 v[176:179], v[216:219], a[8:11], v[176:179]
    ds_read_b64_tr_b16 v[76:77], v12 offset:15360
    ds_read_b64_tr_b16 v[78:79], v12 offset:17920
    v_mfma_f32_16x16x32_bf16 v[196:199], v[216:219], a[12:15], v[196:199]
    ds_read_b64_tr_b16 v[80:81], v12 offset:15368
    ds_read_b64_tr_b16 v[82:83], v12 offset:17928
    v_mfma_f32_16x16x32_bf16 v[180:183], v[220:223], a[8:11], v[180:183]
    ds_read_b64_tr_b16 v[84:85], v12 offset:15376
    ds_read_b64_tr_b16 v[86:87], v12 offset:17936
    v_mfma_f32_16x16x32_bf16 v[200:203], v[220:223], a[12:15], v[200:203]
    ds_read_b64_tr_b16 v[88:89], v12 offset:15384
    ds_read_b64_tr_b16 v[90:91], v12 offset:17944
    v_mfma_f32_16x16x32_bf16 v[184:187], v[224:227], a[8:11], v[184:187]
    ds_read_b64_tr_b16 v[92:93], v12 offset:15392
    ds_read_b64_tr_b16 v[94:95], v12 offset:17952
    v_mfma_f32_16x16x32_bf16 v[204:207], v[224:227], a[12:15], v[204:207]
    v_mfma_f32_16x16x32_bf16 v[188:191], v[228:231], a[8:11], v[188:191]
    v_mfma_f32_16x16x32_bf16 v[208:211], v[228:231], a[12:15], v[208:211]
    v_mfma_f32_16x16x32_bf16 v[192:195], v[232:235], a[8:11], v[192:195]
    v_mfma_f32_16x16x32_bf16 v[212:215], v[232:235], a[12:15], v[212:215]
    s_waitcnt lgkmcnt(10)
    s_barrier
    v_mfma_f32_16x16x32_bf16 v[176:179], v[236:239], a[16:19], v[176:179]
    ds_read_b64_tr_b16 v[216:217], v12 offset:20480
    ds_read_b64_tr_b16 v[218:219], v12 offset:23040
    v_mfma_f32_16x16x32_bf16 v[196:199], v[236:239], a[20:23], v[196:199]
    ds_read_b64_tr_b16 v[220:221], v12 offset:20488
    ds_read_b64_tr_b16 v[222:223], v12 offset:23048
    v_mfma_f32_16x16x32_bf16 v[180:183], v[240:243], a[16:19], v[180:183]
    ds_read_b64_tr_b16 v[224:225], v12 offset:20496
    ds_read_b64_tr_b16 v[226:227], v12 offset:23056
    v_mfma_f32_16x16x32_bf16 v[200:203], v[240:243], a[20:23], v[200:203]
    ds_read_b64_tr_b16 v[228:229], v12 offset:20504
    ds_read_b64_tr_b16 v[230:231], v12 offset:23064
    v_mfma_f32_16x16x32_bf16 v[184:187], v[244:247], a[16:19], v[184:187]
    ds_read_b64_tr_b16 v[232:233], v12 offset:20512
    ds_read_b64_tr_b16 v[234:235], v12 offset:23072
    v_mfma_f32_16x16x32_bf16 v[204:207], v[244:247], a[20:23], v[204:207]
    v_mfma_f32_16x16x32_bf16 v[188:191], v[248:251], a[16:19], v[188:191]
    v_mfma_f32_16x16x32_bf16 v[208:211], v[248:251], a[20:23], v[208:211]
    v_mfma_f32_16x16x32_bf16 v[192:195], v[252:255], a[16:19], v[192:195]
    v_mfma_f32_16x16x32_bf16 v[212:215], v[252:255], a[20:23], v[212:215]
    s_waitcnt lgkmcnt(10)
    v_mfma_f32_16x16x32_bf16 v[176:179], v[76:79], a[24:27], v[176:179]
    ds_read_b64_tr_b16 v[236:237], v12 offset:25600
    ds_read_b64_tr_b16 v[238:239], v12 offset:28160
    v_mfma_f32_16x16x32_bf16 v[196:199], v[76:79], a[28:31], v[196:199]
    ds_read_b64_tr_b16 v[240:241], v12 offset:25608
    ds_read_b64_tr_b16 v[242:243], v12 offset:28168
    v_mfma_f32_16x16x32_bf16 v[180:183], v[80:83], a[24:27], v[180:183]
    ds_read_b64_tr_b16 v[244:245], v12 offset:25616
    ds_read_b64_tr_b16 v[246:247], v12 offset:28176
    v_mfma_f32_16x16x32_bf16 v[200:203], v[80:83], a[28:31], v[200:203]
    ds_read_b64_tr_b16 v[248:249], v12 offset:25624
    ds_read_b64_tr_b16 v[250:251], v12 offset:28184
    v_mfma_f32_16x16x32_bf16 v[184:187], v[84:87], a[24:27], v[184:187]
    ds_read_b64_tr_b16 v[252:253], v12 offset:25632
    ds_read_b64_tr_b16 v[254:255], v12 offset:28192
    v_mfma_f32_16x16x32_bf16 v[204:207], v[84:87], a[28:31], v[204:207]
    v_mfma_f32_16x16x32_bf16 v[188:191], v[88:91], a[24:27], v[188:191]
    v_mfma_f32_16x16x32_bf16 v[208:211], v[88:91], a[28:31], v[208:211]
    v_mfma_f32_16x16x32_bf16 v[192:195], v[92:95], a[24:27], v[192:195]
    v_mfma_f32_16x16x32_bf16 v[212:215], v[92:95], a[28:31], v[212:215]
    s_waitcnt lgkmcnt(10)
    v_mfma_f32_16x16x32_bf16 v[176:179], v[216:219], a[32:35], v[176:179]
    ds_read_b64_tr_b16 v[76:77], v12 offset:30720
    ds_read_b64_tr_b16 v[78:79], v12 offset:33280
    v_mfma_f32_16x16x32_bf16 v[196:199], v[216:219], a[36:39], v[196:199]
    ds_read_b64_tr_b16 v[80:81], v12 offset:30728
    ds_read_b64_tr_b16 v[82:83], v12 offset:33288
    v_mfma_f32_16x16x32_bf16 v[180:183], v[220:223], a[32:35], v[180:183]
    ds_read_b64_tr_b16 v[84:85], v12 offset:30736
    ds_read_b64_tr_b16 v[86:87], v12 offset:33296
    v_mfma_f32_16x16x32_bf16 v[200:203], v[220:223], a[36:39], v[200:203]
    ds_read_b64_tr_b16 v[88:89], v12 offset:30744
    ds_read_b64_tr_b16 v[90:91], v12 offset:33304
    v_mfma_f32_16x16x32_bf16 v[184:187], v[224:227], a[32:35], v[184:187]
    ds_read_b64_tr_b16 v[92:93], v12 offset:30752
    ds_read_b64_tr_b16 v[94:95], v12 offset:33312
    v_mfma_f32_16x16x32_bf16 v[204:207], v[224:227], a[36:39], v[204:207]
    v_mfma_f32_16x16x32_bf16 v[188:191], v[228:231], a[32:35], v[188:191]
    v_mfma_f32_16x16x32_bf16 v[208:211], v[228:231], a[36:39], v[208:211]
    v_mfma_f32_16x16x32_bf16 v[192:195], v[232:235], a[32:35], v[192:195]
    v_mfma_f32_16x16x32_bf16 v[212:215], v[232:235], a[36:39], v[212:215]
    s_waitcnt lgkmcnt(10)
    v_mfma_f32_16x16x32_bf16 v[176:179], v[236:239], a[40:43], v[176:179]
    ds_read_b64_tr_b16 v[216:217], v12 offset:35840
    ds_read_b64_tr_b16 v[218:219], v12 offset:38400
    v_mfma_f32_16x16x32_bf16 v[196:199], v[236:239], a[44:47], v[196:199]
    ds_read_b64_tr_b16 v[220:221], v12 offset:35848
    ds_read_b64_tr_b16 v[222:223], v12 offset:38408
    v_mfma_f32_16x16x32_bf16 v[180:183], v[240:243], a[40:43], v[180:183]
    ds_read_b64_tr_b16 v[224:225], v12 offset:35856
    ds_read_b64_tr_b16 v[226:227], v12 offset:38416
    v_mfma_f32_16x16x32_bf16 v[200:203], v[240:243], a[44:47], v[200:203]
    ds_read_b64_tr_b16 v[228:229], v12 offset:35864
    ds_read_b64_tr_b16 v[230:231], v12 offset:38424
    v_mfma_f32_16x16x32_bf16 v[184:187], v[244:247], a[40:43], v[184:187]
    ds_read_b64_tr_b16 v[232:233], v12 offset:35872
    ds_read_b64_tr_b16 v[234:235], v12 offset:38432
    v_mfma_f32_16x16x32_bf16 v[204:207], v[244:247], a[44:47], v[204:207]
    v_mfma_f32_16x16x32_bf16 v[188:191], v[248:251], a[40:43], v[188:191]
    v_mfma_f32_16x16x32_bf16 v[208:211], v[248:251], a[44:47], v[208:211]
    v_mfma_f32_16x16x32_bf16 v[192:195], v[252:255], a[40:43], v[192:195]
    v_mfma_f32_16x16x32_bf16 v[212:215], v[252:255], a[44:47], v[212:215]
    s_waitcnt lgkmcnt(10)
    s_barrier
    s_add_u32 s100, s87, 16
    s_cmp_ge_u32 s100, 20
    s_cselect_b32 s101, 20, 0
    s_sub_u32 s100, s100, s101
    s_mul_i32 s100, s100, 122880
    s_add_u32 s100, s100, s25
    s_add_u32 m0, s26, 0
    s_nop 0
    buffer_load_dwordx4 v5, s[8:11], s100 offen lds
    s_add_u32 m0, s26, 1024
    s_nop 0
    buffer_load_dwordx4 v6, s[8:11], s100 offen lds
    s_add_u32 m0, s26, 2048
    s_nop 0
    buffer_load_dwordx4 v7, s[8:11], s100 offen lds
    s_add_u32 m0, s26, 3072
    s_nop 0
    buffer_load_dwordx4 v8, s[8:11], s100 offen lds
    s_add_u32 m0, s26, 4096
    s_nop 0
    buffer_load_dwordx4 v9, s[8:11], s100 offen lds
    v_mfma_f32_16x16x32_bf16 v[176:179], v[76:79], a[48:51], v[176:179]
    ds_read_b64_tr_b16 v[236:237], v12 offset:40960
    ds_read_b64_tr_b16 v[238:239], v12 offset:43520
    v_mfma_f32_16x16x32_bf16 v[196:199], v[76:79], a[52:55], v[196:199]
    ds_read_b64_tr_b16 v[240:241], v12 offset:40968
    ds_read_b64_tr_b16 v[242:243], v12 offset:43528
    v_mfma_f32_16x16x32_bf16 v[180:183], v[80:83], a[48:51], v[180:183]
    ds_read_b64_tr_b16 v[244:245], v12 offset:40976
    ds_read_b64_tr_b16 v[246:247], v12 offset:43536
    v_mfma_f32_16x16x32_bf16 v[200:203], v[80:83], a[52:55], v[200:203]
    ds_read_b64_tr_b16 v[248:249], v12 offset:40984
    ds_read_b64_tr_b16 v[250:251], v12 offset:43544
    v_mfma_f32_16x16x32_bf16 v[184:187], v[84:87], a[48:51], v[184:187]
    ds_read_b64_tr_b16 v[252:253], v12 offset:40992
    ds_read_b64_tr_b16 v[254:255], v12 offset:43552
    v_mfma_f32_16x16x32_bf16 v[204:207], v[84:87], a[52:55], v[204:207]
    v_mfma_f32_16x16x32_bf16 v[188:191], v[88:91], a[48:51], v[188:191]
    v_mfma_f32_16x16x32_bf16 v[208:211], v[88:91], a[52:55], v[208:211]
    v_mfma_f32_16x16x32_bf16 v[192:195], v[92:95], a[48:51], v[192:195]
    v_mfma_f32_16x16x32_bf16 v[212:215], v[92:95], a[52:55], v[212:215]
    s_waitcnt lgkmcnt(10)
    v_mfma_f32_16x16x32_bf16 v[176:179], v[216:219], a[56:59], v[176:179]
    ds_read_b64_tr_b16 v[76:77], v12 offset:46080
    ds_read_b64_tr_b16 v[78:79], v12 offset:48640
    v_mfma_f32_16x16x32_bf16 v[196:199], v[216:219], a[60:63], v[196:199]
    ds_read_b64_tr_b16 v[80:81], v12 offset:46088
    ds_read_b64_tr_b16 v[82:83], v12 offset:48648
    v_mfma_f32_16x16x32_bf16 v[180:183], v[220:223], a[56:59], v[180:183]
    ds_read_b64_tr_b16 v[84:85], v12 offset:46096
    ds_read_b64_tr_b16 v[86:87], v12 offset:48656
    v_mfma_f32_16x16x32_bf16 v[200:203], v[220:223], a[60:63], v[200:203]
    ds_read_b64_tr_b16 v[88:89], v12 offset:46104
    ds_read_b64_tr_b16 v[90:91], v12 offset:48664
    v_mfma_f32_16x16x32_bf16 v[184:187], v[224:227], a[56:59], v[184:187]
    ds_read_b64_tr_b16 v[92:93], v12 offset:46112
    ds_read_b64_tr_b16 v[94:95], v12 offset:48672
    v_mfma_f32_16x16x32_bf16 v[204:207], v[224:227], a[60:63], v[204:207]
    v_mfma_f32_16x16x32_bf16 v[188:191], v[228:231], a[56:59], v[188:191]
    v_mfma_f32_16x16x32_bf16 v[208:211], v[228:231], a[60:63], v[208:211]
    v_mfma_f32_16x16x32_bf16 v[192:195], v[232:235], a[56:59], v[192:195]
    v_mfma_f32_16x16x32_bf16 v[212:215], v[232:235], a[60:63], v[212:215]
    s_waitcnt lgkmcnt(10)
    v_mfma_f32_16x16x32_bf16 v[176:179], v[236:239], a[64:67], v[176:179]
    ds_read_b64_tr_b16 v[216:217], v12 offset:51200
    ds_read_b64_tr_b16 v[218:219], v12 offset:53760
    v_mfma_f32_16x16x32_bf16 v[196:199], v[236:239], a[68:71], v[196:199]
    ds_read_b64_tr_b16 v[220:221], v12 offset:51208
    ds_read_b64_tr_b16 v[222:223], v12 offset:53768
    v_mfma_f32_16x16x32_bf16 v[180:183], v[240:243], a[64:67], v[180:183]
    ds_read_b64_tr_b16 v[224:225], v12 offset:51216
    ds_read_b64_tr_b16 v[226:227], v12 offset:53776
    v_mfma_f32_16x16x32_bf16 v[200:203], v[240:243], a[68:71], v[200:203]
    ds_read_b64_tr_b16 v[228:229], v12 offset:51224
    ds_read_b64_tr_b16 v[230:231], v12 offset:53784
    v_mfma_f32_16x16x32_bf16 v[184:187], v[244:247], a[64:67], v[184:187]
    ds_read_b64_tr_b16 v[232:233], v12 offset:51232
    ds_read_b64_tr_b16 v[234:235], v12 offset:53792
    v_mfma_f32_16x16x32_bf16 v[204:207], v[244:247], a[68:71], v[204:207]
    v_mfma_f32_16x16x32_bf16 v[188:191], v[248:251], a[64:67], v[188:191]
    v_mfma_f32_16x16x32_bf16 v[208:211], v[248:251], a[68:71], v[208:211]
    v_mfma_f32_16x16x32_bf16 v[192:195], v[252:255], a[64:67], v[192:195]
    v_mfma_f32_16x16x32_bf16 v[212:215], v[252:255], a[68:71], v[212:215]
    s_waitcnt lgkmcnt(10)
    v_mfma_f32_16x16x32_bf16 v[176:179], v[76:79], a[72:75], v[176:179]
    ds_read_b64_tr_b16 v[236:237], v12 offset:56320
    ds_read_b64_tr_b16 v[238:239], v12 offset:58880
    v_mfma_f32_16x16x32_bf16 v[196:199], v[76:79], a[76:79], v[196:199]
    ds_read_b64_tr_b16 v[240:241], v12 offset:56328
    ds_read_b64_tr_b16 v[242:243], v12 offset:58888
    v_mfma_f32_16x16x32_bf16 v[180:183], v[80:83], a[72:75], v[180:183]
    ds_read_b64_tr_b16 v[244:245], v12 offset:56336
    ds_read_b64_tr_b16 v[246:247], v12 offset:58896
    v_mfma_f32_16x16x32_bf16 v[200:203], v[80:83], a[76:79], v[200:203]
    ds_read_b64_tr_b16 v[248:249], v12 offset:56344
    ds_read_b64_tr_b16 v[250:251], v12 offset:58904
    v_mfma_f32_16x16x32_bf16 v[184:187], v[84:87], a[72:75], v[184:187]
    ds_read_b64_tr_b16 v[252:253], v12 offset:56352
    ds_read_b64_tr_b16 v[254:255], v12 offset:58912
    v_mfma_f32_16x16x32_bf16 v[204:207], v[84:87], a[76:79], v[204:207]
    v_mfma_f32_16x16x32_bf16 v[188:191], v[88:91], a[72:75], v[188:191]
    v_mfma_f32_16x16x32_bf16 v[208:211], v[88:91], a[76:79], v[208:211]
    v_mfma_f32_16x16x32_bf16 v[192:195], v[92:95], a[72:75], v[192:195]
    v_mfma_f32_16x16x32_bf16 v[212:215], v[92:95], a[76:79], v[212:215]
    s_waitcnt lgkmcnt(10)
    s_barrier
    v_mfma_f32_16x16x32_bf16 v[176:179], v[216:219], a[80:83], v[176:179]
    ds_read_b64_tr_b16 v[76:77], v13 offset:0
    ds_read_b64_tr_b16 v[78:79], v13 offset:2560
    v_mfma_f32_16x16x32_bf16 v[196:199], v[216:219], a[84:87], v[196:199]
    ds_read_b64_tr_b16 v[80:81], v13 offset:8
    ds_read_b64_tr_b16 v[82:83], v13 offset:2568
    v_mfma_f32_16x16x32_bf16 v[180:183], v[220:223], a[80:83], v[180:183]
    ds_read_b64_tr_b16 v[84:85], v13 offset:16
    ds_read_b64_tr_b16 v[86:87], v13 offset:2576
    v_mfma_f32_16x16x32_bf16 v[200:203], v[220:223], a[84:87], v[200:203]
    ds_read_b64_tr_b16 v[88:89], v13 offset:24
    ds_read_b64_tr_b16 v[90:91], v13 offset:2584
    v_mfma_f32_16x16x32_bf16 v[184:187], v[224:227], a[80:83], v[184:187]
    ds_read_b64_tr_b16 v[92:93], v13 offset:32
    ds_read_b64_tr_b16 v[94:95], v13 offset:2592
    v_mfma_f32_16x16x32_bf16 v[204:207], v[224:227], a[84:87], v[204:207]
    v_mfma_f32_16x16x32_bf16 v[188:191], v[228:231], a[80:83], v[188:191]
    v_mfma_f32_16x16x32_bf16 v[208:211], v[228:231], a[84:87], v[208:211]
    v_mfma_f32_16x16x32_bf16 v[192:195], v[232:235], a[80:83], v[192:195]
    v_mfma_f32_16x16x32_bf16 v[212:215], v[232:235], a[84:87], v[212:215]
    s_waitcnt lgkmcnt(10)
    v_mfma_f32_16x16x32_bf16 v[176:179], v[236:239], a[88:91], v[176:179]
    ds_read_b64_tr_b16 v[216:217], v13 offset:5120
    ds_read_b64_tr_b16 v[218:219], v13 offset:7680
    v_mfma_f32_16x16x32_bf16 v[196:199], v[236:239], a[92:95], v[196:199]
    ds_read_b64_tr_b16 v[220:221], v13 offset:5128
    ds_read_b64_tr_b16 v[222:223], v13 offset:7688
    v_mfma_f32_16x16x32_bf16 v[180:183], v[240:243], a[88:91], v[180:183]
    ds_read_b64_tr_b16 v[224:225], v13 offset:5136
    ds_read_b64_tr_b16 v[226:227], v13 offset:7696
    v_mfma_f32_16x16x32_bf16 v[200:203], v[240:243], a[92:95], v[200:203]
    ds_read_b64_tr_b16 v[228:229], v13 offset:5144
    ds_read_b64_tr_b16 v[230:231], v13 offset:7704
    v_mfma_f32_16x16x32_bf16 v[184:187], v[244:247], a[88:91], v[184:187]
    ds_read_b64_tr_b16 v[232:233], v13 offset:5152
    ds_read_b64_tr_b16 v[234:235], v13 offset:7712
    v_mfma_f32_16x16x32_bf16 v[204:207], v[244:247], a[92:95], v[204:207]
    v_mfma_f32_16x16x32_bf16 v[188:191], v[248:251], a[88:91], v[188:191]
    s_waitcnt vmcnt(5)
    s_barrier
    s_cmp_lg_u32 s27, 0
    s_cbranch_scc1 L_sc
    v_mov_b32 v14, 1
    s_lshl_b32 s28, s21, 2
    s_mov_b64 exec, 1
    buffer_atomic_add v14, off, s[16:19], s28 offset:32
    s_mov_b64 exec, -1
    s_nop 0
L_sc:
    v_mfma_f32_16x16x32_bf16 v[208:211], v[248:251], a[92:95], v[208:211]
    v_mfma_f32_16x16x32_bf16 v[192:195], v[252:255], a[88:91], v[192:195]
    v_mfma_f32_16x16x32_bf16 v[212:215], v[252:255], a[92:95], v[212:215]
    s_waitcnt lgkmcnt(10)
    v_mfma_f32_16x16x32_bf16 v[176:179], v[76:79], a[96:99], v[176:179]
    ds_read_b64_tr_b16 v[236:237], v13 offset:10240
    ds_read_b64_tr_b16 v[238:239], v13 offset:12800
    v_mfma_f32_16x16x32_bf16 v[196:199], v[76:79], a[100:103], v[196:199]
    ds_read_b64_tr_b16 v[240:241], v13 offset:10248
    ds_read_b64_tr_b16 v[242:243], v13 offset:12808
    v_mfma_f32_16x16x32_bf16 v[180:183], v[80:83], a[96:99], v[180:183]
    ds_read_b64_tr_b16 v[244:245], v13 offset:10256
    ds_read_b64_tr_b16 v[246:247], v13 offset:12816
    v_mfma_f32_16x16x32_bf16 v[200:203], v[80:83], a[100:103], v[200:203]
    ds_read_b64_tr_b16 v[248:249], v13 offset:10264
    ds_read_b64_tr_b16 v[250:251], v13 offset:12824
    v_mfma_f32_16x16x32_bf16 v[184:187], v[84:87], a[96:99], v[184:187]
    ds_read_b64_tr_b16 v[252:253], v13 offset:10272
    ds_read_b64_tr_b16 v[254:255], v13 offset:12832
    v_mfma_f32_16x16x32_bf16 v[204:207], v[84:87], a[100:103], v[204:207]
    v_mfma_f32_16x16x32_bf16 v[188:191], v[88:91], a[96:99], v[188:191]
    v_mfma_f32_16x16x32_bf16 v[208:211], v[88:91], a[100:103], v[208:211]
    v_mfma_f32_16x16x32_bf16 v[192:195], v[92:95], a[96:99], v[192:195]
    v_mfma_f32_16x16x32_bf16 v[212:215], v[92:95], a[100:103], v[212:215]
    s_waitcnt lgkmcnt(10)
    v_mfma_f32_16x16x32_bf16 v[176:179], v[216:219], a[104:107], v[176:179]
    ds_read_b64_tr_b16 v[76:77], v13 offset:15360
    ds_read_b64_tr_b16 v[78:79], v13 offset:17920
    v_mfma_f32_16x16x32_bf16 v[196:199], v[216:219], a[108:111], v[196:199]
    ds_read_b64_tr_b16 v[80:81], v13 offset:15368
    ds_read_b64_tr_b16 v[82:83], v13 offset:17928
    v_mfma_f32_16x16x32_bf16 v[180:183], v[220:223], a[104:107], v[180:183]
    ds_read_b64_tr_b16 v[84:85], v13 offset:15376
    ds_read_b64_tr_b16 v[86:87], v13 offset:17936
    v_mfma_f32_16x16x32_bf16 v[200:203], v[220:223], a[108:111], v[200:203]
    ds_read_b64_tr_b16 v[88:89], v13 offset:15384
    ds_read_b64_tr_b16 v[90:91], v13 offset:17944
    v_mfma_f32_16x16x32_bf16 v[184:187], v[224:227], a[104:107], v[184:187]
    ds_read_b64_tr_b16 v[92:93], v13 offset:15392
    ds_read_b64_tr_b16 v[94:95], v13 offset:17952
    v_mfma_f32_16x16x32_bf16 v[204:207], v[224:227], a[108:111], v[204:207]
    v_mfma_f32_16x16x32_bf16 v[188:191], v[228:231], a[104:107], v[188:191]
    v_mfma_f32_16x16x32_bf16 v[208:211], v[228:231], a[108:111], v[208:211]
    v_mfma_f32_16x16x32_bf16 v[192:195], v[232:235], a[104:107], v[192:195]
    v_mfma_f32_16x16x32_bf16 v[212:215], v[232:235], a[108:111], v[212:215]
    s_waitcnt lgkmcnt(10)
    s_waitcnt vmcnt(0)
    s_barrier
    v_mfma_f32_16x16x32_bf16 v[176:179], v[236:239], a[112:115], v[176:179]
    ds_read_b64_tr_b16 v[216:217], v12 offset:0
    ds_read_b64_tr_b16 v[218:219], v12 offset:2560
    v_mfma_f32_16x16x32_bf16 v[196:199], v[236:239], a[116:119], v[196:199]
    ds_read_b64_tr_b16 v[220:221], v12 offset:8
    ds_read_b64_tr_b16 v[222:223], v12 offset:2568
    v_mfma_f32_16x16x32_bf16 v[180:183], v[240:243], a[112:115], v[180:183]
    ds_read_b64_tr_b16 v[224:225], v12 offset:16
    ds_read_b64_tr_b16 v[226:227], v12 offset:2576
    v_mfma_f32_16x16x32_bf16 v[200:203], v[240:243], a[116:119], v[200:203]
    ds_read_b64_tr_b16 v[228:229], v12 offset:24
    ds_read_b64_tr_b16 v[230:231], v12 offset:2584
    v_mfma_f32_16x16x32_bf16 v[184:187], v[244:247], a[112:115], v[184:187]
    ds_read_b64_tr_b16 v[232:233], v12 offset:32
    ds_read_b64_tr_b16 v[234:235], v12 offset:2592
    v_mfma_f32_16x16x32_bf16 v[204:207], v[244:247], a[116:119], v[204:207]
    v_mfma_f32_16x16x32_bf16 v[188:191], v[248:251], a[112:115], v[188:191]
    v_mfma_f32_16x16x32_bf16 v[208:211], v[248:251], a[116:119], v[208:211]
    v_mfma_f32_16x16x32_bf16 v[192:195], v[252:255], a[112:115], v[192:195]
    v_mfma_f32_16x16x32_bf16 v[212:215], v[252:255], a[116:119], v[212:215]
    s_waitcnt lgkmcnt(10)
    v_mfma_f32_16x16x32_bf16 v[176:179], v[76:79], a[120:123], v[176:179]
    ds_read_b64_tr_b16 v[236:237], v12 offset:5120
    ds_read_b64_tr_b16 v[238:239], v12 offset:7680
    v_mfma_f32_16x16x32_bf16 v[196:199], v[76:79], a[124:127], v[196:199]
    ds_read_b64_tr_b16 v[240:241], v12 offset:5128
    ds_read_b64_tr_b16 v[242:243], v12 offset:7688
    v_mfma_f32_16x16x32_bf16 v[180:183], v[80:83], a[120:123], v[180:183]
    ds_read_b64_tr_b16 v[244:245], v12 offset:5136
    ds_read_b64_tr_b16 v[246:247], v12 offset:7696
    v_mfma_f32_16x16x32_bf16 v[200:203], v[80:83], a[124:127], v[200:203]
    ds_read_b64_tr_b16 v[248:249], v12 offset:5144
    ds_read_b64_tr_b16 v[250:251], v12 offset:7704
    v_mfma_f32_16x16x32_bf16 v[184:187], v[84:87], a[120:123], v[184:187]
    ds_read_b64_tr_b16 v[252:253], v12 offset:5152
    ds_read_b64_tr_b16 v[254:255], v12 offset:7712
    v_mfma_f32_16x16x32_bf16 v[204:207], v[84:87], a[124:127], v[204:207]
    v_mfma_f32_16x16x32_bf16 v[188:191], v[88:91], a[120:123], v[188:191]
    v_mfma_f32_16x16x32_bf16 v[208:211], v[88:91], a[124:127], v[208:211]
    v_mfma_f32_16x16x32_bf16 v[192:195], v[92:95], a[120:123], v[192:195]
    v_mfma_f32_16x16x32_bf16 v[212:215], v[92:95], a[124:127], v[212:215]
    s_waitcnt lgkmcnt(10)
    v_mfma_f32_16x16x32_bf16 v[176:179], v[216:219], a[128:131], v[176:179]
    ds_read_b64_tr_b16 v[76:77], v12 offset:10240
    ds_read_b64_tr_b16 v[78:79], v12 offset:12800
    v_mfma_f32_16x16x32_bf16 v[196:199], v[216:219], a[132:135], v[196:199]
    ds_read_b64_tr_b16 v[80:81], v12 offset:10248
    ds_read_b64_tr_b16 v[82:83], v12 offset:12808
    v_mfma_f32_16x16x32_bf16 v[180:183], v[220:223], a[128:131], v[180:183]
    ds_read_b64_tr_b16 v[84:85], v12 offset:10256
    ds_read_b64_tr_b16 v[86:87], v12 offset:12816
    v_mfma_f32_16x16x32_bf16 v[200:203], v[220:223], a[132:135], v[200:203]
    ds_read_b64_tr_b16 v[88:89], v12 offset:10264
    ds_read_b64_tr_b16 v[90:91], v12 offset:12824
    v_mfma_f32_16x16x32_bf16 v[184:187], v[224:227], a[128:131], v[184:187]
    ds_read_b64_tr_b16 v[92:93], v12 offset:10272
    ds_read_b64_tr_b16 v[94:95], v12 offset:12832
    v_mfma_f32_16x16x32_bf16 v[204:207], v[224:227], a[132:135], v[204:207]
    v_mfma_f32_16x16x32_bf16 v[188:191], v[228:231], a[128:131], v[188:191]
    v_mfma_f32_16x16x32_bf16 v[208:211], v[228:231], a[132:135], v[208:211]
    v_mfma_f32_16x16x32_bf16 v[192:195], v[232:235], a[128:131], v[192:195]
    v_mfma_f32_16x16x32_bf16 v[212:215], v[232:235], a[132:135], v[212:215]
    s_waitcnt lgkmcnt(10)
    v_mfma_f32_16x16x32_bf16 v[176:179], v[236:239], a[136:139], v[176:179]
    ds_read_b64_tr_b16 v[216:217], v12 offset:15360
    ds_read_b64_tr_b16 v[218:219], v12 offset:17920
    v_mfma_f32_16x16x32_bf16 v[196:199], v[236:239], a[140:143], v[196:199]
    ds_read_b64_tr_b16 v[220:221], v12 offset:15368
    ds_read_b64_tr_b16 v[222:223], v12 offset:17928
    v_mfma_f32_16x16x32_bf16 v[180:183], v[240:243], a[136:139], v[180:183]
    ds_read_b64_tr_b16 v[224:225], v12 offset:15376
    ds_read_b64_tr_b16 v[226:227], v12 offset:17936
    v_mfma_f32_16x16x32_bf16 v[200:203], v[240:243], a[140:143], v[200:203]
    ds_read_b64_tr_b16 v[228:229], v12 offset:15384
    ds_read_b64_tr_b16 v[230:231], v12 offset:17944
    v_mfma_f32_16x16x32_bf16 v[184:187], v[244:247], a[136:139], v[184:187]
    ds_read_b64_tr_b16 v[232:233], v12 offset:15392
    ds_read_b64_tr_b16 v[234:235], v12 offset:17952
    v_mfma_f32_16x16x32_bf16 v[204:207], v[244:247], a[140:143], v[204:207]
    v_mfma_f32_16x16x32_bf16 v[188:191], v[248:251], a[136:139], v[188:191]
    v_mfma_f32_16x16x32_bf16 v[208:211], v[248:251], a[140:143], v[208:211]
    v_mfma_f32_16x16x32_bf16 v[192:195], v[252:255], a[136:139], v[192:195]
    v_mfma_f32_16x16x32_bf16 v[212:215], v[252:255], a[140:143], v[212:215]
    s_waitcnt lgkmcnt(10)
    v_mfma_f32_16x16x32_bf16 v[176:179], v[76:79], a[144:147], v[176:179]
    v_mfma_f32_16x16x32_bf16 v[196:199], v[76:79], a[148:151], v[196:199]
    v_mfma_f32_16x16x32_bf16 v[180:183], v[80:83], a[144:147], v[180:183]
    v_mfma_f32_16x16x32_bf16 v[200:203], v[80:83], a[148:151], v[200:203]
    v_mfma_f32_16x16x32_bf16 v[184:187], v[84:87], a[144:147], v[184:187]
    v_mfma_f32_16x16x32_bf16 v[204:207], v[84:87], a[148:151], v[204:207]
    v_mfma_f32_16x16x32_bf16 v[188:191], v[88:91], a[144:147], v[188:191]
    v_mfma_f32_16x16x32_bf16 v[208:211], v[88:91], a[148:151], v[208:211]
    v_mfma_f32_16x16x32_bf16 v[192:195], v[92:95], a[144:147], v[192:195]
    v_mfma_f32_16x16x32_bf16 v[212:215], v[92:95], a[148:151], v[212:215]
    s_waitcnt lgkmcnt(0)
    v_mfma_f32_16x16x32_bf16 v[176:179], v[216:219], a[152:155], v[176:179]
    v_mfma_f32_16x16x32_bf16 v[196:199], v[216:219], a[156:159], v[196:199]
    v_mfma_f32_16x16x32_bf16 v[180:183], v[220:223], a[152:155], v[180:183]
    v_mfma_f32_16x16x32_bf16 v[200:203], v[220:223], a[156:159], v[200:203]
    v_mfma_f32_16x16x32_bf16 v[184:187], v[224:227], a[152:155], v[184:187]
    v_mfma_f32_16x16x32_bf16 v[204:207], v[224:227], a[156:159], v[204:207]
    v_mfma_f32_16x16x32_bf16 v[188:191], v[228:231], a[152:155], v[188:191]
    v_mfma_f32_16x16x32_bf16 v[208:211], v[228:231], a[156:159], v[208:211]
    v_mfma_f32_16x16x32_bf16 v[192:195], v[232:235], a[152:155], v[192:195]
    v_mfma_f32_16x16x32_bf16 v[212:215], v[232:235], a[156:159], v[212:215]
    s_barrier
    v_cvt_pk_bf16_f32 v16, v176, v177
    v_cvt_pk_bf16_f32 v17, v178, v179
    v_cvt_pk_bf16_f32 v18, v180, v181
    v_cvt_pk_bf16_f32 v19, v182, v183
    v_cvt_pk_bf16_f32 v20, v184, v185
    v_cvt_pk_bf16_f32 v21, v186, v187
    v_cvt_pk_bf16_f32 v22, v188, v189
    v_cvt_pk_bf16_f32 v23, v190, v191
    v_cvt_pk_bf16_f32 v24, v192, v193
    v_cvt_pk_bf16_f32 v25, v194, v195
    v_mov_b32 v26, 0
    v_mov_b32 v27, 0
    v_mfma_f32_16x16x32_bf16 v[28:31], a[180:183], v[16:19], 0
    v_mfma_f32_16x16x32_bf16 v[32:35], a[192:195], v[16:19], 0
    v_mfma_f32_16x16x32_bf16 v[36:39], a[204:207], v[16:19], 0
    v_mfma_f32_16x16x32_bf16 v[40:43], a[216:219], v[16:19], 0
    v_mfma_f32_16x16x32_bf16 v[44:47], a[228:231], v[16:19], 0
    v_mfma_f32_16x16x32_bf16 v[28:31], a[184:187], v[20:23], v[28:31]
    v_mfma_f32_16x16x32_bf16 v[32:35], a[196:199], v[20:23], v[32:35]
    v_mfma_f32_16x16x32_bf16 v[36:39], a[208:211], v[20:23], v[36:39]
    v_mfma_f32_16x16x32_bf16 v[40:43], a[220:223], v[20:23], v[40:43]
    v_mfma_f32_16x16x32_bf16 v[44:47], a[232:235], v[20:23], v[44:47]
    v_mfma_f32_16x16x32_bf16 v[28:31], a[188:191], v[24:27], v[28:31]
    v_mfma_f32_16x16x32_bf16 v[32:35], a[200:203], v[24:27], v[32:35]
    v_mfma_f32_16x16x32_bf16 v[36:39], a[212:215], v[24:27], v[36:39]
    v_mfma_f32_16x16x32_bf16 v[40:43], a[224:227], v[24:27], v[40:43]
    v_mfma_f32_16x16x32_bf16 v[44:47], a[236:239], v[24:27], v[44:47]
    s_nop 3
    v_cvt_pk_bf16_f32 v16, v28, v29
    v_cvt_pk_bf16_f32 v17, v30, v31
    v_cvt_pk_bf16_f32 v18, v32, v33
    v_cvt_pk_bf16_f32 v19, v34, v35
    v_cvt_pk_bf16_f32 v20, v36, v37
    v_cvt_pk_bf16_f32 v21, v38, v39
    v_cvt_pk_bf16_f32 v22, v40, v41
    v_cvt_pk_bf16_f32 v23, v42, v43
    v_cvt_pk_bf16_f32 v24, v44, v45
    v_cvt_pk_bf16_f32 v25, v46, v47
    v_lshlrev_b32 v28, 16, v16
    v_and_b32 v29, 0xffff0000, v16
    v_lshlrev_b32 v30, 16, v17
    v_and_b32 v31, 0xffff0000, v17
    v_lshlrev_b32 v32, 16, v18
    v_and_b32 v33, 0xffff0000, v18
    v_lshlrev_b32 v34, 16, v19
    v_and_b32 v35, 0xffff0000, v19
    v_lshlrev_b32 v36, 16, v20
    v_and_b32 v37, 0xffff0000, v20
    v_lshlrev_b32 v38, 16, v21
    v_and_b32 v39, 0xffff0000, v21
    v_lshlrev_b32 v40, 16, v22
    v_and_b32 v41, 0xffff0000, v22
    v_lshlrev_b32 v42, 16, v23
    v_and_b32 v43, 0xffff0000, v23
    v_lshlrev_b32 v44, 16, v24
    v_and_b32 v45, 0xffff0000, v24
    v_lshlrev_b32 v46, 16, v25
    v_and_b32 v47, 0xffff0000, v25
    v_max3_f32 v68, v28, v29, v30
    v_min3_f32 v69, v28, v29, v30
    v_max3_f32 v68, v68, v31, v32
    v_min3_f32 v69, v69, v31, v32
    v_max3_f32 v68, v68, v33, v34
    v_min3_f32 v69, v69, v33, v34
    v_max3_f32 v68, v68, v35, v36
    v_min3_f32 v69, v69, v35, v36
    v_max3_f32 v68, v68, v37, v38
    v_min3_f32 v69, v69, v37, v38
    v_max3_f32 v68, v68, v39, v40
    v_min3_f32 v69, v69, v39, v40
    v_max3_f32 v68, v68, v41, v42
    v_min3_f32 v69, v69, v41, v42
    v_max3_f32 v68, v68, v43, v44
    v_min3_f32 v69, v69, v43, v44
    v_max3_f32 v68, v68, v45, v46
    v_min3_f32 v69, v69, v45, v46
    v_max_f32 v68, v68, v47
    v_min_f32 v69, v69, v47
    v_mul_f32 v68, s31, v68
    v_mul_f32 v69, s31, v69
    v_mov_b32 v73, v68
    v_mov_b32 v72, v68
    v_mov_b32 v75, v69
    v_mov_b32 v74, v69
    v_pk_fma_f32 v[48:49], v[28:29], s[62:63], v[74:75] neg_lo:[1,0,0] neg_hi:[1,0,0]
    v_pk_fma_f32 v[28:29], v[28:29], s[62:63], v[72:73] neg_lo:[0,0,1] neg_hi:[0,0,1]
    v_pk_fma_f32 v[50:51], v[30:31], s[62:63], v[74:75] neg_lo:[1,0,0] neg_hi:[1,0,0]
    v_pk_fma_f32 v[30:31], v[30:31], s[62:63], v[72:73] neg_lo:[0,0,1] neg_hi:[0,0,1]
    v_pk_fma_f32 v[52:53], v[32:33], s[62:63], v[74:75] neg_lo:[1,0,0] neg_hi:[1,0,0]
    v_pk_fma_f32 v[32:33], v[32:33], s[62:63], v[72:73] neg_lo:[0,0,1] neg_hi:[0,0,1]
    v_pk_fma_f32 v[54:55], v[34:35], s[62:63], v[74:75] neg_lo:[1,0,0] neg_hi:[1,0,0]
    v_pk_fma_f32 v[34:35], v[34:35], s[62:63], v[72:73] neg_lo:[0,0,1] neg_hi:[0,0,1]
    v_pk_fma_f32 v[56:57], v[36:37], s[62:63], v[74:75] neg_lo:[1,0,0] neg_hi:[1,0,0]
    v_pk_fma_f32 v[36:37], v[36:37], s[62:63], v[72:73] neg_lo:[0,0,1] neg_hi:[0,0,1]
    v_pk_fma_f32 v[58:59], v[38:39], s[62:63], v[74:75] neg_lo:[1,0,0] neg_hi:[1,0,0]
    v_pk_fma_f32 v[38:39], v[38:39], s[62:63], v[72:73] neg_lo:[0,0,1] neg_hi:[0,0,1]
    v_pk_fma_f32 v[60:61], v[40:41], s[62:63], v[74:75] neg_lo:[1,0,0] neg_hi:[1,0,0]
    v_pk_fma_f32 v[40:41], v[40:41], s[62:63], v[72:73] neg_lo:[0,0,1] neg_hi:[0,0,1]
    v_pk_fma_f32 v[62:63], v[42:43], s[62:63], v[74:75] neg_lo:[1,0,0] neg_hi:[1,0,0]
    v_pk_fma_f32 v[42:43], v[42:43], s[62:63], v[72:73] neg_lo:[0,0,1] neg_hi:[0,0,1]
    v_pk_fma_f32 v[64:65], v[44:45], s[62:63], v[74:75] neg_lo:[1,0,0] neg_hi:[1,0,0]
    v_pk_fma_f32 v[44:45], v[44:45], s[62:63], v[72:73] neg_lo:[0,0,1] neg_hi:[0,0,1]
    v_pk_fma_f32 v[66:67], v[46:47], s[62:63], v[74:75] neg_lo:[1,0,0] neg_hi:[1,0,0]
    v_pk_fma_f32 v[46:47], v[46:47], s[62:63], v[72:73] neg_lo:[0,0,1] neg_hi:[0,0,1]
    v_exp_f32 v28, v28
    v_exp_f32 v48, v48
    v_exp_f32 v29, v29
    v_exp_f32 v49, v49
    v_exp_f32 v30, v30
    v_exp_f32 v50, v50
    v_exp_f32 v31, v31
    v_exp_f32 v51, v51
    v_exp_f32 v32, v32
    v_exp_f32 v52, v52
    v_exp_f32 v33, v33
    v_exp_f32 v53, v53
    v_exp_f32 v34, v34
    v_exp_f32 v54, v54
    v_exp_f32 v35, v35
    v_exp_f32 v55, v55
    v_exp_f32 v36, v36
    v_exp_f32 v56, v56
    v_exp_f32 v37, v37
    v_exp_f32 v57, v57
    v_exp_f32 v38, v38
    v_exp_f32 v58, v58
    v_exp_f32 v39, v39
    v_exp_f32 v59, v59
    v_exp_f32 v40, v40
    v_exp_f32 v60, v60
    v_exp_f32 v41, v41
    v_exp_f32 v61, v61
    v_exp_f32 v42, v42
    v_exp_f32 v62, v62
    v_exp_f32 v43, v43
    v_exp_f32 v63, v63
    v_exp_f32 v44, v44
    v_exp_f32 v64, v64
    v_exp_f32 v45, v45
    v_exp_f32 v65, v65
    v_exp_f32 v46, v46
    v_exp_f32 v66, v66
    v_exp_f32 v47, v47
    v_exp_f32 v67, v67
    v_pk_add_f32 v[72:73], v[28:29], v[30:31]
    v_pk_add_f32 v[74:75], v[48:49], v[50:51]
    v_pk_add_f32 v[72:73], v[72:73], v[32:33]
    v_pk_add_f32 v[74:75], v[74:75], v[52:53]
    v_pk_add_f32 v[72:73], v[72:73], v[34:35]
    v_pk_add_f32 v[74:75], v[74:75], v[54:55]
    v_pk_add_f32 v[72:73], v[72:73], v[36:37]
    v_pk_add_f32 v[74:75], v[74:75], v[56:57]
    v_pk_add_f32 v[72:73], v[72:73], v[38:39]
    v_pk_add_f32 v[74:75], v[74:75], v[58:59]
    v_pk_add_f32 v[72:73], v[72:73], v[40:41]
    v_pk_add_f32 v[74:75], v[74:75], v[60:61]
    v_pk_add_f32 v[72:73], v[72:73], v[42:43]
    v_pk_add_f32 v[74:75], v[74:75], v[62:63]
    v_pk_add_f32 v[72:73], v[72:73], v[44:45]
    v_pk_add_f32 v[74:75], v[74:75], v[64:65]
    v_pk_add_f32 v[72:73], v[72:73], v[46:47]
    v_pk_add_f32 v[74:75], v[74:75], v[66:67]
    v_add_f32 v70, v72, v73
    v_add_f32 v71, v74, v75
    v_rcp_f32 v72, v70
    v_rcp_f32 v74, v71
    v_mov_b32 v73, v72
    v_mov_b32 v75, v74
    v_pk_mul_f32 v[28:29], v[28:29], v[72:73]
    v_pk_mul_f32 v[48:49], v[48:49], v[74:75]
    v_pk_mul_f32 v[30:31], v[30:31], v[72:73]
    v_pk_mul_f32 v[50:51], v[50:51], v[74:75]
    v_pk_mul_f32 v[32:33], v[32:33], v[72:73]
    v_pk_mul_f32 v[52:53], v[52:53], v[74:75]
    v_pk_mul_f32 v[34:35], v[34:35], v[72:73]
    v_pk_mul_f32 v[54:55], v[54:55], v[74:75]
    v_pk_mul_f32 v[36:37], v[36:37], v[72:73]
    v_pk_mul_f32 v[56:57], v[56:57], v[74:75]
    v_pk_mul_f32 v[38:39], v[38:39], v[72:73]
    v_pk_mul_f32 v[58:59], v[58:59], v[74:75]
    v_pk_mul_f32 v[40:41], v[40:41], v[72:73]
    v_pk_mul_f32 v[60:61], v[60:61], v[74:75]
    v_pk_mul_f32 v[42:43], v[42:43], v[72:73]
    v_pk_mul_f32 v[62:63], v[62:63], v[74:75]
    v_pk_mul_f32 v[44:45], v[44:45], v[72:73]
    v_pk_mul_f32 v[64:65], v[64:65], v[74:75]
    v_pk_mul_f32 v[46:47], v[46:47], v[72:73]
    v_pk_mul_f32 v[66:67], v[66:67], v[74:75]
    v_cvt_pk_bf16_f32 v136, v28, v29
    v_cvt_pk_bf16_f32 v146, v48, v49
    v_cvt_pk_bf16_f32 v137, v30, v31
    v_cvt_pk_bf16_f32 v147, v50, v51
    v_cvt_pk_bf16_f32 v138, v32, v33
    v_cvt_pk_bf16_f32 v148, v52, v53
    v_cvt_pk_bf16_f32 v139, v34, v35
    v_cvt_pk_bf16_f32 v149, v54, v55
    v_cvt_pk_bf16_f32 v140, v36, v37
    v_cvt_pk_bf16_f32 v150, v56, v57
    v_cvt_pk_bf16_f32 v141, v38, v39
    v_cvt_pk_bf16_f32 v151, v58, v59
    v_cvt_pk_bf16_f32 v142, v40, v41
    v_cvt_pk_bf16_f32 v152, v60, v61
    v_cvt_pk_bf16_f32 v143, v42, v43
    v_cvt_pk_bf16_f32 v153, v62, v63
    v_cvt_pk_bf16_f32 v144, v44, v45
    v_cvt_pk_bf16_f32 v154, v64, v65
    v_cvt_pk_bf16_f32 v145, v46, v47
    v_cvt_pk_bf16_f32 v155, v66, v67
    s_lshl_b32 s30, s21, 2
    s_cmp_lg_u32 s27, 0
    s_cbranch_scc1 L_pc_w
    s_mov_b32 s29, 0x20000
    s_nop 0
L_pc:
    buffer_load_dword v15, off, s[16:19], s30 offset:32 sc1
    s_waitcnt vmcnt(0)
    v_readfirstlane_b32 s28, v15
    s_nop 0
    s_cmp_ge_u32 s28, 16
    s_cbranch_scc1 L_pc_done
    s_sleep 4
    s_sub_u32 s29, s29, 1
    s_cmp_lg_u32 s29, 0
    s_cbranch_scc1 L_pc
    s_nop 0
L_pc_done:
L_pc_w:
    s_barrier
    v_lshlrev_b32 v15, 4, v0
    s_lshl_b32 s28, s21, 14
    buffer_load_dwordx4 v[216:219], v15, s[12:15], s28 offen sc1
    s_add_u32 s28, s28, 4096
    buffer_load_dwordx4 v[220:223], v15, s[12:15], s28 offen sc1
    s_add_u32 s28, s28, 4096
    buffer_load_dwordx4 v[224:227], v15, s[12:15], s28 offen sc1
    s_add_u32 s28, s28, 4096
    buffer_load_dwordx4 v[228:231], v15, s[12:15], s28 offen sc1
    s_add_u32 s28, s28, 4096
    v_cvt_pk_bf16_f32 v16, v196, v197
    v_cvt_pk_bf16_f32 v17, v198, v199
    v_cvt_pk_bf16_f32 v18, v200, v201
    v_cvt_pk_bf16_f32 v19, v202, v203
    v_cvt_pk_bf16_f32 v20, v204, v205
    v_cvt_pk_bf16_f32 v21, v206, v207
    v_cvt_pk_bf16_f32 v22, v208, v209
    v_cvt_pk_bf16_f32 v23, v210, v211
    v_cvt_pk_bf16_f32 v24, v212, v213
    v_cvt_pk_bf16_f32 v25, v214, v215
    v_mov_b32 v26, 0
    v_mov_b32 v27, 0
    v_mfma_f32_16x16x32_bf16 v[28:31], a[180:183], v[16:19], 0
    v_mfma_f32_16x16x32_bf16 v[32:35], a[192:195], v[16:19], 0
    v_mfma_f32_16x16x32_bf16 v[36:39], a[204:207], v[16:19], 0
    v_mfma_f32_16x16x32_bf16 v[40:43], a[216:219], v[16:19], 0
    v_mfma_f32_16x16x32_bf16 v[44:47], a[228:231], v[16:19], 0
    v_mfma_f32_16x16x32_bf16 v[28:31], a[184:187], v[20:23], v[28:31]
    v_mfma_f32_16x16x32_bf16 v[32:35], a[196:199], v[20:23], v[32:35]
    v_mfma_f32_16x16x32_bf16 v[36:39], a[208:211], v[20:23], v[36:39]
    v_mfma_f32_16x16x32_bf16 v[40:43], a[220:223], v[20:23], v[40:43]
    v_mfma_f32_16x16x32_bf16 v[44:47], a[232:235], v[20:23], v[44:47]
    v_mfma_f32_16x16x32_bf16 v[28:31], a[188:191], v[24:27], v[28:31]
    v_mfma_f32_16x16x32_bf16 v[32:35], a[200:203], v[24:27], v[32:35]
    v_mfma_f32_16x16x32_bf16 v[36:39], a[212:215], v[24:27], v[36:39]
    v_mfma_f32_16x16x32_bf16 v[40:43], a[224:227], v[24:27], v[40:43]
    v_mfma_f32_16x16x32_bf16 v[44:47], a[236:239], v[24:27], v[44:47]
    s_nop 3
    v_cvt_pk_bf16_f32 v16, v28, v29
    v_cvt_pk_bf16_f32 v17, v30, v31
    v_cvt_pk_bf16_f32 v18, v32, v33
    v_cvt_pk_bf16_f32 v19, v34, v35
    v_cvt_pk_bf16_f32 v20, v36, v37
    v_cvt_pk_bf16_f32 v21, v38, v39
    v_cvt_pk_bf16_f32 v22, v40, v41
    v_cvt_pk_bf16_f32 v23, v42, v43
    v_cvt_pk_bf16_f32 v24, v44, v45
    v_cvt_pk_bf16_f32 v25, v46, v47
    v_lshlrev_b32 v28, 16, v16
    v_and_b32 v29, 0xffff0000, v16
    v_lshlrev_b32 v30, 16, v17
    v_and_b32 v31, 0xffff0000, v17
    v_lshlrev_b32 v32, 16, v18
    v_and_b32 v33, 0xffff0000, v18
    v_lshlrev_b32 v34, 16, v19
    v_and_b32 v35, 0xffff0000, v19
    v_lshlrev_b32 v36, 16, v20
    v_and_b32 v37, 0xffff0000, v20
    v_lshlrev_b32 v38, 16, v21
    v_and_b32 v39, 0xffff0000, v21
    v_lshlrev_b32 v40, 16, v22
    v_and_b32 v41, 0xffff0000, v22
    v_lshlrev_b32 v42, 16, v23
    v_and_b32 v43, 0xffff0000, v23
    v_lshlrev_b32 v44, 16, v24
    v_and_b32 v45, 0xffff0000, v24
    v_lshlrev_b32 v46, 16, v25
    v_and_b32 v47, 0xffff0000, v25
    v_max3_f32 v68, v28, v29, v30
    v_min3_f32 v69, v28, v29, v30
    v_max3_f32 v68, v68, v31, v32
    v_min3_f32 v69, v69, v31, v32
    v_max3_f32 v68, v68, v33, v34
    v_min3_f32 v69, v69, v33, v34
    v_max3_f32 v68, v68, v35, v36
    v_min3_f32 v69, v69, v35, v36
    v_max3_f32 v68, v68, v37, v38
    v_min3_f32 v69, v69, v37, v38
    v_max3_f32 v68, v68, v39, v40
    v_min3_f32 v69, v69, v39, v40
    v_max3_f32 v68, v68, v41, v42
    v_min3_f32 v69, v69, v41, v42
    v_max3_f32 v68, v68, v43, v44
    v_min3_f32 v69, v69, v43, v44
    v_max3_f32 v68, v68, v45, v46
    v_min3_f32 v69, v69, v45, v46
    v_max_f32 v68, v68, v47
    v_min_f32 v69, v69, v47
    v_mul_f32 v68, s31, v68
    v_mul_f32 v69, s31, v69
    v_mov_b32 v73, v68
    v_mov_b32 v72, v68
    v_mov_b32 v75, v69
    v_mov_b32 v74, v69
    v_pk_fma_f32 v[48:49], v[28:29], s[62:63], v[74:75] neg_lo:[1,0,0] neg_hi:[1,0,0]
    v_pk_fma_f32 v[28:29], v[28:29], s[62:63], v[72:73] neg_lo:[0,0,1] neg_hi:[0,0,1]
    v_pk_fma_f32 v[50:51], v[30:31], s[62:63], v[74:75] neg_lo:[1,0,0] neg_hi:[1,0,0]
    v_pk_fma_f32 v[30:31], v[30:31], s[62:63], v[72:73] neg_lo:[0,0,1] neg_hi:[0,0,1]
    v_pk_fma_f32 v[52:53], v[32:33], s[62:63], v[74:75] neg_lo:[1,0,0] neg_hi:[1,0,0]
    v_pk_fma_f32 v[32:33], v[32:33], s[62:63], v[72:73] neg_lo:[0,0,1] neg_hi:[0,0,1]
    v_pk_fma_f32 v[54:55], v[34:35], s[62:63], v[74:75] neg_lo:[1,0,0] neg_hi:[1,0,0]
    v_pk_fma_f32 v[34:35], v[34:35], s[62:63], v[72:73] neg_lo:[0,0,1] neg_hi:[0,0,1]
    v_pk_fma_f32 v[56:57], v[36:37], s[62:63], v[74:75] neg_lo:[1,0,0] neg_hi:[1,0,0]
    v_pk_fma_f32 v[36:37], v[36:37], s[62:63], v[72:73] neg_lo:[0,0,1] neg_hi:[0,0,1]
    v_pk_fma_f32 v[58:59], v[38:39], s[62:63], v[74:75] neg_lo:[1,0,0] neg_hi:[1,0,0]
    v_pk_fma_f32 v[38:39], v[38:39], s[62:63], v[72:73] neg_lo:[0,0,1] neg_hi:[0,0,1]
    v_pk_fma_f32 v[60:61], v[40:41], s[62:63], v[74:75] neg_lo:[1,0,0] neg_hi:[1,0,0]
    v_pk_fma_f32 v[40:41], v[40:41], s[62:63], v[72:73] neg_lo:[0,0,1] neg_hi:[0,0,1]
    v_pk_fma_f32 v[62:63], v[42:43], s[62:63], v[74:75] neg_lo:[1,0,0] neg_hi:[1,0,0]
    v_pk_fma_f32 v[42:43], v[42:43], s[62:63], v[72:73] neg_lo:[0,0,1] neg_hi:[0,0,1]
    v_pk_fma_f32 v[64:65], v[44:45], s[62:63], v[74:75] neg_lo:[1,0,0] neg_hi:[1,0,0]
    v_pk_fma_f32 v[44:45], v[44:45], s[62:63], v[72:73] neg_lo:[0,0,1] neg_hi:[0,0,1]
    v_pk_fma_f32 v[66:67], v[46:47], s[62:63], v[74:75] neg_lo:[1,0,0] neg_hi:[1,0,0]
    v_pk_fma_f32 v[46:47], v[46:47], s[62:63], v[72:73] neg_lo:[0,0,1] neg_hi:[0,0,1]
    v_exp_f32 v28, v28
    v_exp_f32 v48, v48
    v_exp_f32 v29, v29
    v_exp_f32 v49, v49
    v_exp_f32 v30, v30
    v_exp_f32 v50, v50
    v_exp_f32 v31, v31
    v_exp_f32 v51, v51
    v_exp_f32 v32, v32
    v_exp_f32 v52, v52
    v_exp_f32 v33, v33
    v_exp_f32 v53, v53
    v_exp_f32 v34, v34
    v_exp_f32 v54, v54
    v_exp_f32 v35, v35
    v_exp_f32 v55, v55
    v_exp_f32 v36, v36
    v_exp_f32 v56, v56
    v_exp_f32 v37, v37
    v_exp_f32 v57, v57
    v_exp_f32 v38, v38
    v_exp_f32 v58, v58
    v_exp_f32 v39, v39
    v_exp_f32 v59, v59
    v_exp_f32 v40, v40
    v_exp_f32 v60, v60
    v_exp_f32 v41, v41
    v_exp_f32 v61, v61
    v_exp_f32 v42, v42
    v_exp_f32 v62, v62
    v_exp_f32 v43, v43
    v_exp_f32 v63, v63
    v_exp_f32 v44, v44
    v_exp_f32 v64, v64
    v_exp_f32 v45, v45
    v_exp_f32 v65, v65
    v_exp_f32 v46, v46
    v_exp_f32 v66, v66
    v_exp_f32 v47, v47
    v_exp_f32 v67, v67
    v_pk_add_f32 v[72:73], v[28:29], v[30:31]
    v_pk_add_f32 v[74:75], v[48:49], v[50:51]
    v_pk_add_f32 v[72:73], v[72:73], v[32:33]
    v_pk_add_f32 v[74:75], v[74:75], v[52:53]
    v_pk_add_f32 v[72:73], v[72:73], v[34:35]
    v_pk_add_f32 v[74:75], v[74:75], v[54:55]
    v_pk_add_f32 v[72:73], v[72:73], v[36:37]
    v_pk_add_f32 v[74:75], v[74:75], v[56:57]
    v_pk_add_f32 v[72:73], v[72:73], v[38:39]
    v_pk_add_f32 v[74:75], v[74:75], v[58:59]
    v_pk_add_f32 v[72:73], v[72:73], v[40:41]
    v_pk_add_f32 v[74:75], v[74:75], v[60:61]
    v_pk_add_f32 v[72:73], v[72:73], v[42:43]
    v_pk_add_f32 v[74:75], v[74:75], v[62:63]
    v_pk_add_f32 v[72:73], v[72:73], v[44:45]
    v_pk_add_f32 v[74:75], v[74:75], v[64:65]
    v_pk_add_f32 v[72:73], v[72:73], v[46:47]
    v_pk_add_f32 v[74:75], v[74:75], v[66:67]
    v_add_f32 v70, v72, v73
    v_add_f32 v71, v74, v75
    v_rcp_f32 v72, v70
    v_rcp_f32 v74, v71
    v_mov_b32 v73, v72
    v_mov_b32 v75, v74
    v_pk_mul_f32 v[28:29], v[28:29], v[72:73]
    v_pk_mul_f32 v[48:49], v[48:49], v[74:75]
    v_pk_mul_f32 v[30:31], v[30:31], v[72:73]
    v_pk_mul_f32 v[50:51], v[50:51], v[74:75]
    v_pk_mul_f32 v[32:33], v[32:33], v[72:73]
    v_pk_mul_f32 v[52:53], v[52:53], v[74:75]
    v_pk_mul_f32 v[34:35], v[34:35], v[72:73]
    v_pk_mul_f32 v[54:55], v[54:55], v[74:75]
    v_pk_mul_f32 v[36:37], v[36:37], v[72:73]
    v_pk_mul_f32 v[56:57], v[56:57], v[74:75]
    v_pk_mul_f32 v[38:39], v[38:39], v[72:73]
    v_pk_mul_f32 v[58:59], v[58:59], v[74:75]
    v_pk_mul_f32 v[40:41], v[40:41], v[72:73]
    v_pk_mul_f32 v[60:61], v[60:61], v[74:75]
    v_pk_mul_f32 v[42:43], v[42:43], v[72:73]
    v_pk_mul_f32 v[62:63], v[62:63], v[74:75]
    v_pk_mul_f32 v[44:45], v[44:45], v[72:73]
    v_pk_mul_f32 v[64:65], v[64:65], v[74:75]
    v_pk_mul_f32 v[46:47], v[46:47], v[72:73]
    v_pk_mul_f32 v[66:67], v[66:67], v[74:75]
    v_cvt_pk_bf16_f32 v156, v28, v29
    v_cvt_pk_bf16_f32 v166, v48, v49
    v_cvt_pk_bf16_f32 v157, v30, v31
    v_cvt_pk_bf16_f32 v167, v50, v51
    v_cvt_pk_bf16_f32 v158, v32, v33
    v_cvt_pk_bf16_f32 v168, v52, v53
    v_cvt_pk_bf16_f32 v159, v34, v35
    v_cvt_pk_bf16_f32 v169, v54, v55
    v_cvt_pk_bf16_f32 v160, v36, v37
    v_cvt_pk_bf16_f32 v170, v56, v57
    v_cvt_pk_bf16_f32 v161, v38, v39
    v_cvt_pk_bf16_f32 v171, v58, v59
    v_cvt_pk_bf16_f32 v162, v40, v41
    v_cvt_pk_bf16_f32 v172, v60, v61
    v_cvt_pk_bf16_f32 v163, v42, v43
    v_cvt_pk_bf16_f32 v173, v62, v63
    v_cvt_pk_bf16_f32 v164, v44, v45
    v_cvt_pk_bf16_f32 v174, v64, v65
    v_cvt_pk_bf16_f32 v165, v46, v47
    v_cvt_pk_bf16_f32 v175, v66, v67
    v_lshlrev_b32 v15, 3, v0
    v_add_u32 v15, 0, v15
    s_waitcnt vmcnt(0)
    v_cvt_pk_bf16_f32 v32, v216, v217
    v_cvt_pk_bf16_f32 v33, v218, v219
    ds_write_b64 v15, v[32:33] offset:0
    v_cvt_pk_bf16_f32 v34, v220, v221
    v_cvt_pk_bf16_f32 v35, v222, v223
    ds_write_b64 v15, v[34:35] offset:2048
    v_cvt_pk_bf16_f32 v36, v224, v225
    v_cvt_pk_bf16_f32 v37, v226, v227
    ds_write_b64 v15, v[36:37] offset:4096
    v_cvt_pk_bf16_f32 v38, v228, v229
    v_cvt_pk_bf16_f32 v39, v230, v231
    ds_write_b64 v15, v[38:39] offset:6144
    v_lshrrev_b32 v16, 2, v3
    v_and_b32 v17, 3, v3
    v_mul_u32_u24 v18, 21, v2
    v_add_u32 v19, v18, v17
    v_mul_u32_u24 v19, 80, v19
    v_add_u32 v19, 0, v19
    v_mul_u32_u24 v18, 80, v18
    v_add_u32 v18, 1600, v18
    v_mov_b32 v20, 154880
    v_cmp_eq_u32 vcc, v16, v2
    s_nop 1
    v_cndmask_b32 v16, v20, v19, vcc
    v_cndmask_b32 v17, v20, v18, vcc
    s_waitcnt lgkmcnt(0)
    s_barrier
    ds_read_b128 v[216:219], v16 offset:0
    ds_read_b128 v[220:223], v16 offset:16
    ds_read_b128 v[224:227], v16 offset:32
    ds_read_b128 v[228:231], v16 offset:48
    ds_read_b128 v[232:235], v16 offset:64
    s_waitcnt lgkmcnt(0)
    v_mfma_f32_16x16x32_bf16 v[40:43], v[216:219], v[136:139], 0
    v_mfma_f32_16x16x32_bf16 v[64:67], v[216:219], v[156:159], 0
    v_mfma_f32_16x16x32_bf16 v[40:43], v[220:223], v[140:143], v[40:43]
    v_mfma_f32_16x16x32_bf16 v[64:67], v[220:223], v[160:163], v[64:67]
    v_mfma_f32_16x16x32_bf16 v[40:43], v[224:227], v[144:147], v[40:43]
    v_mfma_f32_16x16x32_bf16 v[64:67], v[224:227], v[164:167], v[64:67]
    v_mfma_f32_16x16x32_bf16 v[40:43], v[228:231], v[148:151], v[40:43]
    v_mfma_f32_16x16x32_bf16 v[64:67], v[228:231], v[168:171], v[64:67]
    v_mfma_f32_16x16x32_bf16 v[40:43], v[232:235], v[152:155], v[40:43]
    v_mfma_f32_16x16x32_bf16 v[64:67], v[232:235], v[172:175], v[64:67]
    ds_read_b128 v[236:239], v16 offset:320
    ds_read_b128 v[240:243], v16 offset:336
    ds_read_b128 v[244:247], v16 offset:352
    ds_read_b128 v[248:251], v16 offset:368
    ds_read_b128 v[252:255], v16 offset:384
    s_waitcnt lgkmcnt(0)
    v_mfma_f32_16x16x32_bf16 v[44:47], v[236:239], v[136:139], 0
    v_mfma_f32_16x16x32_bf16 v[68:71], v[236:239], v[156:159], 0
    v_mfma_f32_16x16x32_bf16 v[44:47], v[240:243], v[140:143], v[44:47]
    v_mfma_f32_16x16x32_bf16 v[68:71], v[240:243], v[160:163], v[68:71]
    v_mfma_f32_16x16x32_bf16 v[44:47], v[244:247], v[144:147], v[44:47]
    v_mfma_f32_16x16x32_bf16 v[68:71], v[244:247], v[164:167], v[68:71]
    v_mfma_f32_16x16x32_bf16 v[44:47], v[248:251], v[148:151], v[44:47]
    v_mfma_f32_16x16x32_bf16 v[68:71], v[248:251], v[168:171], v[68:71]
    v_mfma_f32_16x16x32_bf16 v[44:47], v[252:255], v[152:155], v[44:47]
    v_mfma_f32_16x16x32_bf16 v[68:71], v[252:255], v[172:175], v[68:71]
    ds_read_b128 v[216:219], v16 offset:640
    ds_read_b128 v[220:223], v16 offset:656
    ds_read_b128 v[224:227], v16 offset:672
    ds_read_b128 v[228:231], v16 offset:688
    ds_read_b128 v[232:235], v16 offset:704
    s_waitcnt lgkmcnt(0)
    v_mfma_f32_16x16x32_bf16 v[48:51], v[216:219], v[136:139], 0
    v_mfma_f32_16x16x32_bf16 v[72:75], v[216:219], v[156:159], 0
    v_mfma_f32_16x16x32_bf16 v[48:51], v[220:223], v[140:143], v[48:51]
    v_mfma_f32_16x16x32_bf16 v[72:75], v[220:223], v[160:163], v[72:75]
    v_mfma_f32_16x16x32_bf16 v[48:51], v[224:227], v[144:147], v[48:51]
    v_mfma_f32_16x16x32_bf16 v[72:75], v[224:227], v[164:167], v[72:75]
    v_mfma_f32_16x16x32_bf16 v[48:51], v[228:231], v[148:151], v[48:51]
    v_mfma_f32_16x16x32_bf16 v[72:75], v[228:231], v[168:171], v[72:75]
    v_mfma_f32_16x16x32_bf16 v[48:51], v[232:235], v[152:155], v[48:51]
    v_mfma_f32_16x16x32_bf16 v[72:75], v[232:235], v[172:175], v[72:75]
    ds_read_b128 v[236:239], v16 offset:960
    ds_read_b128 v[240:243], v16 offset:976
    ds_read_b128 v[244:247], v16 offset:992
    ds_read_b128 v[248:251], v16 offset:1008
    ds_read_b128 v[252:255], v16 offset:1024
    s_waitcnt lgkmcnt(0)
    v_mfma_f32_16x16x32_bf16 v[52:55], v[236:239], v[136:139], 0
    v_mfma_f32_16x16x32_bf16 v[76:79], v[236:239], v[156:159], 0
    v_mfma_f32_16x16x32_bf16 v[52:55], v[240:243], v[140:143], v[52:55]
    v_mfma_f32_16x16x32_bf16 v[76:79], v[240:243], v[160:163], v[76:79]
    v_mfma_f32_16x16x32_bf16 v[52:55], v[244:247], v[144:147], v[52:55]
    v_mfma_f32_16x16x32_bf16 v[76:79], v[244:247], v[164:167], v[76:79]
    v_mfma_f32_16x16x32_bf16 v[52:55], v[248:251], v[148:151], v[52:55]
    v_mfma_f32_16x16x32_bf16 v[76:79], v[248:251], v[168:171], v[76:79]
    v_mfma_f32_16x16x32_bf16 v[52:55], v[252:255], v[152:155], v[52:55]
    v_mfma_f32_16x16x32_bf16 v[76:79], v[252:255], v[172:175], v[76:79]
    ds_read_b128 v[216:219], v16 offset:1280
    ds_read_b128 v[220:223], v16 offset:1296
    ds_read_b128 v[224:227], v16 offset:1312
    ds_read_b128 v[228:231], v16 offset:1328
    ds_read_b128 v[232:235], v16 offset:1344
    s_waitcnt lgkmcnt(0)
    v_mfma_f32_16x16x32_bf16 v[56:59], v[216:219], v[136:139], 0
    v_mfma_f32_16x16x32_bf16 v[80:83], v[216:219], v[156:159], 0
    v_mfma_f32_16x16x32_bf16 v[56:59], v[220:223], v[140:143], v[56:59]
    v_mfma_f32_16x16x32_bf16 v[80:83], v[220:223], v[160:163], v[80:83]
    v_mfma_f32_16x16x32_bf16 v[56:59], v[224:227], v[144:147], v[56:59]
    v_mfma_f32_16x16x32_bf16 v[80:83], v[224:227], v[164:167], v[80:83]
    v_mfma_f32_16x16x32_bf16 v[56:59], v[228:231], v[148:151], v[56:59]
    v_mfma_f32_16x16x32_bf16 v[80:83], v[228:231], v[168:171], v[80:83]
    v_mfma_f32_16x16x32_bf16 v[56:59], v[232:235], v[152:155], v[56:59]
    v_mfma_f32_16x16x32_bf16 v[80:83], v[232:235], v[172:175], v[80:83]
    ds_read_b128 v[236:239], v17 offset:0
    ds_read_b128 v[240:243], v17 offset:16
    ds_read_b128 v[244:247], v17 offset:32
    ds_read_b128 v[248:251], v17 offset:48
    ds_read_b128 v[252:255], v17 offset:64
    s_waitcnt lgkmcnt(0)
    v_mfma_f32_16x16x32_bf16 v[60:63], v[236:239], v[136:139], 0
    v_mfma_f32_16x16x32_bf16 v[84:87], v[236:239], v[156:159], 0
    v_mfma_f32_16x16x32_bf16 v[60:63], v[240:243], v[140:143], v[60:63]
    v_mfma_f32_16x16x32_bf16 v[84:87], v[240:243], v[160:163], v[84:87]
    v_mfma_f32_16x16x32_bf16 v[60:63], v[244:247], v[144:147], v[60:63]
    v_mfma_f32_16x16x32_bf16 v[84:87], v[244:247], v[164:167], v[84:87]
    v_mfma_f32_16x16x32_bf16 v[60:63], v[248:251], v[148:151], v[60:63]
    v_mfma_f32_16x16x32_bf16 v[84:87], v[248:251], v[168:171], v[84:87]
    v_mfma_f32_16x16x32_bf16 v[60:63], v[252:255], v[152:155], v[60:63]
    v_mfma_f32_16x16x32_bf16 v[84:87], v[252:255], v[172:175], v[84:87]
    s_lshl_b32 s22, s20, 3
    s_lshl_b32 s28, s27, 1
    s_add_u32 s22, s22, s28
    s_mul_i32 s22, s22, 20480
    s_add_u32 s22, s22, 0x40000
    s_lshr_b32 s28, s21, 1
    s_mul_i32 s28, s28, 5120
    s_add_u32 s22, s22, s28
    s_add_u32 s23, s22, 2048
    s_and_b32 s28, s21, 1
    s_mul_i32 s29, s28, 3072
    s_add_u32 s22, s22, s29
    s_lshl_b32 s28, s28, 3
    s_add_u32 s23, s23, s28
    v_lshlrev_b32 v15, 4, v1
    v_cvt_pk_bf16_f32 v60, v60, v60
    v_lshlrev_b32 v60, 16, v60
    v_add_f32 v60, 0x358637bd, v60
    v_cvt_pk_bf16_f32 v60, v60, v60
    v_lshlrev_b32 v60, 16, v60
    v_rcp_f32 v60, v60
    v_cvt_pk_bf16_f32 v100, v40, v41
    v_cvt_pk_bf16_f32 v101, v42, v43
    v_cvt_pk_bf16_f32 v102, v44, v45
    v_cvt_pk_bf16_f32 v103, v46, v47
    v_cvt_pk_bf16_f32 v104, v48, v49
    v_cvt_pk_bf16_f32 v105, v50, v51
    v_cvt_pk_bf16_f32 v106, v52, v53
    v_cvt_pk_bf16_f32 v107, v54, v55
    v_cvt_pk_bf16_f32 v108, v56, v57
    v_cvt_pk_bf16_f32 v109, v58, v59
    v_lshlrev_b32 v40, 16, v100
    v_and_b32 v41, 0xffff0000, v100
    v_lshlrev_b32 v42, 16, v101
    v_and_b32 v43, 0xffff0000, v101
    v_lshlrev_b32 v44, 16, v102
    v_and_b32 v45, 0xffff0000, v102
    v_lshlrev_b32 v46, 16, v103
    v_and_b32 v47, 0xffff0000, v103
    v_lshlrev_b32 v48, 16, v104
    v_and_b32 v49, 0xffff0000, v104
    v_lshlrev_b32 v50, 16, v105
    v_and_b32 v51, 0xffff0000, v105
    v_lshlrev_b32 v52, 16, v106
    v_and_b32 v53, 0xffff0000, v106
    v_lshlrev_b32 v54, 16, v107
    v_and_b32 v55, 0xffff0000, v107
    v_lshlrev_b32 v56, 16, v108
    v_and_b32 v57, 0xffff0000, v108
    v_lshlrev_b32 v58, 16, v109
    v_and_b32 v59, 0xffff0000, v109
    v_mul_f32 v40, v40, v60
    v_mul_f32 v41, v41, v60
    v_mul_f32 v42, v42, v60
    v_mul_f32 v43, v43, v60
    v_mul_f32 v44, v44, v60
    v_mul_f32 v45, v45, v60
    v_mul_f32 v46, v46, v60
    v_mul_f32 v47, v47, v60
    v_mul_f32 v48, v48, v60
    v_mul_f32 v49, v49, v60
    v_mul_f32 v50, v50, v60
    v_mul_f32 v51, v51, v60
    v_mul_f32 v52, v52, v60
    v_mul_f32 v53, v53, v60
    v_mul_f32 v54, v54, v60
    v_mul_f32 v55, v55, v60
    v_mul_f32 v56, v56, v60
    v_mul_f32 v57, v57, v60
    v_mul_f32 v58, v58, v60
    v_mul_f32 v59, v59, v60
    v_cvt_pk_bf16_f32 v100, v40, v41
    v_cvt_pk_bf16_f32 v101, v42, v43
    v_cvt_pk_bf16_f32 v102, v44, v45
    v_cvt_pk_bf16_f32 v103, v46, v47
    v_cvt_pk_bf16_f32 v104, v48, v49
    v_cvt_pk_bf16_f32 v105, v50, v51
    v_cvt_pk_bf16_f32 v106, v52, v53
    v_cvt_pk_bf16_f32 v107, v54, v55
    v_cvt_pk_bf16_f32 v108, v56, v57
    v_cvt_pk_bf16_f32 v109, v58, v59
    buffer_store_dwordx4 v[100:103], v15, s[12:15], s22 offen offset:0 sc0 sc1
    buffer_store_dwordx4 v[104:107], v15, s[12:15], s22 offen offset:1024 sc0 sc1
    buffer_store_dwordx2 v[108:109], v15, s[12:15], s23 offen sc0 sc1
    s_add_u32 s22, s22, 20480
    s_add_u32 s23, s23, 20480
    v_cvt_pk_bf16_f32 v84, v84, v84
    v_lshlrev_b32 v84, 16, v84
    v_add_f32 v84, 0x358637bd, v84
    v_cvt_pk_bf16_f32 v84, v84, v84
    v_lshlrev_b32 v84, 16, v84
    v_rcp_f32 v84, v84
    v_cvt_pk_bf16_f32 v112, v64, v65
    v_cvt_pk_bf16_f32 v113, v66, v67
    v_cvt_pk_bf16_f32 v114, v68, v69
    v_cvt_pk_bf16_f32 v115, v70, v71
    v_cvt_pk_bf16_f32 v116, v72, v73
    v_cvt_pk_bf16_f32 v117, v74, v75
    v_cvt_pk_bf16_f32 v118, v76, v77
    v_cvt_pk_bf16_f32 v119, v78, v79
    v_cvt_pk_bf16_f32 v120, v80, v81
    v_cvt_pk_bf16_f32 v121, v82, v83
    v_lshlrev_b32 v64, 16, v112
    v_and_b32 v65, 0xffff0000, v112
    v_lshlrev_b32 v66, 16, v113
    v_and_b32 v67, 0xffff0000, v113
    v_lshlrev_b32 v68, 16, v114
    v_and_b32 v69, 0xffff0000, v114
    v_lshlrev_b32 v70, 16, v115
    v_and_b32 v71, 0xffff0000, v115
    v_lshlrev_b32 v72, 16, v116
    v_and_b32 v73, 0xffff0000, v116
    v_lshlrev_b32 v74, 16, v117
    v_and_b32 v75, 0xffff0000, v117
    v_lshlrev_b32 v76, 16, v118
    v_and_b32 v77, 0xffff0000, v118
    v_lshlrev_b32 v78, 16, v119
    v_and_b32 v79, 0xffff0000, v119
    v_lshlrev_b32 v80, 16, v120
    v_and_b32 v81, 0xffff0000, v120
    v_lshlrev_b32 v82, 16, v121
    v_and_b32 v83, 0xffff0000, v121
    v_mul_f32 v64, v64, v84
    v_mul_f32 v65, v65, v84
    v_mul_f32 v66, v66, v84
    v_mul_f32 v67, v67, v84
    v_mul_f32 v68, v68, v84
    v_mul_f32 v69, v69, v84
    v_mul_f32 v70, v70, v84
    v_mul_f32 v71, v71, v84
    v_mul_f32 v72, v72, v84
    v_mul_f32 v73, v73, v84
    v_mul_f32 v74, v74, v84
    v_mul_f32 v75, v75, v84
    v_mul_f32 v76, v76, v84
    v_mul_f32 v77, v77, v84
    v_mul_f32 v78, v78, v84
    v_mul_f32 v79, v79, v84
    v_mul_f32 v80, v80, v84
    v_mul_f32 v81, v81, v84
    v_mul_f32 v82, v82, v84
    v_mul_f32 v83, v83, v84
    v_cvt_pk_bf16_f32 v112, v64, v65
    v_cvt_pk_bf16_f32 v113, v66, v67
    v_cvt_pk_bf16_f32 v114, v68, v69
    v_cvt_pk_bf16_f32 v115, v70, v71
    v_cvt_pk_bf16_f32 v116, v72, v73
    v_cvt_pk_bf16_f32 v117, v74, v75
    v_cvt_pk_bf16_f32 v118, v76, v77
    v_cvt_pk_bf16_f32 v119, v78, v79
    v_cvt_pk_bf16_f32 v120, v80, v81
    v_cvt_pk_bf16_f32 v121, v82, v83
    buffer_store_dwordx4 v[112:115], v15, s[12:15], s22 offen offset:0 sc0 sc1
    buffer_store_dwordx4 v[116:119], v15, s[12:15], s22 offen offset:1024 sc0 sc1
    buffer_store_dwordx2 v[120:121], v15, s[12:15], s23 offen sc0 sc1
    s_branch L_p2
    s_nop 0
L_k1_B:
    s_lshl_b32 s28, s20, 7
    s_sub_u32 s28, s28, 16
    v_add_u32 v14, s28, v3
    v_mul_i32_i24 v14, 1280, v14
    v_lshl_add_u32 v14, v2, 4, v14
    s_add_u32 s28, s87, 0
    s_cmp_ge_u32 s28, 20
    s_cselect_b32 s29, 20, 0
    s_sub_u32 s28, s28, s29
    s_lshl_b32 s28, s28, 6
    buffer_load_dwordx4 a[160:163], v14, s[4:7], s28 offen
    s_add_u32 s28, s87, 4
    s_cmp_ge_u32 s28, 20
    s_cselect_b32 s29, 20, 0
    s_sub_u32 s28, s28, s29
    s_lshl_b32 s28, s28, 6
    buffer_load_dwordx4 a[164:167], v14, s[4:7], s28 offen
    s_add_u32 s28, s87, 8
    s_cmp_ge_u32 s28, 20
    s_cselect_b32 s29, 20, 0
    s_sub_u32 s28, s28, s29
    s_lshl_b32 s28, s28, 6
    buffer_load_dwordx4 a[168:171], v14, s[4:7], s28 offen
    s_add_u32 s28, s87, 12
    s_cmp_ge_u32 s28, 20
    s_cselect_b32 s29, 20, 0
    s_sub_u32 s28, s28, s29
    s_lshl_b32 s28, s28, 6
    buffer_load_dwordx4 a[172:175], v14, s[4:7], s28 offen
    s_add_u32 s28, s87, 16
    s_cmp_ge_u32 s28, 20
    s_cselect_b32 s29, 20, 0
    s_sub_u32 s28, s28, s29
    s_lshl_b32 s28, s28, 6
    buffer_load_dwordx4 a[176:179], v14, s[4:7], s28 offen
    v_mov_b32 v216, 0
    v_mov_b32 v217, 0
    v_mov_b32 v218, 0
    v_mov_b32 v219, 0
    v_mov_b32 v220, 0
    v_mov_b32 v221, 0
    v_mov_b32 v222, 0
    v_mov_b32 v223, 0
    v_mov_b32 v224, 0
    v_mov_b32 v225, 0
    v_mov_b32 v226, 0
    v_mov_b32 v227, 0
    v_mov_b32 v228, 0
    v_mov_b32 v229, 0
    v_mov_b32 v230, 0
    v_mov_b32 v231, 0
    v_mov_b32 v232, 0
    v_mov_b32 v233, 0
    v_mov_b32 v234, 0
    v_mov_b32 v235, 0
    v_mov_b32 v236, 0
    v_mov_b32 v237, 0
    v_mov_b32 v238, 0
    v_mov_b32 v239, 0
    v_mov_b32 v240, 0
    v_mov_b32 v241, 0
    v_mov_b32 v242, 0
    v_mov_b32 v243, 0
    v_mov_b32 v244, 0
    v_mov_b32 v245, 0
    v_mov_b32 v246, 0
    v_mov_b32 v247, 0
    v_mov_b32 v248, 0
    v_mov_b32 v249, 0
    v_mov_b32 v250, 0
    v_mov_b32 v251, 0
    v_mov_b32 v252, 0
    v_mov_b32 v253, 0
    v_mov_b32 v254, 0
    v_mov_b32 v255, 0
    s_mov_b32 s32, s78
    s_mov_b32 s33, s79
    s_mov_b32 s34, 0x500
    s_mov_b32 s35, 0x00020000
    v_lshrrev_b32 v14, 4, v0
    s_lshl_b32 s28, s20, 7
    s_lshl_b32 s29, s21, 4
    s_add_u32 s28, s28, s29
    v_add_u32 v14, s28, v14
    v_mul_u32_u24 v15, 1280, v14
    v_lshl_add_u32 v15, v3, 4, v15
    v_lshlrev_b32 v16, 4, v3
    buffer_load_dwordx4 v[20:23], v15, s[4:7], 0 offen offset:0
    buffer_load_dwordx4 v[40:43], v16, s[32:35], 0 offen offset:0
    buffer_load_dwordx4 v[24:27], v15, s[4:7], 0 offen offset:256
    buffer_load_dwordx4 v[44:47], v16, s[32:35], 0 offen offset:256
    buffer_load_dwordx4 v[28:31], v15, s[4:7], 0 offen offset:512
    buffer_load_dwordx4 v[48:51], v16, s[32:35], 0 offen offset:512
    buffer_load_dwordx4 v[32:35], v15, s[4:7], 0 offen offset:768
    buffer_load_dwordx4 v[52:55], v16, s[32:35], 0 offen offset:768
    buffer_load_dwordx4 v[36:39], v15, s[4:7], 0 offen offset:1024
    buffer_load_dwordx4 v[56:59], v16, s[32:35], 0 offen offset:1024
    s_waitcnt vmcnt(0)
    v_mov_b32 v60, 0
    v_mov_b32 v61, 0
    v_lshlrev_b32 v62, 16, v20
    v_and_b32 v63, 0xffff0000, v20
    v_lshlrev_b32 v64, 16, v40
    v_and_b32 v65, 0xffff0000, v40
    v_mul_f32 v62, v62, v64
    v_mul_f32 v63, v63, v65
    v_cvt_pk_bf16_f32 v62, v62, v63
    v_lshlrev_b32 v63, 16, v62
    v_and_b32 v62, 0xffff0000, v62
    v_add_f32 v60, v60, v63
    v_add_f32 v61, v61, v62
    v_lshlrev_b32 v62, 16, v21
    v_and_b32 v63, 0xffff0000, v21
    v_lshlrev_b32 v64, 16, v41
    v_and_b32 v65, 0xffff0000, v41
    v_mul_f32 v62, v62, v64
    v_mul_f32 v63, v63, v65
    v_cvt_pk_bf16_f32 v62, v62, v63
    v_lshlrev_b32 v63, 16, v62
    v_and_b32 v62, 0xffff0000, v62
    v_add_f32 v60, v60, v63
    v_add_f32 v61, v61, v62
    v_lshlrev_b32 v62, 16, v22
    v_and_b32 v63, 0xffff0000, v22
    v_lshlrev_b32 v64, 16, v42
    v_and_b32 v65, 0xffff0000, v42
    v_mul_f32 v62, v62, v64
    v_mul_f32 v63, v63, v65
    v_cvt_pk_bf16_f32 v62, v62, v63
    v_lshlrev_b32 v63, 16, v62
    v_and_b32 v62, 0xffff0000, v62
    v_add_f32 v60, v60, v63
    v_add_f32 v61, v61, v62
    v_lshlrev_b32 v62, 16, v23
    v_and_b32 v63, 0xffff0000, v23
    v_lshlrev_b32 v64, 16, v43
    v_and_b32 v65, 0xffff0000, v43
    v_mul_f32 v62, v62, v64
    v_mul_f32 v63, v63, v65
    v_cvt_pk_bf16_f32 v62, v62, v63
    v_lshlrev_b32 v63, 16, v62
    v_and_b32 v62, 0xffff0000, v62
    v_add_f32 v60, v60, v63
    v_add_f32 v61, v61, v62
    v_lshlrev_b32 v62, 16, v24
    v_and_b32 v63, 0xffff0000, v24
    v_lshlrev_b32 v64, 16, v44
    v_and_b32 v65, 0xffff0000, v44
    v_mul_f32 v62, v62, v64
    v_mul_f32 v63, v63, v65
    v_cvt_pk_bf16_f32 v62, v62, v63
    v_lshlrev_b32 v63, 16, v62
    v_and_b32 v62, 0xffff0000, v62
    v_add_f32 v60, v60, v63
    v_add_f32 v61, v61, v62
    v_lshlrev_b32 v62, 16, v25
    v_and_b32 v63, 0xffff0000, v25
    v_lshlrev_b32 v64, 16, v45
    v_and_b32 v65, 0xffff0000, v45
    v_mul_f32 v62, v62, v64
    v_mul_f32 v63, v63, v65
    v_cvt_pk_bf16_f32 v62, v62, v63
    v_lshlrev_b32 v63, 16, v62
    v_and_b32 v62, 0xffff0000, v62
    v_add_f32 v60, v60, v63
    v_add_f32 v61, v61, v62
    v_lshlrev_b32 v62, 16, v26
    v_and_b32 v63, 0xffff0000, v26
    v_lshlrev_b32 v64, 16, v46
    v_and_b32 v65, 0xffff0000, v46
    v_mul_f32 v62, v62, v64
    v_mul_f32 v63, v63, v65
    v_cvt_pk_bf16_f32 v62, v62, v63
    v_lshlrev_b32 v63, 16, v62
    v_and_b32 v62, 0xffff0000, v62
    v_add_f32 v60, v60, v63
    v_add_f32 v61, v61, v62
    v_lshlrev_b32 v62, 16, v27
    v_and_b32 v63, 0xffff0000, v27
    v_lshlrev_b32 v64, 16, v47
    v_and_b32 v65, 0xffff0000, v47
    v_mul_f32 v62, v62, v64
    v_mul_f32 v63, v63, v65
    v_cvt_pk_bf16_f32 v62, v62, v63
    v_lshlrev_b32 v63, 16, v62
    v_and_b32 v62, 0xffff0000, v62
    v_add_f32 v60, v60, v63
    v_add_f32 v61, v61, v62
    v_lshlrev_b32 v62, 16, v28
    v_and_b32 v63, 0xffff0000, v28
    v_lshlrev_b32 v64, 16, v48
    v_and_b32 v65, 0xffff0000, v48
    v_mul_f32 v62, v62, v64
    v_mul_f32 v63, v63, v65
    v_cvt_pk_bf16_f32 v62, v62, v63
    v_lshlrev_b32 v63, 16, v62
    v_and_b32 v62, 0xffff0000, v62
    v_add_f32 v60, v60, v63
    v_add_f32 v61, v61, v62
    v_lshlrev_b32 v62, 16, v29
    v_and_b32 v63, 0xffff0000, v29
    v_lshlrev_b32 v64, 16, v49
    v_and_b32 v65, 0xffff0000, v49
    v_mul_f32 v62, v62, v64
    v_mul_f32 v63, v63, v65
    v_cvt_pk_bf16_f32 v62, v62, v63
    v_lshlrev_b32 v63, 16, v62
    v_and_b32 v62, 0xffff0000, v62
    v_add_f32 v60, v60, v63
    v_add_f32 v61, v61, v62
    v_lshlrev_b32 v62, 16, v30
    v_and_b32 v63, 0xffff0000, v30
    v_lshlrev_b32 v64, 16, v50
    v_and_b32 v65, 0xffff0000, v50
    v_mul_f32 v62, v62, v64
    v_mul_f32 v63, v63, v65
    v_cvt_pk_bf16_f32 v62, v62, v63
    v_lshlrev_b32 v63, 16, v62
    v_and_b32 v62, 0xffff0000, v62
    v_add_f32 v60, v60, v63
    v_add_f32 v61, v61, v62
    v_lshlrev_b32 v62, 16, v31
    v_and_b32 v63, 0xffff0000, v31
    v_lshlrev_b32 v64, 16, v51
    v_and_b32 v65, 0xffff0000, v51
    v_mul_f32 v62, v62, v64
    v_mul_f32 v63, v63, v65
    v_cvt_pk_bf16_f32 v62, v62, v63
    v_lshlrev_b32 v63, 16, v62
    v_and_b32 v62, 0xffff0000, v62
    v_add_f32 v60, v60, v63
    v_add_f32 v61, v61, v62
    v_lshlrev_b32 v62, 16, v32
    v_and_b32 v63, 0xffff0000, v32
    v_lshlrev_b32 v64, 16, v52
    v_and_b32 v65, 0xffff0000, v52
    v_mul_f32 v62, v62, v64
    v_mul_f32 v63, v63, v65
    v_cvt_pk_bf16_f32 v62, v62, v63
    v_lshlrev_b32 v63, 16, v62
    v_and_b32 v62, 0xffff0000, v62
    v_add_f32 v60, v60, v63
    v_add_f32 v61, v61, v62
    v_lshlrev_b32 v62, 16, v33
    v_and_b32 v63, 0xffff0000, v33
    v_lshlrev_b32 v64, 16, v53
    v_and_b32 v65, 0xffff0000, v53
    v_mul_f32 v62, v62, v64
    v_mul_f32 v63, v63, v65
    v_cvt_pk_bf16_f32 v62, v62, v63
    v_lshlrev_b32 v63, 16, v62
    v_and_b32 v62, 0xffff0000, v62
    v_add_f32 v60, v60, v63
    v_add_f32 v61, v61, v62
    v_lshlrev_b32 v62, 16, v34
    v_and_b32 v63, 0xffff0000, v34
    v_lshlrev_b32 v64, 16, v54
    v_and_b32 v65, 0xffff0000, v54
    v_mul_f32 v62, v62, v64
    v_mul_f32 v63, v63, v65
    v_cvt_pk_bf16_f32 v62, v62, v63
    v_lshlrev_b32 v63, 16, v62
    v_and_b32 v62, 0xffff0000, v62
    v_add_f32 v60, v60, v63
    v_add_f32 v61, v61, v62
    v_lshlrev_b32 v62, 16, v35
    v_and_b32 v63, 0xffff0000, v35
    v_lshlrev_b32 v64, 16, v55
    v_and_b32 v65, 0xffff0000, v55
    v_mul_f32 v62, v62, v64
    v_mul_f32 v63, v63, v65
    v_cvt_pk_bf16_f32 v62, v62, v63
    v_lshlrev_b32 v63, 16, v62
    v_and_b32 v62, 0xffff0000, v62
    v_add_f32 v60, v60, v63
    v_add_f32 v61, v61, v62
    v_lshlrev_b32 v62, 16, v36
    v_and_b32 v63, 0xffff0000, v36
    v_lshlrev_b32 v64, 16, v56
    v_and_b32 v65, 0xffff0000, v56
    v_mul_f32 v62, v62, v64
    v_mul_f32 v63, v63, v65
    v_cvt_pk_bf16_f32 v62, v62, v63
    v_lshlrev_b32 v63, 16, v62
    v_and_b32 v62, 0xffff0000, v62
    v_add_f32 v60, v60, v63
    v_add_f32 v61, v61, v62
    v_lshlrev_b32 v62, 16, v37
    v_and_b32 v63, 0xffff0000, v37
    v_lshlrev_b32 v64, 16, v57
    v_and_b32 v65, 0xffff0000, v57
    v_mul_f32 v62, v62, v64
    v_mul_f32 v63, v63, v65
    v_cvt_pk_bf16_f32 v62, v62, v63
    v_lshlrev_b32 v63, 16, v62
    v_and_b32 v62, 0xffff0000, v62
    v_add_f32 v60, v60, v63
    v_add_f32 v61, v61, v62
    v_lshlrev_b32 v62, 16, v38
    v_and_b32 v63, 0xffff0000, v38
    v_lshlrev_b32 v64, 16, v58
    v_and_b32 v65, 0xffff0000, v58
    v_mul_f32 v62, v62, v64
    v_mul_f32 v63, v63, v65
    v_cvt_pk_bf16_f32 v62, v62, v63
    v_lshlrev_b32 v63, 16, v62
    v_and_b32 v62, 0xffff0000, v62
    v_add_f32 v60, v60, v63
    v_add_f32 v61, v61, v62
    v_lshlrev_b32 v62, 16, v39
    v_and_b32 v63, 0xffff0000, v39
    v_lshlrev_b32 v64, 16, v59
    v_and_b32 v65, 0xffff0000, v59
    v_mul_f32 v62, v62, v64
    v_mul_f32 v63, v63, v65
    v_cvt_pk_bf16_f32 v62, v62, v63
    v_lshlrev_b32 v63, 16, v62
    v_and_b32 v62, 0xffff0000, v62
    v_add_f32 v60, v60, v63
    v_add_f32 v61, v61, v62
    v_add_f32 v60, v60, v61
    s_nop 1
    v_add_f32_dpp v60, v60, v60 row_ror:8 row_mask:0xf bank_mask:0xf
    s_nop 1
    v_add_f32_dpp v60, v60, v60 row_ror:4 row_mask:0xf bank_mask:0xf
    s_nop 1
    v_add_f32_dpp v60, v60, v60 row_ror:2 row_mask:0xf bank_mask:0xf
    s_nop 1
    v_add_f32_dpp v60, v60, v60 row_ror:1 row_mask:0xf bank_mask:0xf
    v_cvt_pk_bf16_f32 v60, v60, v60
    v_lshlrev_b32 v60, 16, v60
    v_mul_f32 v60, s31, v60
    v_exp_f32 v60, -v60
    s_nop 0
    v_add_f32 v60, 1.0, v60
    v_rcp_f32 v60, v60
    s_nop 0
    v_cvt_pk_bf16_f32 v60, v60, v60
    v_lshlrev_b32 v60, 16, v60
    v_lshlrev_b32 v14, 2, v14
    v_cmp_eq_u32 vcc, 0, v3
    s_nop 0
    s_and_saveexec_b64 s[28:29], vcc
    s_mov_b32 s36, 0x20000
    buffer_store_dword v60, v14, s[12:15], s36 offen sc0 sc1
    s_mov_b64 exec, s[28:29]
    v_lshlrev_b32 v14, 2, v2
    v_sub_u32 v14, v3, v14
    v_subrev_u32 v15, 0, v14
    v_and_b32 v16, 1, v15
    v_cmp_eq_u32 vcc, 0, v16
    v_cmp_le_i32 s[28:29], 0, v15
    s_nop 0
    s_and_b64 s[32:33], vcc, s[28:29]
    v_cmp_ge_i32 s[28:29], -2, v15
    s_nop 0
    s_and_b64 s[40:41], vcc, s[28:29]
    v_subrev_u32 v15, 1, v14
    v_and_b32 v16, 1, v15
    v_cmp_eq_u32 vcc, 0, v16
    v_cmp_le_i32 s[28:29], 0, v15
    s_nop 0
    s_and_b64 s[34:35], vcc, s[28:29]
    v_cmp_ge_i32 s[28:29], -2, v15
    s_nop 0
    s_and_b64 s[42:43], vcc, s[28:29]
    v_subrev_u32 v15, 2, v14
    v_and_b32 v16, 1, v15
    v_cmp_eq_u32 vcc, 0, v16
    v_cmp_le_i32 s[28:29], 0, v15
    s_nop 0
    s_and_b64 s[36:37], vcc, s[28:29]
    v_cmp_ge_i32 s[28:29], -2, v15
    s_nop 0
    s_and_b64 s[44:45], vcc, s[28:29]
    v_subrev_u32 v15, 3, v14
    v_and_b32 v16, 1, v15
    v_cmp_eq_u32 vcc, 0, v16
    v_cmp_le_i32 s[28:29], 0, v15
    s_nop 0
    s_and_b64 s[38:39], vcc, s[28:29]
    v_cmp_ge_i32 s[28:29], -2, v15
    s_nop 0
    s_and_b64 s[46:47], vcc, s[28:29]
    s_or_b32 s28, s20, s27
    s_cmp_eq_u32 s28, 0
    s_cselect_b64 s[48:49], 0, s[40:41]
    s_cselect_b64 s[50:51], 0, s[42:43]
    s_cselect_b64 s[52:53], 0, s[44:45]
    s_cselect_b64 s[54:55], 0, s[46:47]
    s_mov_b32 s56, 0xffff0000
    s_mov_b32 s57, -1
    s_mov_b32 s58, 0
    s_mov_b32 s59, -1
    s_mov_b32 s60, 0
    s_mov_b32 s61, 0xffff0000
    v_lshrrev_b32 v16, 1, v3
    v_xor_b32 v16, v16, v2
    v_lshlrev_b32 v17, 7, v3
    v_add_u32 v17, s23, v17
    v_lshl_add_u32 v14, v16, 4, v17
    v_xor_b32 v15, 64, v14
    v_xor_b32 v1, 64, v4
    ds_read_b128 a[0:3], v14 offset:0
    ds_read_b128 a[4:7], v14 offset:2048
    ds_read_b128 a[8:11], v15 offset:0
    ds_read_b128 a[12:15], v15 offset:2048
    s_waitcnt lgkmcnt(0)
    s_barrier
    s_add_u32 s29, s86, 3
    s_cmp_ge_u32 s29, 10
    s_cselect_b32 s101, 10, 0
    s_sub_u32 s29, s29, s101
    s_lshl_b32 s29, s29, 7
    s_add_u32 m0, s23, 0
    s_add_u32 s28, s29, 0
    buffer_load_dwordx4 v4, s[4:7], s28 offen lds
    s_add_u32 m0, s23, 1024
    s_add_u32 s28, s29, 10240
    buffer_load_dwordx4 v1, s[4:7], s28 offen lds
    s_add_u32 m0, s23, 2048
    s_add_u32 s28, s29, 20480
    buffer_load_dwordx4 v4, s[4:7], s28 offen lds
    s_add_u32 m0, s23, 3072
    s_add_u32 s28, s29, 30720
    buffer_load_dwordx4 v1, s[4:7], s28 offen lds
    ds_read_b64_tr_b16 v[16:17], v10 offset:0
    ds_read_b64_tr_b16 v[18:19], v10 offset:2560
    ds_read_b64_tr_b16 v[20:21], v10 offset:32
    ds_read_b64_tr_b16 v[22:23], v10 offset:2592
    ds_read_b64_tr_b16 v[24:25], v10 offset:64
    ds_read_b64_tr_b16 v[26:27], v10 offset:2624
    ds_read_b64_tr_b16 v[28:29], v10 offset:96
    ds_read_b64_tr_b16 v[30:31], v10 offset:2656
    ds_read_b64_tr_b16 v[32:33], v10 offset:128
    ds_read_b64_tr_b16 v[34:35], v10 offset:2688
    ds_read_b64_tr_b16 v[36:37], v10 offset:5120
    ds_read_b64_tr_b16 v[38:39], v10 offset:7680
    ds_read_b64_tr_b16 v[40:41], v10 offset:5152
    ds_read_b64_tr_b16 v[42:43], v10 offset:7712
    ds_read_b64_tr_b16 v[44:45], v10 offset:5184
    ds_read_b64_tr_b16 v[46:47], v10 offset:7744
    ds_read_b64_tr_b16 v[48:49], v10 offset:5216
    ds_read_b64_tr_b16 v[50:51], v10 offset:7776
    ds_read_b64_tr_b16 v[52:53], v10 offset:5248
    ds_read_b64_tr_b16 v[54:55], v10 offset:7808
    s_waitcnt lgkmcnt(0)
    v_mfma_f32_16x16x32_bf16 v[96:99], v[16:19], a[0:3], 0
    ds_read_b64_tr_b16 v[56:57], v10 offset:10240
    ds_read_b64_tr_b16 v[58:59], v10 offset:12800
    v_mfma_f32_16x16x32_bf16 v[116:119], v[16:19], a[4:7], 0
    ds_read_b64_tr_b16 v[60:61], v10 offset:10272
    ds_read_b64_tr_b16 v[62:63], v10 offset:12832
    v_mfma_f32_16x16x32_bf16 v[100:103], v[20:23], a[0:3], 0
    ds_read_b64_tr_b16 v[64:65], v10 offset:10304
    ds_read_b64_tr_b16 v[66:67], v10 offset:12864
    v_mfma_f32_16x16x32_bf16 v[120:123], v[20:23], a[4:7], 0
    ds_read_b64_tr_b16 v[68:69], v10 offset:10336
    ds_read_b64_tr_b16 v[70:71], v10 offset:12896
    v_mfma_f32_16x16x32_bf16 v[104:107], v[24:27], a[0:3], 0
    ds_read_b64_tr_b16 v[72:73], v10 offset:10368
    ds_read_b64_tr_b16 v[74:75], v10 offset:12928
    v_mfma_f32_16x16x32_bf16 v[124:127], v[24:27], a[4:7], 0
    ds_read_b64_tr_b16 v[76:77], v10 offset:15360
    ds_read_b64_tr_b16 v[78:79], v10 offset:17920
    v_mfma_f32_16x16x32_bf16 v[108:111], v[28:31], a[0:3], 0
    ds_read_b64_tr_b16 v[80:81], v10 offset:15392
    ds_read_b64_tr_b16 v[82:83], v10 offset:17952
    v_mfma_f32_16x16x32_bf16 v[128:131], v[28:31], a[4:7], 0
    ds_read_b64_tr_b16 v[84:85], v10 offset:15424
    ds_read_b64_tr_b16 v[86:87], v10 offset:17984
    v_mfma_f32_16x16x32_bf16 v[112:115], v[32:35], a[0:3], 0
    ds_read_b64_tr_b16 v[88:89], v10 offset:15456
    ds_read_b64_tr_b16 v[90:91], v10 offset:18016
    v_mfma_f32_16x16x32_bf16 v[132:135], v[32:35], a[4:7], 0
    ds_read_b64_tr_b16 v[92:93], v10 offset:15488
    ds_read_b64_tr_b16 v[94:95], v10 offset:18048
    v_mfma_f32_16x16x32_bf16 v[136:139], a[0:3], v[36:39], 0
    v_mfma_f32_16x16x32_bf16 v[156:159], a[4:7], v[36:39], 0
    v_mfma_f32_16x16x32_bf16 v[140:143], a[0:3], v[40:43], 0
    v_mfma_f32_16x16x32_bf16 v[160:163], a[4:7], v[40:43], 0
    v_mfma_f32_16x16x32_bf16 v[144:147], a[0:3], v[44:47], 0
    v_mfma_f32_16x16x32_bf16 v[164:167], a[4:7], v[44:47], 0
    v_mfma_f32_16x16x32_bf16 v[148:151], a[0:3], v[48:51], 0
    v_mfma_f32_16x16x32_bf16 v[168:171], a[4:7], v[48:51], 0
    v_mfma_f32_16x16x32_bf16 v[152:155], a[0:3], v[52:55], 0
    v_mfma_f32_16x16x32_bf16 v[172:175], a[4:7], v[52:55], 0
    s_cmp_eq_u32 s27, 0
    s_cbranch_scc0 L_h0
    v_mfma_f32_16x16x32_bf16 v[216:219], v[16:19], a[160:163], v[216:219]
    v_mfma_f32_16x16x32_bf16 v[220:223], v[20:23], a[160:163], v[220:223]
    v_mfma_f32_16x16x32_bf16 v[224:227], v[24:27], a[160:163], v[224:227]
    v_mfma_f32_16x16x32_bf16 v[228:231], v[28:31], a[160:163], v[228:231]
    v_mfma_f32_16x16x32_bf16 v[232:235], v[32:35], a[160:163], v[232:235]
    v_mfma_f32_16x16x32_bf16 v[236:239], a[160:163], v[36:39], v[236:239]
    v_mfma_f32_16x16x32_bf16 v[240:243], a[160:163], v[40:43], v[240:243]
    v_mfma_f32_16x16x32_bf16 v[244:247], a[160:163], v[44:47], v[244:247]
    v_mfma_f32_16x16x32_bf16 v[248:251], a[160:163], v[48:51], v[248:251]
    v_mfma_f32_16x16x32_bf16 v[252:255], a[160:163], v[52:55], v[252:255]
    s_nop 7
L_h0:
    s_waitcnt lgkmcnt(0)
    s_barrier
    s_add_u32 s28, s86, 4
    s_cmp_ge_u32 s28, 10
    s_cselect_b32 s101, 10, 0
    s_sub_u32 s28, s28, s101
    s_mul_i32 s28, s28, 245760
    s_add_u32 s28, s28, s24
    s_add_u32 m0, s26, 81920
    s_nop 0
    buffer_load_dwordx4 v5, s[8:11], s28 offen lds
    s_add_u32 m0, s26, 82944
    s_nop 0
    buffer_load_dwordx4 v6, s[8:11], s28 offen lds
    s_add_u32 m0, s26, 83968
    s_nop 0
    buffer_load_dwordx4 v7, s[8:11], s28 offen lds
    s_add_u32 m0, s26, 84992
    s_nop 0
    buffer_load_dwordx4 v8, s[8:11], s28 offen lds
    s_add_u32 m0, s26, 86016
    s_nop 0
    buffer_load_dwordx4 v9, s[8:11], s28 offen lds
    v_mfma_f32_16x16x32_bf16 v[96:99], v[56:59], a[8:11], v[96:99]
    ds_read_b128 a[16:19], v14 offset:4096
    ds_read_b128 a[20:23], v14 offset:6144
    v_mfma_f32_16x16x32_bf16 v[116:119], v[56:59], a[12:15], v[116:119]
    ds_read_b128 a[24:27], v15 offset:4096
    ds_read_b128 a[28:31], v15 offset:6144
    v_mfma_f32_16x16x32_bf16 v[100:103], v[60:63], a[8:11], v[100:103]
    ds_read_b64_tr_b16 v[16:17], v10 offset:20480
    ds_read_b64_tr_b16 v[18:19], v10 offset:23040
    v_mfma_f32_16x16x32_bf16 v[120:123], v[60:63], a[12:15], v[120:123]
    ds_read_b64_tr_b16 v[20:21], v10 offset:20512
    ds_read_b64_tr_b16 v[22:23], v10 offset:23072
    v_mfma_f32_16x16x32_bf16 v[104:107], v[64:67], a[8:11], v[104:107]
    ds_read_b64_tr_b16 v[24:25], v10 offset:20544
    ds_read_b64_tr_b16 v[26:27], v10 offset:23104
    v_mfma_f32_16x16x32_bf16 v[124:127], v[64:67], a[12:15], v[124:127]
    ds_read_b64_tr_b16 v[28:29], v10 offset:20576
    ds_read_b64_tr_b16 v[30:31], v10 offset:23136
    v_mfma_f32_16x16x32_bf16 v[108:111], v[68:71], a[8:11], v[108:111]
    ds_read_b64_tr_b16 v[32:33], v10 offset:20608
    ds_read_b64_tr_b16 v[34:35], v10 offset:23168
    v_mfma_f32_16x16x32_bf16 v[128:131], v[68:71], a[12:15], v[128:131]
    ds_read_b64_tr_b16 v[36:37], v10 offset:25600
    ds_read_b64_tr_b16 v[38:39], v10 offset:28160
    v_mfma_f32_16x16x32_bf16 v[112:115], v[72:75], a[8:11], v[112:115]
    ds_read_b64_tr_b16 v[40:41], v10 offset:25632
    ds_read_b64_tr_b16 v[42:43], v10 offset:28192
    v_mfma_f32_16x16x32_bf16 v[132:135], v[72:75], a[12:15], v[132:135]
    ds_read_b64_tr_b16 v[44:45], v10 offset:25664
    ds_read_b64_tr_b16 v[46:47], v10 offset:28224
    v_mfma_f32_16x16x32_bf16 v[136:139], a[8:11], v[76:79], v[136:139]
    ds_read_b64_tr_b16 v[48:49], v10 offset:25696
    ds_read_b64_tr_b16 v[50:51], v10 offset:28256
    v_mfma_f32_16x16x32_bf16 v[156:159], a[12:15], v[76:79], v[156:159]
    ds_read_b64_tr_b16 v[52:53], v10 offset:25728
    ds_read_b64_tr_b16 v[54:55], v10 offset:28288
    v_mfma_f32_16x16x32_bf16 v[140:143], a[8:11], v[80:83], v[140:143]
    v_mfma_f32_16x16x32_bf16 v[160:163], a[12:15], v[80:83], v[160:163]
    v_mfma_f32_16x16x32_bf16 v[144:147], a[8:11], v[84:87], v[144:147]
    v_mfma_f32_16x16x32_bf16 v[164:167], a[12:15], v[84:87], v[164:167]
    v_mfma_f32_16x16x32_bf16 v[148:151], a[8:11], v[88:91], v[148:151]
    v_mfma_f32_16x16x32_bf16 v[168:171], a[12:15], v[88:91], v[168:171]
    v_mfma_f32_16x16x32_bf16 v[152:155], a[8:11], v[92:95], v[152:155]
    v_mfma_f32_16x16x32_bf16 v[172:175], a[12:15], v[92:95], v[172:175]
    s_cmp_eq_u32 s27, 1
    s_cbranch_scc0 L_h1
    v_mfma_f32_16x16x32_bf16 v[216:219], v[56:59], a[160:163], v[216:219]
    v_mfma_f32_16x16x32_bf16 v[220:223], v[60:63], a[160:163], v[220:223]
    v_mfma_f32_16x16x32_bf16 v[224:227], v[64:67], a[160:163], v[224:227]
    v_mfma_f32_16x16x32_bf16 v[228:231], v[68:71], a[160:163], v[228:231]
    v_mfma_f32_16x16x32_bf16 v[232:235], v[72:75], a[160:163], v[232:235]
    v_mfma_f32_16x16x32_bf16 v[236:239], a[160:163], v[76:79], v[236:239]
    v_mfma_f32_16x16x32_bf16 v[240:243], a[160:163], v[80:83], v[240:243]
    v_mfma_f32_16x16x32_bf16 v[244:247], a[160:163], v[84:87], v[244:247]
    v_mfma_f32_16x16x32_bf16 v[248:251], a[160:163], v[88:91], v[248:251]
    v_mfma_f32_16x16x32_bf16 v[252:255], a[160:163], v[92:95], v[252:255]
    s_nop 7
L_h1:
    s_waitcnt lgkmcnt(0)
    s_add_u32 s29, s86, 4
    s_cmp_ge_u32 s29, 10
    s_cselect_b32 s101, 10, 0
    s_sub_u32 s29, s29, s101
    s_lshl_b32 s29, s29, 7
    s_add_u32 m0, s23, 4096
    s_add_u32 s28, s29, 0
    buffer_load_dwordx4 v4, s[4:7], s28 offen lds
    s_add_u32 m0, s23, 5120
    s_add_u32 s28, s29, 10240
    buffer_load_dwordx4 v1, s[4:7], s28 offen lds
    s_add_u32 m0, s23, 6144
    s_add_u32 s28, s29, 20480
    buffer_load_dwordx4 v4, s[4:7], s28 offen lds
    s_add_u32 m0, s23, 7168
    s_add_u32 s28, s29, 30720
    buffer_load_dwordx4 v1, s[4:7], s28 offen lds
    v_mfma_f32_16x16x32_bf16 v[96:99], v[16:19], a[16:19], v[96:99]
    ds_read_b64_tr_b16 v[56:57], v10 offset:30720
    ds_read_b64_tr_b16 v[58:59], v10 offset:33280
    v_mfma_f32_16x16x32_bf16 v[116:119], v[16:19], a[20:23], v[116:119]
    ds_read_b64_tr_b16 v[60:61], v10 offset:30752
    ds_read_b64_tr_b16 v[62:63], v10 offset:33312
    v_mfma_f32_16x16x32_bf16 v[100:103], v[20:23], a[16:19], v[100:103]
    ds_read_b64_tr_b16 v[64:65], v10 offset:30784
    ds_read_b64_tr_b16 v[66:67], v10 offset:33344
    v_mfma_f32_16x16x32_bf16 v[120:123], v[20:23], a[20:23], v[120:123]
    ds_read_b64_tr_b16 v[68:69], v10 offset:30816
    ds_read_b64_tr_b16 v[70:71], v10 offset:33376
    v_mfma_f32_16x16x32_bf16 v[104:107], v[24:27], a[16:19], v[104:107]
    ds_read_b64_tr_b16 v[72:73], v10 offset:30848
    ds_read_b64_tr_b16 v[74:75], v10 offset:33408
    v_mfma_f32_16x16x32_bf16 v[124:127], v[24:27], a[20:23], v[124:127]
    ds_read_b64_tr_b16 v[76:77], v10 offset:35840
    ds_read_b64_tr_b16 v[78:79], v10 offset:38400
    v_mfma_f32_16x16x32_bf16 v[108:111], v[28:31], a[16:19], v[108:111]
    ds_read_b64_tr_b16 v[80:81], v10 offset:35872
    ds_read_b64_tr_b16 v[82:83], v10 offset:38432
    v_mfma_f32_16x16x32_bf16 v[128:131], v[28:31], a[20:23], v[128:131]
    ds_read_b64_tr_b16 v[84:85], v10 offset:35904
    ds_read_b64_tr_b16 v[86:87], v10 offset:38464
    v_mfma_f32_16x16x32_bf16 v[112:115], v[32:35], a[16:19], v[112:115]
    ds_read_b64_tr_b16 v[88:89], v10 offset:35936
    ds_read_b64_tr_b16 v[90:91], v10 offset:38496
    v_mfma_f32_16x16x32_bf16 v[132:135], v[32:35], a[20:23], v[132:135]
    ds_read_b64_tr_b16 v[92:93], v10 offset:35968
    ds_read_b64_tr_b16 v[94:95], v10 offset:38528
    v_mfma_f32_16x16x32_bf16 v[136:139], a[16:19], v[36:39], v[136:139]
    v_mfma_f32_16x16x32_bf16 v[156:159], a[20:23], v[36:39], v[156:159]
    v_mfma_f32_16x16x32_bf16 v[140:143], a[16:19], v[40:43], v[140:143]
    v_mfma_f32_16x16x32_bf16 v[160:163], a[20:23], v[40:43], v[160:163]
    v_mfma_f32_16x16x32_bf16 v[144:147], a[16:19], v[44:47], v[144:147]
    v_mfma_f32_16x16x32_bf16 v[164:167], a[20:23], v[44:47], v[164:167]
    v_mfma_f32_16x16x32_bf16 v[148:151], a[16:19], v[48:51], v[148:151]
    v_mfma_f32_16x16x32_bf16 v[168:171], a[20:23], v[48:51], v[168:171]
    v_mfma_f32_16x16x32_bf16 v[152:155], a[16:19], v[52:55], v[152:155]
    v_mfma_f32_16x16x32_bf16 v[172:175], a[20:23], v[52:55], v[172:175]
    s_cmp_eq_u32 s27, 2
    s_cbranch_scc0 L_h2
    v_mfma_f32_16x16x32_bf16 v[216:219], v[16:19], a[160:163], v[216:219]
    v_mfma_f32_16x16x32_bf16 v[220:223], v[20:23], a[160:163], v[220:223]
    v_mfma_f32_16x16x32_bf16 v[224:227], v[24:27], a[160:163], v[224:227]
    v_mfma_f32_16x16x32_bf16 v[228:231], v[28:31], a[160:163], v[228:231]
    v_mfma_f32_16x16x32_bf16 v[232:235], v[32:35], a[160:163], v[232:235]
    v_mfma_f32_16x16x32_bf16 v[236:239], a[160:163], v[36:39], v[236:239]
    v_mfma_f32_16x16x32_bf16 v[240:243], a[160:163], v[40:43], v[240:243]
    v_mfma_f32_16x16x32_bf16 v[244:247], a[160:163], v[44:47], v[244:247]
    v_mfma_f32_16x16x32_bf16 v[248:251], a[160:163], v[48:51], v[248:251]
    v_mfma_f32_16x16x32_bf16 v[252:255], a[160:163], v[52:55], v[252:255]
    s_nop 7
L_h2:
    s_waitcnt lgkmcnt(0)
    s_barrier
    s_add_u32 s28, s86, 5
    s_cmp_ge_u32 s28, 10
    s_cselect_b32 s101, 10, 0
    s_sub_u32 s28, s28, s101
    s_mul_i32 s28, s28, 245760
    s_add_u32 s28, s28, s24
    s_add_u32 m0, s26, 0
    s_nop 0
    buffer_load_dwordx4 v5, s[8:11], s28 offen lds
    s_add_u32 m0, s26, 1024
    s_nop 0
    buffer_load_dwordx4 v6, s[8:11], s28 offen lds
    s_add_u32 m0, s26, 2048
    s_nop 0
    buffer_load_dwordx4 v7, s[8:11], s28 offen lds
    s_add_u32 m0, s26, 3072
    s_nop 0
    buffer_load_dwordx4 v8, s[8:11], s28 offen lds
    s_add_u32 m0, s26, 4096
    s_nop 0
    buffer_load_dwordx4 v9, s[8:11], s28 offen lds
    v_mfma_f32_16x16x32_bf16 v[96:99], v[56:59], a[24:27], v[96:99]
    ds_read_b128 a[32:35], v14 offset:8192
    ds_read_b128 a[36:39], v14 offset:10240
    v_mfma_f32_16x16x32_bf16 v[116:119], v[56:59], a[28:31], v[116:119]
    ds_read_b128 a[40:43], v15 offset:8192
    ds_read_b128 a[44:47], v15 offset:10240
    v_mfma_f32_16x16x32_bf16 v[100:103], v[60:63], a[24:27], v[100:103]
    ds_read_b64_tr_b16 v[16:17], v10 offset:40960
    ds_read_b64_tr_b16 v[18:19], v10 offset:43520
    v_mfma_f32_16x16x32_bf16 v[120:123], v[60:63], a[28:31], v[120:123]
    ds_read_b64_tr_b16 v[20:21], v10 offset:40992
    ds_read_b64_tr_b16 v[22:23], v10 offset:43552
    v_mfma_f32_16x16x32_bf16 v[104:107], v[64:67], a[24:27], v[104:107]
    ds_read_b64_tr_b16 v[24:25], v10 offset:41024
    ds_read_b64_tr_b16 v[26:27], v10 offset:43584
    v_mfma_f32_16x16x32_bf16 v[124:127], v[64:67], a[28:31], v[124:127]
    ds_read_b64_tr_b16 v[28:29], v10 offset:41056
    ds_read_b64_tr_b16 v[30:31], v10 offset:43616
    v_mfma_f32_16x16x32_bf16 v[108:111], v[68:71], a[24:27], v[108:111]
    ds_read_b64_tr_b16 v[32:33], v10 offset:41088
    ds_read_b64_tr_b16 v[34:35], v10 offset:43648
    v_mfma_f32_16x16x32_bf16 v[128:131], v[68:71], a[28:31], v[128:131]
    ds_read_b64_tr_b16 v[36:37], v10 offset:46080
    ds_read_b64_tr_b16 v[38:39], v10 offset:48640
    v_mfma_f32_16x16x32_bf16 v[112:115], v[72:75], a[24:27], v[112:115]
    ds_read_b64_tr_b16 v[40:41], v10 offset:46112
    ds_read_b64_tr_b16 v[42:43], v10 offset:48672
    v_mfma_f32_16x16x32_bf16 v[132:135], v[72:75], a[28:31], v[132:135]
    ds_read_b64_tr_b16 v[44:45], v10 offset:46144
    ds_read_b64_tr_b16 v[46:47], v10 offset:48704
    v_mfma_f32_16x16x32_bf16 v[136:139], a[24:27], v[76:79], v[136:139]
    ds_read_b64_tr_b16 v[48:49], v10 offset:46176
    ds_read_b64_tr_b16 v[50:51], v10 offset:48736
    v_mfma_f32_16x16x32_bf16 v[156:159], a[28:31], v[76:79], v[156:159]
    ds_read_b64_tr_b16 v[52:53], v10 offset:46208
    ds_read_b64_tr_b16 v[54:55], v10 offset:48768
    v_mfma_f32_16x16x32_bf16 v[140:143], a[24:27], v[80:83], v[140:143]
    v_mfma_f32_16x16x32_bf16 v[160:163], a[28:31], v[80:83], v[160:163]
    v_mfma_f32_16x16x32_bf16 v[144:147], a[24:27], v[84:87], v[144:147]
    v_mfma_f32_16x16x32_bf16 v[164:167], a[28:31], v[84:87], v[164:167]
    v_mfma_f32_16x16x32_bf16 v[148:151], a[24:27], v[88:91], v[148:151]
    v_mfma_f32_16x16x32_bf16 v[168:171], a[28:31], v[88:91], v[168:171]
    v_mfma_f32_16x16x32_bf16 v[152:155], a[24:27], v[92:95], v[152:155]
    v_mfma_f32_16x16x32_bf16 v[172:175], a[28:31], v[92:95], v[172:175]
    s_cmp_eq_u32 s27, 3
    s_cbranch_scc0 L_h3
    v_mfma_f32_16x16x32_bf16 v[216:219], v[56:59], a[160:163], v[216:219]
    v_mfma_f32_16x16x32_bf16 v[220:223], v[60:63], a[160:163], v[220:223]
    v_mfma_f32_16x16x32_bf16 v[224:227], v[64:67], a[160:163], v[224:227]
    v_mfma_f32_16x16x32_bf16 v[228:231], v[68:71], a[160:163], v[228:231]
    v_mfma_f32_16x16x32_bf16 v[232:235], v[72:75], a[160:163], v[232:235]
    v_mfma_f32_16x16x32_bf16 v[236:239], a[160:163], v[76:79], v[236:239]
    v_mfma_f32_16x16x32_bf16 v[240:243], a[160:163], v[80:83], v[240:243]
    v_mfma_f32_16x16x32_bf16 v[244:247], a[160:163], v[84:87], v[244:247]
    v_mfma_f32_16x16x32_bf16 v[248:251], a[160:163], v[88:91], v[248:251]
    v_mfma_f32_16x16x32_bf16 v[252:255], a[160:163], v[92:95], v[252:255]
    s_nop 7
L_h3:
    s_waitcnt lgkmcnt(0)
    s_add_u32 s29, s86, 5
    s_cmp_ge_u32 s29, 10
    s_cselect_b32 s101, 10, 0
    s_sub_u32 s29, s29, s101
    s_lshl_b32 s29, s29, 7
    s_add_u32 m0, s23, 8192
    s_add_u32 s28, s29, 0
    buffer_load_dwordx4 v4, s[4:7], s28 offen lds
    s_add_u32 m0, s23, 9216
    s_add_u32 s28, s29, 10240
    buffer_load_dwordx4 v1, s[4:7], s28 offen lds
    s_add_u32 m0, s23, 10240
    s_add_u32 s28, s29, 20480
    buffer_load_dwordx4 v4, s[4:7], s28 offen lds
    s_add_u32 m0, s23, 11264
    s_add_u32 s28, s29, 30720
    buffer_load_dwordx4 v1, s[4:7], s28 offen lds
    v_mfma_f32_16x16x32_bf16 v[96:99], v[16:19], a[32:35], v[96:99]
    ds_read_b64_tr_b16 v[56:57], v10 offset:51200
    ds_read_b64_tr_b16 v[58:59], v10 offset:53760
    v_mfma_f32_16x16x32_bf16 v[116:119], v[16:19], a[36:39], v[116:119]
    ds_read_b64_tr_b16 v[60:61], v10 offset:51232
    ds_read_b64_tr_b16 v[62:63], v10 offset:53792
    v_mfma_f32_16x16x32_bf16 v[100:103], v[20:23], a[32:35], v[100:103]
    ds_read_b64_tr_b16 v[64:65], v10 offset:51264
    ds_read_b64_tr_b16 v[66:67], v10 offset:53824
    v_mfma_f32_16x16x32_bf16 v[120:123], v[20:23], a[36:39], v[120:123]
    ds_read_b64_tr_b16 v[68:69], v10 offset:51296
    ds_read_b64_tr_b16 v[70:71], v10 offset:53856
    v_mfma_f32_16x16x32_bf16 v[104:107], v[24:27], a[32:35], v[104:107]
    ds_read_b64_tr_b16 v[72:73], v10 offset:51328
    ds_read_b64_tr_b16 v[74:75], v10 offset:53888
    v_mfma_f32_16x16x32_bf16 v[124:127], v[24:27], a[36:39], v[124:127]
    ds_read_b64_tr_b16 v[76:77], v10 offset:56320
    ds_read_b64_tr_b16 v[78:79], v10 offset:58880
    v_mfma_f32_16x16x32_bf16 v[108:111], v[28:31], a[32:35], v[108:111]
    ds_read_b64_tr_b16 v[80:81], v10 offset:56352
    ds_read_b64_tr_b16 v[82:83], v10 offset:58912
    v_mfma_f32_16x16x32_bf16 v[128:131], v[28:31], a[36:39], v[128:131]
    ds_read_b64_tr_b16 v[84:85], v10 offset:56384
    ds_read_b64_tr_b16 v[86:87], v10 offset:58944
    v_mfma_f32_16x16x32_bf16 v[112:115], v[32:35], a[32:35], v[112:115]
    ds_read_b64_tr_b16 v[88:89], v10 offset:56416
    ds_read_b64_tr_b16 v[90:91], v10 offset:58976
    v_mfma_f32_16x16x32_bf16 v[132:135], v[32:35], a[36:39], v[132:135]
    ds_read_b64_tr_b16 v[92:93], v10 offset:56448
    ds_read_b64_tr_b16 v[94:95], v10 offset:59008
    v_mfma_f32_16x16x32_bf16 v[136:139], a[32:35], v[36:39], v[136:139]
    v_mfma_f32_16x16x32_bf16 v[156:159], a[36:39], v[36:39], v[156:159]
    v_mfma_f32_16x16x32_bf16 v[140:143], a[32:35], v[40:43], v[140:143]
    v_mfma_f32_16x16x32_bf16 v[160:163], a[36:39], v[40:43], v[160:163]
    v_mfma_f32_16x16x32_bf16 v[144:147], a[32:35], v[44:47], v[144:147]
    v_mfma_f32_16x16x32_bf16 v[164:167], a[36:39], v[44:47], v[164:167]
    v_mfma_f32_16x16x32_bf16 v[148:151], a[32:35], v[48:51], v[148:151]
    v_mfma_f32_16x16x32_bf16 v[168:171], a[36:39], v[48:51], v[168:171]
    v_mfma_f32_16x16x32_bf16 v[152:155], a[32:35], v[52:55], v[152:155]
    v_mfma_f32_16x16x32_bf16 v[172:175], a[36:39], v[52:55], v[172:175]
    s_cmp_eq_u32 s27, 0
    s_cbranch_scc0 L_h4
    v_mfma_f32_16x16x32_bf16 v[216:219], v[16:19], a[164:167], v[216:219]
    v_mfma_f32_16x16x32_bf16 v[220:223], v[20:23], a[164:167], v[220:223]
    v_mfma_f32_16x16x32_bf16 v[224:227], v[24:27], a[164:167], v[224:227]
    v_mfma_f32_16x16x32_bf16 v[228:231], v[28:31], a[164:167], v[228:231]
    v_mfma_f32_16x16x32_bf16 v[232:235], v[32:35], a[164:167], v[232:235]
    v_mfma_f32_16x16x32_bf16 v[236:239], a[164:167], v[36:39], v[236:239]
    v_mfma_f32_16x16x32_bf16 v[240:243], a[164:167], v[40:43], v[240:243]
    v_mfma_f32_16x16x32_bf16 v[244:247], a[164:167], v[44:47], v[244:247]
    v_mfma_f32_16x16x32_bf16 v[248:251], a[164:167], v[48:51], v[248:251]
    v_mfma_f32_16x16x32_bf16 v[252:255], a[164:167], v[52:55], v[252:255]
    s_nop 7
L_h4:
    s_waitcnt lgkmcnt(0)
    s_waitcnt vmcnt(18)
    s_barrier
    s_add_u32 s28, s86, 6
    s_cmp_ge_u32 s28, 10
    s_cselect_b32 s101, 10, 0
    s_sub_u32 s28, s28, s101
    s_mul_i32 s28, s28, 245760
    s_add_u32 s28, s28, s24
    s_add_u32 m0, s26, 20480
    s_nop 0
    buffer_load_dwordx4 v5, s[8:11], s28 offen lds
    s_add_u32 m0, s26, 21504
    s_nop 0
    buffer_load_dwordx4 v6, s[8:11], s28 offen lds
    s_add_u32 m0, s26, 22528
    s_nop 0
    buffer_load_dwordx4 v7, s[8:11], s28 offen lds
    s_add_u32 m0, s26, 23552
    s_nop 0
    buffer_load_dwordx4 v8, s[8:11], s28 offen lds
    s_add_u32 m0, s26, 24576
    s_nop 0
    buffer_load_dwordx4 v9, s[8:11], s28 offen lds
    v_mfma_f32_16x16x32_bf16 v[96:99], v[56:59], a[40:43], v[96:99]
    ds_read_b128 a[48:51], v14 offset:0
    ds_read_b128 a[52:55], v14 offset:2048
    v_mfma_f32_16x16x32_bf16 v[116:119], v[56:59], a[44:47], v[116:119]
    ds_read_b128 a[56:59], v15 offset:0
    ds_read_b128 a[60:63], v15 offset:2048
    v_mfma_f32_16x16x32_bf16 v[100:103], v[60:63], a[40:43], v[100:103]
    ds_read_b64_tr_b16 v[16:17], v11 offset:0
    ds_read_b64_tr_b16 v[18:19], v11 offset:2560
    v_mfma_f32_16x16x32_bf16 v[120:123], v[60:63], a[44:47], v[120:123]
    ds_read_b64_tr_b16 v[20:21], v11 offset:32
    ds_read_b64_tr_b16 v[22:23], v11 offset:2592
    v_mfma_f32_16x16x32_bf16 v[104:107], v[64:67], a[40:43], v[104:107]
    ds_read_b64_tr_b16 v[24:25], v11 offset:64
    ds_read_b64_tr_b16 v[26:27], v11 offset:2624
    v_mfma_f32_16x16x32_bf16 v[124:127], v[64:67], a[44:47], v[124:127]
    ds_read_b64_tr_b16 v[28:29], v11 offset:96
    ds_read_b64_tr_b16 v[30:31], v11 offset:2656
    v_mfma_f32_16x16x32_bf16 v[108:111], v[68:71], a[40:43], v[108:111]
    ds_read_b64_tr_b16 v[32:33], v11 offset:128
    ds_read_b64_tr_b16 v[34:35], v11 offset:2688
    v_mfma_f32_16x16x32_bf16 v[128:131], v[68:71], a[44:47], v[128:131]
    ds_read_b64_tr_b16 v[36:37], v11 offset:5120
    ds_read_b64_tr_b16 v[38:39], v11 offset:7680
    v_mfma_f32_16x16x32_bf16 v[112:115], v[72:75], a[40:43], v[112:115]
    ds_read_b64_tr_b16 v[40:41], v11 offset:5152
    ds_read_b64_tr_b16 v[42:43], v11 offset:7712
    v_mfma_f32_16x16x32_bf16 v[132:135], v[72:75], a[44:47], v[132:135]
    ds_read_b64_tr_b16 v[44:45], v11 offset:5184
    ds_read_b64_tr_b16 v[46:47], v11 offset:7744
    v_mfma_f32_16x16x32_bf16 v[136:139], a[40:43], v[76:79], v[136:139]
    ds_read_b64_tr_b16 v[48:49], v11 offset:5216
    ds_read_b64_tr_b16 v[50:51], v11 offset:7776
    v_mfma_f32_16x16x32_bf16 v[156:159], a[44:47], v[76:79], v[156:159]
    ds_read_b64_tr_b16 v[52:53], v11 offset:5248
    ds_read_b64_tr_b16 v[54:55], v11 offset:7808
    v_mfma_f32_16x16x32_bf16 v[140:143], a[40:43], v[80:83], v[140:143]
    v_mfma_f32_16x16x32_bf16 v[160:163], a[44:47], v[80:83], v[160:163]
    v_mfma_f32_16x16x32_bf16 v[144:147], a[40:43], v[84:87], v[144:147]
    v_mfma_f32_16x16x32_bf16 v[164:167], a[44:47], v[84:87], v[164:167]
    v_mfma_f32_16x16x32_bf16 v[148:151], a[40:43], v[88:91], v[148:151]
    v_mfma_f32_16x16x32_bf16 v[168:171], a[44:47], v[88:91], v[168:171]
    v_mfma_f32_16x16x32_bf16 v[152:155], a[40:43], v[92:95], v[152:155]
    v_mfma_f32_16x16x32_bf16 v[172:175], a[44:47], v[92:95], v[172:175]
    s_cmp_eq_u32 s27, 1
    s_cbranch_scc0 L_h5
    v_mfma_f32_16x16x32_bf16 v[216:219], v[56:59], a[164:167], v[216:219]
    v_mfma_f32_16x16x32_bf16 v[220:223], v[60:63], a[164:167], v[220:223]
    v_mfma_f32_16x16x32_bf16 v[224:227], v[64:67], a[164:167], v[224:227]
    v_mfma_f32_16x16x32_bf16 v[228:231], v[68:71], a[164:167], v[228:231]
    v_mfma_f32_16x16x32_bf16 v[232:235], v[72:75], a[164:167], v[232:235]
    v_mfma_f32_16x16x32_bf16 v[236:239], a[164:167], v[76:79], v[236:239]
    v_mfma_f32_16x16x32_bf16 v[240:243], a[164:167], v[80:83], v[240:243]
    v_mfma_f32_16x16x32_bf16 v[244:247], a[164:167], v[84:87], v[244:247]
    v_mfma_f32_16x16x32_bf16 v[248:251], a[164:167], v[88:91], v[248:251]
    v_mfma_f32_16x16x32_bf16 v[252:255], a[164:167], v[92:95], v[252:255]
    s_nop 7
L_h5:
    s_waitcnt lgkmcnt(0)
    s_add_u32 s29, s86, 6
    s_cmp_ge_u32 s29, 10
    s_cselect_b32 s101, 10, 0
    s_sub_u32 s29, s29, s101
    s_lshl_b32 s29, s29, 7
    s_add_u32 m0, s23, 0
    s_add_u32 s28, s29, 0
    buffer_load_dwordx4 v4, s[4:7], s28 offen lds
    s_add_u32 m0, s23, 1024
    s_add_u32 s28, s29, 10240
    buffer_load_dwordx4 v1, s[4:7], s28 offen lds
    s_add_u32 m0, s23, 2048
    s_add_u32 s28, s29, 20480
    buffer_load_dwordx4 v4, s[4:7], s28 offen lds
    s_add_u32 m0, s23, 3072
    s_add_u32 s28, s29, 30720
    buffer_load_dwordx4 v1, s[4:7], s28 offen lds
    v_mfma_f32_16x16x32_bf16 v[96:99], v[16:19], a[48:51], v[96:99]
    ds_read_b64_tr_b16 v[56:57], v11 offset:10240
    ds_read_b64_tr_b16 v[58:59], v11 offset:12800
    v_mfma_f32_16x16x32_bf16 v[116:119], v[16:19], a[52:55], v[116:119]
    ds_read_b64_tr_b16 v[60:61], v11 offset:10272
    ds_read_b64_tr_b16 v[62:63], v11 offset:12832
    v_mfma_f32_16x16x32_bf16 v[100:103], v[20:23], a[48:51], v[100:103]
    ds_read_b64_tr_b16 v[64:65], v11 offset:10304
    ds_read_b64_tr_b16 v[66:67], v11 offset:12864
    v_mfma_f32_16x16x32_bf16 v[120:123], v[20:23], a[52:55], v[120:123]
    ds_read_b64_tr_b16 v[68:69], v11 offset:10336
    ds_read_b64_tr_b16 v[70:71], v11 offset:12896
    v_mfma_f32_16x16x32_bf16 v[104:107], v[24:27], a[48:51], v[104:107]
    ds_read_b64_tr_b16 v[72:73], v11 offset:10368
    ds_read_b64_tr_b16 v[74:75], v11 offset:12928
    v_mfma_f32_16x16x32_bf16 v[124:127], v[24:27], a[52:55], v[124:127]
    ds_read_b64_tr_b16 v[76:77], v11 offset:15360
    ds_read_b64_tr_b16 v[78:79], v11 offset:17920
    v_mfma_f32_16x16x32_bf16 v[108:111], v[28:31], a[48:51], v[108:111]
    ds_read_b64_tr_b16 v[80:81], v11 offset:15392
    ds_read_b64_tr_b16 v[82:83], v11 offset:17952
    v_mfma_f32_16x16x32_bf16 v[128:131], v[28:31], a[52:55], v[128:131]
    ds_read_b64_tr_b16 v[84:85], v11 offset:15424
    ds_read_b64_tr_b16 v[86:87], v11 offset:17984
    v_mfma_f32_16x16x32_bf16 v[112:115], v[32:35], a[48:51], v[112:115]
    ds_read_b64_tr_b16 v[88:89], v11 offset:15456
    ds_read_b64_tr_b16 v[90:91], v11 offset:18016
    v_mfma_f32_16x16x32_bf16 v[132:135], v[32:35], a[52:55], v[132:135]
    ds_read_b64_tr_b16 v[92:93], v11 offset:15488
    ds_read_b64_tr_b16 v[94:95], v11 offset:18048
    v_mfma_f32_16x16x32_bf16 v[136:139], a[48:51], v[36:39], v[136:139]
    v_mfma_f32_16x16x32_bf16 v[156:159], a[52:55], v[36:39], v[156:159]
    v_mfma_f32_16x16x32_bf16 v[140:143], a[48:51], v[40:43], v[140:143]
    v_mfma_f32_16x16x32_bf16 v[160:163], a[52:55], v[40:43], v[160:163]
    v_mfma_f32_16x16x32_bf16 v[144:147], a[48:51], v[44:47], v[144:147]
    v_mfma_f32_16x16x32_bf16 v[164:167], a[52:55], v[44:47], v[164:167]
    v_mfma_f32_16x16x32_bf16 v[148:151], a[48:51], v[48:51], v[148:151]
    v_mfma_f32_16x16x32_bf16 v[168:171], a[52:55], v[48:51], v[168:171]
    v_mfma_f32_16x16x32_bf16 v[152:155], a[48:51], v[52:55], v[152:155]
    v_mfma_f32_16x16x32_bf16 v[172:175], a[52:55], v[52:55], v[172:175]
    s_cmp_eq_u32 s27, 2
    s_cbranch_scc0 L_h6
    v_mfma_f32_16x16x32_bf16 v[216:219], v[16:19], a[164:167], v[216:219]
    v_mfma_f32_16x16x32_bf16 v[220:223], v[20:23], a[164:167], v[220:223]
    v_mfma_f32_16x16x32_bf16 v[224:227], v[24:27], a[164:167], v[224:227]
    v_mfma_f32_16x16x32_bf16 v[228:231], v[28:31], a[164:167], v[228:231]
    v_mfma_f32_16x16x32_bf16 v[232:235], v[32:35], a[164:167], v[232:235]
    v_mfma_f32_16x16x32_bf16 v[236:239], a[164:167], v[36:39], v[236:239]
    v_mfma_f32_16x16x32_bf16 v[240:243], a[164:167], v[40:43], v[240:243]
    v_mfma_f32_16x16x32_bf16 v[244:247], a[164:167], v[44:47], v[244:247]
    v_mfma_f32_16x16x32_bf16 v[248:251], a[164:167], v[48:51], v[248:251]
    v_mfma_f32_16x16x32_bf16 v[252:255], a[164:167], v[52:55], v[252:255]
    s_nop 7
L_h6:
    s_waitcnt lgkmcnt(0)
    s_waitcnt vmcnt(18)
    s_barrier
    s_add_u32 s28, s86, 7
    s_cmp_ge_u32 s28, 10
    s_cselect_b32 s101, 10, 0
    s_sub_u32 s28, s28, s101
    s_mul_i32 s28, s28, 245760
    s_add_u32 s28, s28, s24
    s_add_u32 m0, s26, 40960
    s_nop 0
    buffer_load_dwordx4 v5, s[8:11], s28 offen lds
    s_add_u32 m0, s26, 41984
    s_nop 0
    buffer_load_dwordx4 v6, s[8:11], s28 offen lds
    s_add_u32 m0, s26, 43008
    s_nop 0
    buffer_load_dwordx4 v7, s[8:11], s28 offen lds
    s_add_u32 m0, s26, 44032
    s_nop 0
    buffer_load_dwordx4 v8, s[8:11], s28 offen lds
    s_add_u32 m0, s26, 45056
    s_nop 0
    buffer_load_dwordx4 v9, s[8:11], s28 offen lds
    v_mfma_f32_16x16x32_bf16 v[96:99], v[56:59], a[56:59], v[96:99]
    ds_read_b128 a[64:67], v14 offset:4096
    ds_read_b128 a[68:71], v14 offset:6144
    v_mfma_f32_16x16x32_bf16 v[116:119], v[56:59], a[60:63], v[116:119]
    ds_read_b128 a[72:75], v15 offset:4096
    ds_read_b128 a[76:79], v15 offset:6144
    v_mfma_f32_16x16x32_bf16 v[100:103], v[60:63], a[56:59], v[100:103]
    ds_read_b64_tr_b16 v[16:17], v11 offset:20480
    ds_read_b64_tr_b16 v[18:19], v11 offset:23040
    v_mfma_f32_16x16x32_bf16 v[120:123], v[60:63], a[60:63], v[120:123]
    ds_read_b64_tr_b16 v[20:21], v11 offset:20512
    ds_read_b64_tr_b16 v[22:23], v11 offset:23072
    v_mfma_f32_16x16x32_bf16 v[104:107], v[64:67], a[56:59], v[104:107]
    ds_read_b64_tr_b16 v[24:25], v11 offset:20544
    ds_read_b64_tr_b16 v[26:27], v11 offset:23104
    v_mfma_f32_16x16x32_bf16 v[124:127], v[64:67], a[60:63], v[124:127]
    ds_read_b64_tr_b16 v[28:29], v11 offset:20576
    ds_read_b64_tr_b16 v[30:31], v11 offset:23136
    v_mfma_f32_16x16x32_bf16 v[108:111], v[68:71], a[56:59], v[108:111]
    ds_read_b64_tr_b16 v[32:33], v11 offset:20608
    ds_read_b64_tr_b16 v[34:35], v11 offset:23168
    v_mfma_f32_16x16x32_bf16 v[128:131], v[68:71], a[60:63], v[128:131]
    ds_read_b64_tr_b16 v[36:37], v11 offset:25600
    ds_read_b64_tr_b16 v[38:39], v11 offset:28160
    v_mfma_f32_16x16x32_bf16 v[112:115], v[72:75], a[56:59], v[112:115]
    ds_read_b64_tr_b16 v[40:41], v11 offset:25632
    ds_read_b64_tr_b16 v[42:43], v11 offset:28192
    v_mfma_f32_16x16x32_bf16 v[132:135], v[72:75], a[60:63], v[132:135]
    ds_read_b64_tr_b16 v[44:45], v11 offset:25664
    ds_read_b64_tr_b16 v[46:47], v11 offset:28224
    v_mfma_f32_16x16x32_bf16 v[136:139], a[56:59], v[76:79], v[136:139]
    ds_read_b64_tr_b16 v[48:49], v11 offset:25696
    ds_read_b64_tr_b16 v[50:51], v11 offset:28256
    v_mfma_f32_16x16x32_bf16 v[156:159], a[60:63], v[76:79], v[156:159]
    ds_read_b64_tr_b16 v[52:53], v11 offset:25728
    ds_read_b64_tr_b16 v[54:55], v11 offset:28288
    v_mfma_f32_16x16x32_bf16 v[140:143], a[56:59], v[80:83], v[140:143]
    v_mfma_f32_16x16x32_bf16 v[160:163], a[60:63], v[80:83], v[160:163]
    v_mfma_f32_16x16x32_bf16 v[144:147], a[56:59], v[84:87], v[144:147]
    v_mfma_f32_16x16x32_bf16 v[164:167], a[60:63], v[84:87], v[164:167]
    v_mfma_f32_16x16x32_bf16 v[148:151], a[56:59], v[88:91], v[148:151]
    v_mfma_f32_16x16x32_bf16 v[168:171], a[60:63], v[88:91], v[168:171]
    v_mfma_f32_16x16x32_bf16 v[152:155], a[56:59], v[92:95], v[152:155]
    v_mfma_f32_16x16x32_bf16 v[172:175], a[60:63], v[92:95], v[172:175]
    s_cmp_eq_u32 s27, 3
    s_cbranch_scc0 L_h7
    v_mfma_f32_16x16x32_bf16 v[216:219], v[56:59], a[164:167], v[216:219]
    v_mfma_f32_16x16x32_bf16 v[220:223], v[60:63], a[164:167], v[220:223]
    v_mfma_f32_16x16x32_bf16 v[224:227], v[64:67], a[164:167], v[224:227]
    v_mfma_f32_16x16x32_bf16 v[228:231], v[68:71], a[164:167], v[228:231]
    v_mfma_f32_16x16x32_bf16 v[232:235], v[72:75], a[164:167], v[232:235]
    v_mfma_f32_16x16x32_bf16 v[236:239], a[164:167], v[76:79], v[236:239]
    v_mfma_f32_16x16x32_bf16 v[240:243], a[164:167], v[80:83], v[240:243]
    v_mfma_f32_16x16x32_bf16 v[244:247], a[164:167], v[84:87], v[244:247]
    v_mfma_f32_16x16x32_bf16 v[248:251], a[164:167], v[88:91], v[248:251]
    v_mfma_f32_16x16x32_bf16 v[252:255], a[164:167], v[92:95], v[252:255]
    s_nop 7
L_h7:
    s_waitcnt lgkmcnt(0)
    s_add_u32 s29, s86, 7
    s_cmp_ge_u32 s29, 10
    s_cselect_b32 s101, 10, 0
    s_sub_u32 s29, s29, s101
    s_lshl_b32 s29, s29, 7
    s_add_u32 m0, s23, 4096
    s_add_u32 s28, s29, 0
    buffer_load_dwordx4 v4, s[4:7], s28 offen lds
    s_add_u32 m0, s23, 5120
    s_add_u32 s28, s29, 10240
    buffer_load_dwordx4 v1, s[4:7], s28 offen lds
    s_add_u32 m0, s23, 6144
    s_add_u32 s28, s29, 20480
    buffer_load_dwordx4 v4, s[4:7], s28 offen lds
    s_add_u32 m0, s23, 7168
    s_add_u32 s28, s29, 30720
    buffer_load_dwordx4 v1, s[4:7], s28 offen lds
    v_mfma_f32_16x16x32_bf16 v[96:99], v[16:19], a[64:67], v[96:99]
    ds_read_b64_tr_b16 v[56:57], v11 offset:30720
    ds_read_b64_tr_b16 v[58:59], v11 offset:33280
    v_mfma_f32_16x16x32_bf16 v[116:119], v[16:19], a[68:71], v[116:119]
    ds_read_b64_tr_b16 v[60:61], v11 offset:30752
    ds_read_b64_tr_b16 v[62:63], v11 offset:33312
    v_mfma_f32_16x16x32_bf16 v[100:103], v[20:23], a[64:67], v[100:103]
    ds_read_b64_tr_b16 v[64:65], v11 offset:30784
    ds_read_b64_tr_b16 v[66:67], v11 offset:33344
    v_mfma_f32_16x16x32_bf16 v[120:123], v[20:23], a[68:71], v[120:123]
    ds_read_b64_tr_b16 v[68:69], v11 offset:30816
    ds_read_b64_tr_b16 v[70:71], v11 offset:33376
    v_mfma_f32_16x16x32_bf16 v[104:107], v[24:27], a[64:67], v[104:107]
    ds_read_b64_tr_b16 v[72:73], v11 offset:30848
    ds_read_b64_tr_b16 v[74:75], v11 offset:33408
    v_mfma_f32_16x16x32_bf16 v[124:127], v[24:27], a[68:71], v[124:127]
    ds_read_b64_tr_b16 v[76:77], v11 offset:35840
    ds_read_b64_tr_b16 v[78:79], v11 offset:38400
    v_mfma_f32_16x16x32_bf16 v[108:111], v[28:31], a[64:67], v[108:111]
    ds_read_b64_tr_b16 v[80:81], v11 offset:35872
    ds_read_b64_tr_b16 v[82:83], v11 offset:38432
    v_mfma_f32_16x16x32_bf16 v[128:131], v[28:31], a[68:71], v[128:131]
    ds_read_b64_tr_b16 v[84:85], v11 offset:35904
    ds_read_b64_tr_b16 v[86:87], v11 offset:38464
    v_mfma_f32_16x16x32_bf16 v[112:115], v[32:35], a[64:67], v[112:115]
    ds_read_b64_tr_b16 v[88:89], v11 offset:35936
    ds_read_b64_tr_b16 v[90:91], v11 offset:38496
    v_mfma_f32_16x16x32_bf16 v[132:135], v[32:35], a[68:71], v[132:135]
    ds_read_b64_tr_b16 v[92:93], v11 offset:35968
    ds_read_b64_tr_b16 v[94:95], v11 offset:38528
    v_mfma_f32_16x16x32_bf16 v[136:139], a[64:67], v[36:39], v[136:139]
    v_mfma_f32_16x16x32_bf16 v[156:159], a[68:71], v[36:39], v[156:159]
    v_mfma_f32_16x16x32_bf16 v[140:143], a[64:67], v[40:43], v[140:143]
    v_mfma_f32_16x16x32_bf16 v[160:163], a[68:71], v[40:43], v[160:163]
    v_mfma_f32_16x16x32_bf16 v[144:147], a[64:67], v[44:47], v[144:147]
    v_mfma_f32_16x16x32_bf16 v[164:167], a[68:71], v[44:47], v[164:167]
    v_mfma_f32_16x16x32_bf16 v[148:151], a[64:67], v[48:51], v[148:151]
    v_mfma_f32_16x16x32_bf16 v[168:171], a[68:71], v[48:51], v[168:171]
    v_mfma_f32_16x16x32_bf16 v[152:155], a[64:67], v[52:55], v[152:155]
    v_mfma_f32_16x16x32_bf16 v[172:175], a[68:71], v[52:55], v[172:175]
    s_cmp_eq_u32 s27, 0
    s_cbranch_scc0 L_h8
    v_mfma_f32_16x16x32_bf16 v[216:219], v[16:19], a[168:171], v[216:219]
    v_mfma_f32_16x16x32_bf16 v[220:223], v[20:23], a[168:171], v[220:223]
    v_mfma_f32_16x16x32_bf16 v[224:227], v[24:27], a[168:171], v[224:227]
    v_mfma_f32_16x16x32_bf16 v[228:231], v[28:31], a[168:171], v[228:231]
    v_mfma_f32_16x16x32_bf16 v[232:235], v[32:35], a[168:171], v[232:235]
    v_mfma_f32_16x16x32_bf16 v[236:239], a[168:171], v[36:39], v[236:239]
    v_mfma_f32_16x16x32_bf16 v[240:243], a[168:171], v[40:43], v[240:243]
    v_mfma_f32_16x16x32_bf16 v[244:247], a[168:171], v[44:47], v[244:247]
    v_mfma_f32_16x16x32_bf16 v[248:251], a[168:171], v[48:51], v[248:251]
    v_mfma_f32_16x16x32_bf16 v[252:255], a[168:171], v[52:55], v[252:255]
    s_nop 7
L_h8:
    s_waitcnt lgkmcnt(0)
    s_waitcnt vmcnt(18)
    s_barrier
    s_add_u32 s28, s86, 8
    s_cmp_ge_u32 s28, 10
    s_cselect_b32 s101, 10, 0
    s_sub_u32 s28, s28, s101
    s_mul_i32 s28, s28, 245760
    s_add_u32 s28, s28, s24
    s_add_u32 m0, s26, 61440
    s_nop 0
    buffer_load_dwordx4 v5, s[8:11], s28 offen lds
    s_add_u32 m0, s26, 62464
    s_nop 0
    buffer_load_dwordx4 v6, s[8:11], s28 offen lds
    s_add_u32 m0, s26, 63488
    s_nop 0
    buffer_load_dwordx4 v7, s[8:11], s28 offen lds
    s_add_u32 m0, s26, 64512
    s_nop 0
    buffer_load_dwordx4 v8, s[8:11], s28 offen lds
    s_add_u32 m0, s26, 65536
    s_nop 0
    buffer_load_dwordx4 v9, s[8:11], s28 offen lds
    v_mfma_f32_16x16x32_bf16 v[96:99], v[56:59], a[72:75], v[96:99]
    ds_read_b128 a[80:83], v14 offset:8192
    ds_read_b128 a[84:87], v14 offset:10240
    v_mfma_f32_16x16x32_bf16 v[116:119], v[56:59], a[76:79], v[116:119]
    ds_read_b128 a[88:91], v15 offset:8192
    ds_read_b128 a[92:95], v15 offset:10240
    v_mfma_f32_16x16x32_bf16 v[100:103], v[60:63], a[72:75], v[100:103]
    ds_read_b64_tr_b16 v[16:17], v10 offset:0
    ds_read_b64_tr_b16 v[18:19], v10 offset:2560
    v_mfma_f32_16x16x32_bf16 v[120:123], v[60:63], a[76:79], v[120:123]
    ds_read_b64_tr_b16 v[20:21], v10 offset:32
    ds_read_b64_tr_b16 v[22:23], v10 offset:2592
    v_mfma_f32_16x16x32_bf16 v[104:107], v[64:67], a[72:75], v[104:107]
    ds_read_b64_tr_b16 v[24:25], v10 offset:64
    ds_read_b64_tr_b16 v[26:27], v10 offset:2624
    v_mfma_f32_16x16x32_bf16 v[124:127], v[64:67], a[76:79], v[124:127]
    ds_read_b64_tr_b16 v[28:29], v10 offset:96
    ds_read_b64_tr_b16 v[30:31], v10 offset:2656
    v_mfma_f32_16x16x32_bf16 v[108:111], v[68:71], a[72:75], v[108:111]
    ds_read_b64_tr_b16 v[32:33], v10 offset:128
    ds_read_b64_tr_b16 v[34:35], v10 offset:2688
    v_mfma_f32_16x16x32_bf16 v[128:131], v[68:71], a[76:79], v[128:131]
    ds_read_b64_tr_b16 v[36:37], v10 offset:5120
    ds_read_b64_tr_b16 v[38:39], v10 offset:7680
    v_mfma_f32_16x16x32_bf16 v[112:115], v[72:75], a[72:75], v[112:115]
    ds_read_b64_tr_b16 v[40:41], v10 offset:5152
    ds_read_b64_tr_b16 v[42:43], v10 offset:7712
    v_mfma_f32_16x16x32_bf16 v[132:135], v[72:75], a[76:79], v[132:135]
    ds_read_b64_tr_b16 v[44:45], v10 offset:5184
    ds_read_b64_tr_b16 v[46:47], v10 offset:7744
    v_mfma_f32_16x16x32_bf16 v[136:139], a[72:75], v[76:79], v[136:139]
    ds_read_b64_tr_b16 v[48:49], v10 offset:5216
    ds_read_b64_tr_b16 v[50:51], v10 offset:7776
    v_mfma_f32_16x16x32_bf16 v[156:159], a[76:79], v[76:79], v[156:159]
    ds_read_b64_tr_b16 v[52:53], v10 offset:5248
    ds_read_b64_tr_b16 v[54:55], v10 offset:7808
    v_mfma_f32_16x16x32_bf16 v[140:143], a[72:75], v[80:83], v[140:143]
    v_mfma_f32_16x16x32_bf16 v[160:163], a[76:79], v[80:83], v[160:163]
    v_mfma_f32_16x16x32_bf16 v[144:147], a[72:75], v[84:87], v[144:147]
    v_mfma_f32_16x16x32_bf16 v[164:167], a[76:79], v[84:87], v[164:167]
    v_mfma_f32_16x16x32_bf16 v[148:151], a[72:75], v[88:91], v[148:151]
    v_mfma_f32_16x16x32_bf16 v[168:171], a[76:79], v[88:91], v[168:171]
    v_mfma_f32_16x16x32_bf16 v[152:155], a[72:75], v[92:95], v[152:155]
    v_mfma_f32_16x16x32_bf16 v[172:175], a[76:79], v[92:95], v[172:175]
    s_cmp_eq_u32 s27, 1
    s_cbranch_scc0 L_h9
    v_mfma_f32_16x16x32_bf16 v[216:219], v[56:59], a[168:171], v[216:219]
    v_mfma_f32_16x16x32_bf16 v[220:223], v[60:63], a[168:171], v[220:223]
    v_mfma_f32_16x16x32_bf16 v[224:227], v[64:67], a[168:171], v[224:227]
    v_mfma_f32_16x16x32_bf16 v[228:231], v[68:71], a[168:171], v[228:231]
    v_mfma_f32_16x16x32_bf16 v[232:235], v[72:75], a[168:171], v[232:235]
    v_mfma_f32_16x16x32_bf16 v[236:239], a[168:171], v[76:79], v[236:239]
    v_mfma_f32_16x16x32_bf16 v[240:243], a[168:171], v[80:83], v[240:243]
    v_mfma_f32_16x16x32_bf16 v[244:247], a[168:171], v[84:87], v[244:247]
    v_mfma_f32_16x16x32_bf16 v[248:251], a[168:171], v[88:91], v[248:251]
    v_mfma_f32_16x16x32_bf16 v[252:255], a[168:171], v[92:95], v[252:255]
    s_nop 7
L_h9:
    s_waitcnt lgkmcnt(0)
    s_add_u32 s29, s86, 8
    s_cmp_ge_u32 s29, 10
    s_cselect_b32 s101, 10, 0
    s_sub_u32 s29, s29, s101
    s_lshl_b32 s29, s29, 7
    s_add_u32 m0, s23, 8192
    s_add_u32 s28, s29, 0
    buffer_load_dwordx4 v4, s[4:7], s28 offen lds
    s_add_u32 m0, s23, 9216
    s_add_u32 s28, s29, 10240
    buffer_load_dwordx4 v1, s[4:7], s28 offen lds
    s_add_u32 m0, s23, 10240
    s_add_u32 s28, s29, 20480
    buffer_load_dwordx4 v4, s[4:7], s28 offen lds
    s_add_u32 m0, s23, 11264
    s_add_u32 s28, s29, 30720
    buffer_load_dwordx4 v1, s[4:7], s28 offen lds
    v_mfma_f32_16x16x32_bf16 v[96:99], v[16:19], a[80:83], v[96:99]
    ds_read_b64_tr_b16 v[56:57], v10 offset:10240
    ds_read_b64_tr_b16 v[58:59], v10 offset:12800
    v_mfma_f32_16x16x32_bf16 v[116:119], v[16:19], a[84:87], v[116:119]
    ds_read_b64_tr_b16 v[60:61], v10 offset:10272
    ds_read_b64_tr_b16 v[62:63], v10 offset:12832
    v_mfma_f32_16x16x32_bf16 v[100:103], v[20:23], a[80:83], v[100:103]
    ds_read_b64_tr_b16 v[64:65], v10 offset:10304
    ds_read_b64_tr_b16 v[66:67], v10 offset:12864
    v_mfma_f32_16x16x32_bf16 v[120:123], v[20:23], a[84:87], v[120:123]
    ds_read_b64_tr_b16 v[68:69], v10 offset:10336
    ds_read_b64_tr_b16 v[70:71], v10 offset:12896
    v_mfma_f32_16x16x32_bf16 v[104:107], v[24:27], a[80:83], v[104:107]
    ds_read_b64_tr_b16 v[72:73], v10 offset:10368
    ds_read_b64_tr_b16 v[74:75], v10 offset:12928
    v_mfma_f32_16x16x32_bf16 v[124:127], v[24:27], a[84:87], v[124:127]
    ds_read_b64_tr_b16 v[76:77], v10 offset:15360
    ds_read_b64_tr_b16 v[78:79], v10 offset:17920
    v_mfma_f32_16x16x32_bf16 v[108:111], v[28:31], a[80:83], v[108:111]
    ds_read_b64_tr_b16 v[80:81], v10 offset:15392
    ds_read_b64_tr_b16 v[82:83], v10 offset:17952
    v_mfma_f32_16x16x32_bf16 v[128:131], v[28:31], a[84:87], v[128:131]
    ds_read_b64_tr_b16 v[84:85], v10 offset:15424
    ds_read_b64_tr_b16 v[86:87], v10 offset:17984
    v_mfma_f32_16x16x32_bf16 v[112:115], v[32:35], a[80:83], v[112:115]
    ds_read_b64_tr_b16 v[88:89], v10 offset:15456
    ds_read_b64_tr_b16 v[90:91], v10 offset:18016
    v_mfma_f32_16x16x32_bf16 v[132:135], v[32:35], a[84:87], v[132:135]
    ds_read_b64_tr_b16 v[92:93], v10 offset:15488
    ds_read_b64_tr_b16 v[94:95], v10 offset:18048
    v_mfma_f32_16x16x32_bf16 v[136:139], a[80:83], v[36:39], v[136:139]
    v_mfma_f32_16x16x32_bf16 v[156:159], a[84:87], v[36:39], v[156:159]
    v_mfma_f32_16x16x32_bf16 v[140:143], a[80:83], v[40:43], v[140:143]
    v_mfma_f32_16x16x32_bf16 v[160:163], a[84:87], v[40:43], v[160:163]
    v_mfma_f32_16x16x32_bf16 v[144:147], a[80:83], v[44:47], v[144:147]
    v_mfma_f32_16x16x32_bf16 v[164:167], a[84:87], v[44:47], v[164:167]
    v_mfma_f32_16x16x32_bf16 v[148:151], a[80:83], v[48:51], v[148:151]
    v_mfma_f32_16x16x32_bf16 v[168:171], a[84:87], v[48:51], v[168:171]
    v_mfma_f32_16x16x32_bf16 v[152:155], a[80:83], v[52:55], v[152:155]
    v_mfma_f32_16x16x32_bf16 v[172:175], a[84:87], v[52:55], v[172:175]
    s_cmp_eq_u32 s27, 2
    s_cbranch_scc0 L_h10
    v_mfma_f32_16x16x32_bf16 v[216:219], v[16:19], a[168:171], v[216:219]
    v_mfma_f32_16x16x32_bf16 v[220:223], v[20:23], a[168:171], v[220:223]
    v_mfma_f32_16x16x32_bf16 v[224:227], v[24:27], a[168:171], v[224:227]
    v_mfma_f32_16x16x32_bf16 v[228:231], v[28:31], a[168:171], v[228:231]
    v_mfma_f32_16x16x32_bf16 v[232:235], v[32:35], a[168:171], v[232:235]
    v_mfma_f32_16x16x32_bf16 v[236:239], a[168:171], v[36:39], v[236:239]
    v_mfma_f32_16x16x32_bf16 v[240:243], a[168:171], v[40:43], v[240:243]
    v_mfma_f32_16x16x32_bf16 v[244:247], a[168:171], v[44:47], v[244:247]
    v_mfma_f32_16x16x32_bf16 v[248:251], a[168:171], v[48:51], v[248:251]
    v_mfma_f32_16x16x32_bf16 v[252:255], a[168:171], v[52:55], v[252:255]
    s_nop 7
L_h10:
    s_waitcnt lgkmcnt(0)
    s_waitcnt vmcnt(18)
    s_barrier
    s_add_u32 s28, s86, 9
    s_cmp_ge_u32 s28, 10
    s_cselect_b32 s101, 10, 0
    s_sub_u32 s28, s28, s101
    s_mul_i32 s28, s28, 245760
    s_add_u32 s28, s28, s24
    s_add_u32 m0, s26, 81920
    s_nop 0
    buffer_load_dwordx4 v5, s[8:11], s28 offen lds
    s_add_u32 m0, s26, 82944
    s_nop 0
    buffer_load_dwordx4 v6, s[8:11], s28 offen lds
    s_add_u32 m0, s26, 83968
    s_nop 0
    buffer_load_dwordx4 v7, s[8:11], s28 offen lds
    s_add_u32 m0, s26, 84992
    s_nop 0
    buffer_load_dwordx4 v8, s[8:11], s28 offen lds
    s_add_u32 m0, s26, 86016
    s_nop 0
    buffer_load_dwordx4 v9, s[8:11], s28 offen lds
    v_mfma_f32_16x16x32_bf16 v[96:99], v[56:59], a[88:91], v[96:99]
    ds_read_b128 a[96:99], v14 offset:0
    ds_read_b128 a[100:103], v14 offset:2048
    v_mfma_f32_16x16x32_bf16 v[116:119], v[56:59], a[92:95], v[116:119]
    ds_read_b128 a[104:107], v15 offset:0
    ds_read_b128 a[108:111], v15 offset:2048
    v_mfma_f32_16x16x32_bf16 v[100:103], v[60:63], a[88:91], v[100:103]
    ds_read_b64_tr_b16 v[16:17], v10 offset:20480
    ds_read_b64_tr_b16 v[18:19], v10 offset:23040
    v_mfma_f32_16x16x32_bf16 v[120:123], v[60:63], a[92:95], v[120:123]
    ds_read_b64_tr_b16 v[20:21], v10 offset:20512
    ds_read_b64_tr_b16 v[22:23], v10 offset:23072
    v_mfma_f32_16x16x32_bf16 v[104:107], v[64:67], a[88:91], v[104:107]
    ds_read_b64_tr_b16 v[24:25], v10 offset:20544
    ds_read_b64_tr_b16 v[26:27], v10 offset:23104
    v_mfma_f32_16x16x32_bf16 v[124:127], v[64:67], a[92:95], v[124:127]
    ds_read_b64_tr_b16 v[28:29], v10 offset:20576
    ds_read_b64_tr_b16 v[30:31], v10 offset:23136
    v_mfma_f32_16x16x32_bf16 v[108:111], v[68:71], a[88:91], v[108:111]
    ds_read_b64_tr_b16 v[32:33], v10 offset:20608
    ds_read_b64_tr_b16 v[34:35], v10 offset:23168
    v_mfma_f32_16x16x32_bf16 v[128:131], v[68:71], a[92:95], v[128:131]
    ds_read_b64_tr_b16 v[36:37], v10 offset:25600
    ds_read_b64_tr_b16 v[38:39], v10 offset:28160
    v_mfma_f32_16x16x32_bf16 v[112:115], v[72:75], a[88:91], v[112:115]
    ds_read_b64_tr_b16 v[40:41], v10 offset:25632
    ds_read_b64_tr_b16 v[42:43], v10 offset:28192
    v_mfma_f32_16x16x32_bf16 v[132:135], v[72:75], a[92:95], v[132:135]
    ds_read_b64_tr_b16 v[44:45], v10 offset:25664
    ds_read_b64_tr_b16 v[46:47], v10 offset:28224
    v_mfma_f32_16x16x32_bf16 v[136:139], a[88:91], v[76:79], v[136:139]
    ds_read_b64_tr_b16 v[48:49], v10 offset:25696
    ds_read_b64_tr_b16 v[50:51], v10 offset:28256
    v_mfma_f32_16x16x32_bf16 v[156:159], a[92:95], v[76:79], v[156:159]
    ds_read_b64_tr_b16 v[52:53], v10 offset:25728
    ds_read_b64_tr_b16 v[54:55], v10 offset:28288
    v_mfma_f32_16x16x32_bf16 v[140:143], a[88:91], v[80:83], v[140:143]
    v_mfma_f32_16x16x32_bf16 v[160:163], a[92:95], v[80:83], v[160:163]
    v_mfma_f32_16x16x32_bf16 v[144:147], a[88:91], v[84:87], v[144:147]
    v_mfma_f32_16x16x32_bf16 v[164:167], a[92:95], v[84:87], v[164:167]
    v_mfma_f32_16x16x32_bf16 v[148:151], a[88:91], v[88:91], v[148:151]
    v_mfma_f32_16x16x32_bf16 v[168:171], a[92:95], v[88:91], v[168:171]
    v_mfma_f32_16x16x32_bf16 v[152:155], a[88:91], v[92:95], v[152:155]
    v_mfma_f32_16x16x32_bf16 v[172:175], a[92:95], v[92:95], v[172:175]
    s_cmp_eq_u32 s27, 3
    s_cbranch_scc0 L_h11
    v_mfma_f32_16x16x32_bf16 v[216:219], v[56:59], a[168:171], v[216:219]
    v_mfma_f32_16x16x32_bf16 v[220:223], v[60:63], a[168:171], v[220:223]
    v_mfma_f32_16x16x32_bf16 v[224:227], v[64:67], a[168:171], v[224:227]
    v_mfma_f32_16x16x32_bf16 v[228:231], v[68:71], a[168:171], v[228:231]
    v_mfma_f32_16x16x32_bf16 v[232:235], v[72:75], a[168:171], v[232:235]
    v_mfma_f32_16x16x32_bf16 v[236:239], a[168:171], v[76:79], v[236:239]
    v_mfma_f32_16x16x32_bf16 v[240:243], a[168:171], v[80:83], v[240:243]
    v_mfma_f32_16x16x32_bf16 v[244:247], a[168:171], v[84:87], v[244:247]
    v_mfma_f32_16x16x32_bf16 v[248:251], a[168:171], v[88:91], v[248:251]
    v_mfma_f32_16x16x32_bf16 v[252:255], a[168:171], v[92:95], v[252:255]
    s_nop 7
L_h11:
    s_waitcnt lgkmcnt(0)
    s_add_u32 s29, s86, 9
    s_cmp_ge_u32 s29, 10
    s_cselect_b32 s101, 10, 0
    s_sub_u32 s29, s29, s101
    s_lshl_b32 s29, s29, 7
    s_add_u32 m0, s23, 0
    s_add_u32 s28, s29, 0
    buffer_load_dwordx4 v4, s[4:7], s28 offen lds
    s_add_u32 m0, s23, 1024
    s_add_u32 s28, s29, 10240
    buffer_load_dwordx4 v1, s[4:7], s28 offen lds
    s_add_u32 m0, s23, 2048
    s_add_u32 s28, s29, 20480
    buffer_load_dwordx4 v4, s[4:7], s28 offen lds
    s_add_u32 m0, s23, 3072
    s_add_u32 s28, s29, 30720
    buffer_load_dwordx4 v1, s[4:7], s28 offen lds
    v_mfma_f32_16x16x32_bf16 v[96:99], v[16:19], a[96:99], v[96:99]
    ds_read_b64_tr_b16 v[56:57], v10 offset:30720
    ds_read_b64_tr_b16 v[58:59], v10 offset:33280
    v_mfma_f32_16x16x32_bf16 v[116:119], v[16:19], a[100:103], v[116:119]
    ds_read_b64_tr_b16 v[60:61], v10 offset:30752
    ds_read_b64_tr_b16 v[62:63], v10 offset:33312
    v_mfma_f32_16x16x32_bf16 v[100:103], v[20:23], a[96:99], v[100:103]
    ds_read_b64_tr_b16 v[64:65], v10 offset:30784
    ds_read_b64_tr_b16 v[66:67], v10 offset:33344
    v_mfma_f32_16x16x32_bf16 v[120:123], v[20:23], a[100:103], v[120:123]
    ds_read_b64_tr_b16 v[68:69], v10 offset:30816
    ds_read_b64_tr_b16 v[70:71], v10 offset:33376
    v_mfma_f32_16x16x32_bf16 v[104:107], v[24:27], a[96:99], v[104:107]
    ds_read_b64_tr_b16 v[72:73], v10 offset:30848
    ds_read_b64_tr_b16 v[74:75], v10 offset:33408
    v_mfma_f32_16x16x32_bf16 v[124:127], v[24:27], a[100:103], v[124:127]
    ds_read_b64_tr_b16 v[76:77], v10 offset:35840
    ds_read_b64_tr_b16 v[78:79], v10 offset:38400
    v_mfma_f32_16x16x32_bf16 v[108:111], v[28:31], a[96:99], v[108:111]
    ds_read_b64_tr_b16 v[80:81], v10 offset:35872
    ds_read_b64_tr_b16 v[82:83], v10 offset:38432
    v_mfma_f32_16x16x32_bf16 v[128:131], v[28:31], a[100:103], v[128:131]
    ds_read_b64_tr_b16 v[84:85], v10 offset:35904
    ds_read_b64_tr_b16 v[86:87], v10 offset:38464
    v_mfma_f32_16x16x32_bf16 v[112:115], v[32:35], a[96:99], v[112:115]
    ds_read_b64_tr_b16 v[88:89], v10 offset:35936
    ds_read_b64_tr_b16 v[90:91], v10 offset:38496
    v_mfma_f32_16x16x32_bf16 v[132:135], v[32:35], a[100:103], v[132:135]
    ds_read_b64_tr_b16 v[92:93], v10 offset:35968
    ds_read_b64_tr_b16 v[94:95], v10 offset:38528
    v_mfma_f32_16x16x32_bf16 v[136:139], a[96:99], v[36:39], v[136:139]
    v_mfma_f32_16x16x32_bf16 v[156:159], a[100:103], v[36:39], v[156:159]
    v_mfma_f32_16x16x32_bf16 v[140:143], a[96:99], v[40:43], v[140:143]
    v_mfma_f32_16x16x32_bf16 v[160:163], a[100:103], v[40:43], v[160:163]
    v_mfma_f32_16x16x32_bf16 v[144:147], a[96:99], v[44:47], v[144:147]
    v_mfma_f32_16x16x32_bf16 v[164:167], a[100:103], v[44:47], v[164:167]
    v_mfma_f32_16x16x32_bf16 v[148:151], a[96:99], v[48:51], v[148:151]
    v_mfma_f32_16x16x32_bf16 v[168:171], a[100:103], v[48:51], v[168:171]
    v_mfma_f32_16x16x32_bf16 v[152:155], a[96:99], v[52:55], v[152:155]
    v_mfma_f32_16x16x32_bf16 v[172:175], a[100:103], v[52:55], v[172:175]
    s_cmp_eq_u32 s27, 0
    s_cbranch_scc0 L_h12
    v_mfma_f32_16x16x32_bf16 v[216:219], v[16:19], a[172:175], v[216:219]
    v_mfma_f32_16x16x32_bf16 v[220:223], v[20:23], a[172:175], v[220:223]
    v_mfma_f32_16x16x32_bf16 v[224:227], v[24:27], a[172:175], v[224:227]
    v_mfma_f32_16x16x32_bf16 v[228:231], v[28:31], a[172:175], v[228:231]
    v_mfma_f32_16x16x32_bf16 v[232:235], v[32:35], a[172:175], v[232:235]
    v_mfma_f32_16x16x32_bf16 v[236:239], a[172:175], v[36:39], v[236:239]
    v_mfma_f32_16x16x32_bf16 v[240:243], a[172:175], v[40:43], v[240:243]
    v_mfma_f32_16x16x32_bf16 v[244:247], a[172:175], v[44:47], v[244:247]
    v_mfma_f32_16x16x32_bf16 v[248:251], a[172:175], v[48:51], v[248:251]
    v_mfma_f32_16x16x32_bf16 v[252:255], a[172:175], v[52:55], v[252:255]
    s_nop 7
L_h12:
    s_waitcnt lgkmcnt(0)
    s_waitcnt vmcnt(18)
    s_barrier
    s_add_u32 s28, s87, 0
    s_cmp_ge_u32 s28, 20
    s_cselect_b32 s101, 20, 0
    s_sub_u32 s28, s28, s101
    s_mul_i32 s28, s28, 122880
    s_add_u32 s28, s28, s25
    s_add_u32 m0, s26, 0
    s_nop 0
    buffer_load_dwordx4 v5, s[8:11], s28 offen lds
    s_add_u32 m0, s26, 1024
    s_nop 0
    buffer_load_dwordx4 v6, s[8:11], s28 offen lds
    s_add_u32 m0, s26, 2048
    s_nop 0
    buffer_load_dwordx4 v7, s[8:11], s28 offen lds
    s_add_u32 m0, s26, 3072
    s_nop 0
    buffer_load_dwordx4 v8, s[8:11], s28 offen lds
    s_add_u32 m0, s26, 4096
    s_nop 0
    buffer_load_dwordx4 v9, s[8:11], s28 offen lds
    v_mfma_f32_16x16x32_bf16 v[96:99], v[56:59], a[104:107], v[96:99]
    ds_read_b128 a[112:115], v14 offset:4096
    ds_read_b128 a[116:119], v14 offset:6144
    v_mfma_f32_16x16x32_bf16 v[116:119], v[56:59], a[108:111], v[116:119]
    ds_read_b128 a[120:123], v15 offset:4096
    ds_read_b128 a[124:127], v15 offset:6144
    v_mfma_f32_16x16x32_bf16 v[100:103], v[60:63], a[104:107], v[100:103]
    ds_read_b64_tr_b16 v[16:17], v10 offset:40960
    ds_read_b64_tr_b16 v[18:19], v10 offset:43520
    v_mfma_f32_16x16x32_bf16 v[120:123], v[60:63], a[108:111], v[120:123]
    ds_read_b64_tr_b16 v[20:21], v10 offset:40992
    ds_read_b64_tr_b16 v[22:23], v10 offset:43552
    v_mfma_f32_16x16x32_bf16 v[104:107], v[64:67], a[104:107], v[104:107]
    ds_read_b64_tr_b16 v[24:25], v10 offset:41024
    ds_read_b64_tr_b16 v[26:27], v10 offset:43584
    v_mfma_f32_16x16x32_bf16 v[124:127], v[64:67], a[108:111], v[124:127]
    ds_read_b64_tr_b16 v[28:29], v10 offset:41056
    ds_read_b64_tr_b16 v[30:31], v10 offset:43616
    v_mfma_f32_16x16x32_bf16 v[108:111], v[68:71], a[104:107], v[108:111]
    ds_read_b64_tr_b16 v[32:33], v10 offset:41088
    ds_read_b64_tr_b16 v[34:35], v10 offset:43648
    v_mfma_f32_16x16x32_bf16 v[128:131], v[68:71], a[108:111], v[128:131]
    ds_read_b64_tr_b16 v[36:37], v10 offset:46080
    ds_read_b64_tr_b16 v[38:39], v10 offset:48640
    v_mfma_f32_16x16x32_bf16 v[112:115], v[72:75], a[104:107], v[112:115]
    ds_read_b64_tr_b16 v[40:41], v10 offset:46112
    ds_read_b64_tr_b16 v[42:43], v10 offset:48672
    v_mfma_f32_16x16x32_bf16 v[132:135], v[72:75], a[108:111], v[132:135]
    ds_read_b64_tr_b16 v[44:45], v10 offset:46144
    ds_read_b64_tr_b16 v[46:47], v10 offset:48704
    v_mfma_f32_16x16x32_bf16 v[136:139], a[104:107], v[76:79], v[136:139]
    ds_read_b64_tr_b16 v[48:49], v10 offset:46176
    ds_read_b64_tr_b16 v[50:51], v10 offset:48736
    v_mfma_f32_16x16x32_bf16 v[156:159], a[108:111], v[76:79], v[156:159]
    ds_read_b64_tr_b16 v[52:53], v10 offset:46208
    ds_read_b64_tr_b16 v[54:55], v10 offset:48768
    v_mfma_f32_16x16x32_bf16 v[140:143], a[104:107], v[80:83], v[140:143]
    v_mfma_f32_16x16x32_bf16 v[160:163], a[108:111], v[80:83], v[160:163]
    v_mfma_f32_16x16x32_bf16 v[144:147], a[104:107], v[84:87], v[144:147]
    v_mfma_f32_16x16x32_bf16 v[164:167], a[108:111], v[84:87], v[164:167]
    v_mfma_f32_16x16x32_bf16 v[148:151], a[104:107], v[88:91], v[148:151]
    v_mfma_f32_16x16x32_bf16 v[168:171], a[108:111], v[88:91], v[168:171]
    v_mfma_f32_16x16x32_bf16 v[152:155], a[104:107], v[92:95], v[152:155]
    v_mfma_f32_16x16x32_bf16 v[172:175], a[108:111], v[92:95], v[172:175]
    s_cmp_eq_u32 s27, 1
    s_cbranch_scc0 L_h13
    v_mfma_f32_16x16x32_bf16 v[216:219], v[56:59], a[172:175], v[216:219]
    v_mfma_f32_16x16x32_bf16 v[220:223], v[60:63], a[172:175], v[220:223]
    v_mfma_f32_16x16x32_bf16 v[224:227], v[64:67], a[172:175], v[224:227]
    v_mfma_f32_16x16x32_bf16 v[228:231], v[68:71], a[172:175], v[228:231]
    v_mfma_f32_16x16x32_bf16 v[232:235], v[72:75], a[172:175], v[232:235]
    v_mfma_f32_16x16x32_bf16 v[236:239], a[172:175], v[76:79], v[236:239]
    v_mfma_f32_16x16x32_bf16 v[240:243], a[172:175], v[80:83], v[240:243]
    v_mfma_f32_16x16x32_bf16 v[244:247], a[172:175], v[84:87], v[244:247]
    v_mfma_f32_16x16x32_bf16 v[248:251], a[172:175], v[88:91], v[248:251]
    v_mfma_f32_16x16x32_bf16 v[252:255], a[172:175], v[92:95], v[252:255]
    s_nop 7
L_h13:
    s_waitcnt lgkmcnt(0)
    v_mfma_f32_16x16x32_bf16 v[96:99], v[16:19], a[112:115], v[96:99]
    ds_read_b64_tr_b16 v[56:57], v10 offset:51200
    ds_read_b64_tr_b16 v[58:59], v10 offset:53760
    v_mfma_f32_16x16x32_bf16 v[116:119], v[16:19], a[116:119], v[116:119]
    ds_read_b64_tr_b16 v[60:61], v10 offset:51232
    ds_read_b64_tr_b16 v[62:63], v10 offset:53792
    v_mfma_f32_16x16x32_bf16 v[100:103], v[20:23], a[112:115], v[100:103]
    ds_read_b64_tr_b16 v[64:65], v10 offset:51264
    ds_read_b64_tr_b16 v[66:67], v10 offset:53824
    v_mfma_f32_16x16x32_bf16 v[120:123], v[20:23], a[116:119], v[120:123]
    ds_read_b64_tr_b16 v[68:69], v10 offset:51296
    ds_read_b64_tr_b16 v[70:71], v10 offset:53856
    v_mfma_f32_16x16x32_bf16 v[104:107], v[24:27], a[112:115], v[104:107]
    ds_read_b64_tr_b16 v[72:73], v10 offset:51328
    ds_read_b64_tr_b16 v[74:75], v10 offset:53888
    v_mfma_f32_16x16x32_bf16 v[124:127], v[24:27], a[116:119], v[124:127]
    ds_read_b64_tr_b16 v[76:77], v10 offset:56320
    ds_read_b64_tr_b16 v[78:79], v10 offset:58880
    v_mfma_f32_16x16x32_bf16 v[108:111], v[28:31], a[112:115], v[108:111]
    ds_read_b64_tr_b16 v[80:81], v10 offset:56352
    ds_read_b64_tr_b16 v[82:83], v10 offset:58912
    v_mfma_f32_16x16x32_bf16 v[128:131], v[28:31], a[116:119], v[128:131]
    ds_read_b64_tr_b16 v[84:85], v10 offset:56384
    ds_read_b64_tr_b16 v[86:87], v10 offset:58944
    v_mfma_f32_16x16x32_bf16 v[112:115], v[32:35], a[112:115], v[112:115]
    ds_read_b64_tr_b16 v[88:89], v10 offset:56416
    ds_read_b64_tr_b16 v[90:91], v10 offset:58976
    v_mfma_f32_16x16x32_bf16 v[132:135], v[32:35], a[116:119], v[132:135]
    ds_read_b64_tr_b16 v[92:93], v10 offset:56448
    ds_read_b64_tr_b16 v[94:95], v10 offset:59008
    v_mfma_f32_16x16x32_bf16 v[136:139], a[112:115], v[36:39], v[136:139]
    v_mfma_f32_16x16x32_bf16 v[156:159], a[116:119], v[36:39], v[156:159]
    v_mfma_f32_16x16x32_bf16 v[140:143], a[112:115], v[40:43], v[140:143]
    v_mfma_f32_16x16x32_bf16 v[160:163], a[116:119], v[40:43], v[160:163]
    v_mfma_f32_16x16x32_bf16 v[144:147], a[112:115], v[44:47], v[144:147]
    v_mfma_f32_16x16x32_bf16 v[164:167], a[116:119], v[44:47], v[164:167]
    v_mfma_f32_16x16x32_bf16 v[148:151], a[112:115], v[48:51], v[148:151]
    v_mfma_f32_16x16x32_bf16 v[168:171], a[116:119], v[48:51], v[168:171]
    v_mfma_f32_16x16x32_bf16 v[152:155], a[112:115], v[52:55], v[152:155]
    v_mfma_f32_16x16x32_bf16 v[172:175], a[116:119], v[52:55], v[172:175]
    s_cmp_eq_u32 s27, 2
    s_cbranch_scc0 L_h14
    v_mfma_f32_16x16x32_bf16 v[216:219], v[16:19], a[172:175], v[216:219]
    v_mfma_f32_16x16x32_bf16 v[220:223], v[20:23], a[172:175], v[220:223]
    v_mfma_f32_16x16x32_bf16 v[224:227], v[24:27], a[172:175], v[224:227]
    v_mfma_f32_16x16x32_bf16 v[228:231], v[28:31], a[172:175], v[228:231]
    v_mfma_f32_16x16x32_bf16 v[232:235], v[32:35], a[172:175], v[232:235]
    v_mfma_f32_16x16x32_bf16 v[236:239], a[172:175], v[36:39], v[236:239]
    v_mfma_f32_16x16x32_bf16 v[240:243], a[172:175], v[40:43], v[240:243]
    v_mfma_f32_16x16x32_bf16 v[244:247], a[172:175], v[44:47], v[244:247]
    v_mfma_f32_16x16x32_bf16 v[248:251], a[172:175], v[48:51], v[248:251]
    v_mfma_f32_16x16x32_bf16 v[252:255], a[172:175], v[52:55], v[252:255]
    s_nop 7
L_h14:
    s_waitcnt lgkmcnt(0)
    s_waitcnt vmcnt(14)
    s_barrier
    s_add_u32 s28, s87, 4
    s_cmp_ge_u32 s28, 20
    s_cselect_b32 s101, 20, 0
    s_sub_u32 s28, s28, s101
    s_mul_i32 s28, s28, 122880
    s_add_u32 s28, s28, s25
    s_add_u32 m0, s26, 20480
    s_nop 0
    buffer_load_dwordx4 v5, s[8:11], s28 offen lds
    s_add_u32 m0, s26, 21504
    s_nop 0
    buffer_load_dwordx4 v6, s[8:11], s28 offen lds
    s_add_u32 m0, s26, 22528
    s_nop 0
    buffer_load_dwordx4 v7, s[8:11], s28 offen lds
    s_add_u32 m0, s26, 23552
    s_nop 0
    buffer_load_dwordx4 v8, s[8:11], s28 offen lds
    s_add_u32 m0, s26, 24576
    s_nop 0
    buffer_load_dwordx4 v9, s[8:11], s28 offen lds
    v_mfma_f32_16x16x32_bf16 v[96:99], v[56:59], a[120:123], v[96:99]
    ds_read_b128 a[128:131], v14 offset:8192
    ds_read_b128 a[132:135], v14 offset:10240
    v_mfma_f32_16x16x32_bf16 v[116:119], v[56:59], a[124:127], v[116:119]
    ds_read_b128 a[136:139], v15 offset:8192
    ds_read_b128 a[140:143], v15 offset:10240
    v_mfma_f32_16x16x32_bf16 v[100:103], v[60:63], a[120:123], v[100:103]
    ds_read_b64_tr_b16 v[16:17], v11 offset:0
    ds_read_b64_tr_b16 v[18:19], v11 offset:2560
    v_mfma_f32_16x16x32_bf16 v[120:123], v[60:63], a[124:127], v[120:123]
    ds_read_b64_tr_b16 v[20:21], v11 offset:32
    ds_read_b64_tr_b16 v[22:23], v11 offset:2592
    v_mfma_f32_16x16x32_bf16 v[104:107], v[64:67], a[120:123], v[104:107]
    ds_read_b64_tr_b16 v[24:25], v11 offset:64
    ds_read_b64_tr_b16 v[26:27], v11 offset:2624
    v_mfma_f32_16x16x32_bf16 v[124:127], v[64:67], a[124:127], v[124:127]
    ds_read_b64_tr_b16 v[28:29], v11 offset:96
    ds_read_b64_tr_b16 v[30:31], v11 offset:2656
    v_mfma_f32_16x16x32_bf16 v[108:111], v[68:71], a[120:123], v[108:111]
    ds_read_b64_tr_b16 v[32:33], v11 offset:128
    ds_read_b64_tr_b16 v[34:35], v11 offset:2688
    v_mfma_f32_16x16x32_bf16 v[128:131], v[68:71], a[124:127], v[128:131]
    ds_read_b64_tr_b16 v[36:37], v11 offset:5120
    ds_read_b64_tr_b16 v[38:39], v11 offset:7680
    v_mfma_f32_16x16x32_bf16 v[112:115], v[72:75], a[120:123], v[112:115]
    ds_read_b64_tr_b16 v[40:41], v11 offset:5152
    ds_read_b64_tr_b16 v[42:43], v11 offset:7712
    v_mfma_f32_16x16x32_bf16 v[132:135], v[72:75], a[124:127], v[132:135]
    ds_read_b64_tr_b16 v[44:45], v11 offset:5184
    ds_read_b64_tr_b16 v[46:47], v11 offset:7744
    v_mfma_f32_16x16x32_bf16 v[136:139], a[120:123], v[76:79], v[136:139]
    ds_read_b64_tr_b16 v[48:49], v11 offset:5216
    ds_read_b64_tr_b16 v[50:51], v11 offset:7776
    v_mfma_f32_16x16x32_bf16 v[156:159], a[124:127], v[76:79], v[156:159]
    ds_read_b64_tr_b16 v[52:53], v11 offset:5248
    ds_read_b64_tr_b16 v[54:55], v11 offset:7808
    v_mfma_f32_16x16x32_bf16 v[140:143], a[120:123], v[80:83], v[140:143]
    v_mfma_f32_16x16x32_bf16 v[160:163], a[124:127], v[80:83], v[160:163]
    v_mfma_f32_16x16x32_bf16 v[144:147], a[120:123], v[84:87], v[144:147]
    v_mfma_f32_16x16x32_bf16 v[164:167], a[124:127], v[84:87], v[164:167]
    v_mfma_f32_16x16x32_bf16 v[148:151], a[120:123], v[88:91], v[148:151]
    v_mfma_f32_16x16x32_bf16 v[168:171], a[124:127], v[88:91], v[168:171]
    v_mfma_f32_16x16x32_bf16 v[152:155], a[120:123], v[92:95], v[152:155]
    v_mfma_f32_16x16x32_bf16 v[172:175], a[124:127], v[92:95], v[172:175]
    s_cmp_eq_u32 s27, 3
    s_cbranch_scc0 L_h15
    v_mfma_f32_16x16x32_bf16 v[216:219], v[56:59], a[172:175], v[216:219]
    v_mfma_f32_16x16x32_bf16 v[220:223], v[60:63], a[172:175], v[220:223]
    v_mfma_f32_16x16x32_bf16 v[224:227], v[64:67], a[172:175], v[224:227]
    v_mfma_f32_16x16x32_bf16 v[228:231], v[68:71], a[172:175], v[228:231]
    v_mfma_f32_16x16x32_bf16 v[232:235], v[72:75], a[172:175], v[232:235]
    v_mfma_f32_16x16x32_bf16 v[236:239], a[172:175], v[76:79], v[236:239]
    v_mfma_f32_16x16x32_bf16 v[240:243], a[172:175], v[80:83], v[240:243]
    v_mfma_f32_16x16x32_bf16 v[244:247], a[172:175], v[84:87], v[244:247]
    v_mfma_f32_16x16x32_bf16 v[248:251], a[172:175], v[88:91], v[248:251]
    v_mfma_f32_16x16x32_bf16 v[252:255], a[172:175], v[92:95], v[252:255]
    s_nop 7
L_h15:
    s_waitcnt lgkmcnt(0)
    v_mfma_f32_16x16x32_bf16 v[96:99], v[16:19], a[128:131], v[96:99]
    ds_read_b64_tr_b16 v[56:57], v11 offset:10240
    ds_read_b64_tr_b16 v[58:59], v11 offset:12800
    v_mfma_f32_16x16x32_bf16 v[116:119], v[16:19], a[132:135], v[116:119]
    ds_read_b64_tr_b16 v[60:61], v11 offset:10272
    ds_read_b64_tr_b16 v[62:63], v11 offset:12832
    v_mfma_f32_16x16x32_bf16 v[100:103], v[20:23], a[128:131], v[100:103]
    ds_read_b64_tr_b16 v[64:65], v11 offset:10304
    ds_read_b64_tr_b16 v[66:67], v11 offset:12864
    v_mfma_f32_16x16x32_bf16 v[120:123], v[20:23], a[132:135], v[120:123]
    ds_read_b64_tr_b16 v[68:69], v11 offset:10336
    ds_read_b64_tr_b16 v[70:71], v11 offset:12896
    v_mfma_f32_16x16x32_bf16 v[104:107], v[24:27], a[128:131], v[104:107]
    ds_read_b64_tr_b16 v[72:73], v11 offset:10368
    ds_read_b64_tr_b16 v[74:75], v11 offset:12928
    v_mfma_f32_16x16x32_bf16 v[124:127], v[24:27], a[132:135], v[124:127]
    ds_read_b64_tr_b16 v[76:77], v11 offset:15360
    ds_read_b64_tr_b16 v[78:79], v11 offset:17920
    v_mfma_f32_16x16x32_bf16 v[108:111], v[28:31], a[128:131], v[108:111]
    ds_read_b64_tr_b16 v[80:81], v11 offset:15392
    ds_read_b64_tr_b16 v[82:83], v11 offset:17952
    v_mfma_f32_16x16x32_bf16 v[128:131], v[28:31], a[132:135], v[128:131]
    ds_read_b64_tr_b16 v[84:85], v11 offset:15424
    ds_read_b64_tr_b16 v[86:87], v11 offset:17984
    v_mfma_f32_16x16x32_bf16 v[112:115], v[32:35], a[128:131], v[112:115]
    ds_read_b64_tr_b16 v[88:89], v11 offset:15456
    ds_read_b64_tr_b16 v[90:91], v11 offset:18016
    v_mfma_f32_16x16x32_bf16 v[132:135], v[32:35], a[132:135], v[132:135]
    ds_read_b64_tr_b16 v[92:93], v11 offset:15488
    ds_read_b64_tr_b16 v[94:95], v11 offset:18048
    v_mfma_f32_16x16x32_bf16 v[136:139], a[128:131], v[36:39], v[136:139]
    v_mfma_f32_16x16x32_bf16 v[156:159], a[132:135], v[36:39], v[156:159]
    v_mfma_f32_16x16x32_bf16 v[140:143], a[128:131], v[40:43], v[140:143]
    v_mfma_f32_16x16x32_bf16 v[160:163], a[132:135], v[40:43], v[160:163]
    v_mfma_f32_16x16x32_bf16 v[144:147], a[128:131], v[44:47], v[144:147]
    v_mfma_f32_16x16x32_bf16 v[164:167], a[132:135], v[44:47], v[164:167]
    v_mfma_f32_16x16x32_bf16 v[148:151], a[128:131], v[48:51], v[148:151]
    v_mfma_f32_16x16x32_bf16 v[168:171], a[132:135], v[48:51], v[168:171]
    v_mfma_f32_16x16x32_bf16 v[152:155], a[128:131], v[52:55], v[152:155]
    v_mfma_f32_16x16x32_bf16 v[172:175], a[132:135], v[52:55], v[172:175]
    s_cmp_eq_u32 s27, 0
    s_cbranch_scc0 L_h16
    v_mfma_f32_16x16x32_bf16 v[216:219], v[16:19], a[176:179], v[216:219]
    v_mfma_f32_16x16x32_bf16 v[220:223], v[20:23], a[176:179], v[220:223]
    v_mfma_f32_16x16x32_bf16 v[224:227], v[24:27], a[176:179], v[224:227]
    v_mfma_f32_16x16x32_bf16 v[228:231], v[28:31], a[176:179], v[228:231]
    v_mfma_f32_16x16x32_bf16 v[232:235], v[32:35], a[176:179], v[232:235]
    v_mfma_f32_16x16x32_bf16 v[236:239], a[176:179], v[36:39], v[236:239]
    v_mfma_f32_16x16x32_bf16 v[240:243], a[176:179], v[40:43], v[240:243]
    v_mfma_f32_16x16x32_bf16 v[244:247], a[176:179], v[44:47], v[244:247]
    v_mfma_f32_16x16x32_bf16 v[248:251], a[176:179], v[48:51], v[248:251]
    v_mfma_f32_16x16x32_bf16 v[252:255], a[176:179], v[52:55], v[252:255]
    s_nop 7
L_h16:
    s_waitcnt lgkmcnt(0)
    s_waitcnt vmcnt(10)
    s_barrier
    s_add_u32 s28, s87, 8
    s_cmp_ge_u32 s28, 20
    s_cselect_b32 s101, 20, 0
    s_sub_u32 s28, s28, s101
    s_mul_i32 s28, s28, 122880
    s_add_u32 s28, s28, s25
    s_add_u32 m0, s26, 40960
    s_nop 0
    buffer_load_dwordx4 v5, s[8:11], s28 offen lds
    s_add_u32 m0, s26, 41984
    s_nop 0
    buffer_load_dwordx4 v6, s[8:11], s28 offen lds
    s_add_u32 m0, s26, 43008
    s_nop 0
    buffer_load_dwordx4 v7, s[8:11], s28 offen lds
    s_add_u32 m0, s26, 44032
    s_nop 0
    buffer_load_dwordx4 v8, s[8:11], s28 offen lds
    s_add_u32 m0, s26, 45056
    s_nop 0
    buffer_load_dwordx4 v9, s[8:11], s28 offen lds
    v_mfma_f32_16x16x32_bf16 v[96:99], v[56:59], a[136:139], v[96:99]
    ds_read_b128 a[144:147], v14 offset:0
    ds_read_b128 a[148:151], v14 offset:2048
    v_mfma_f32_16x16x32_bf16 v[116:119], v[56:59], a[140:143], v[116:119]
    ds_read_b128 a[152:155], v15 offset:0
    ds_read_b128 a[156:159], v15 offset:2048
    v_mfma_f32_16x16x32_bf16 v[100:103], v[60:63], a[136:139], v[100:103]
    ds_read_b64_tr_b16 v[16:17], v11 offset:20480
    ds_read_b64_tr_b16 v[18:19], v11 offset:23040
    v_mfma_f32_16x16x32_bf16 v[120:123], v[60:63], a[140:143], v[120:123]
    ds_read_b64_tr_b16 v[20:21], v11 offset:20512
    ds_read_b64_tr_b16 v[22:23], v11 offset:23072
    v_mfma_f32_16x16x32_bf16 v[104:107], v[64:67], a[136:139], v[104:107]
    ds_read_b64_tr_b16 v[24:25], v11 offset:20544
    ds_read_b64_tr_b16 v[26:27], v11 offset:23104
    v_mfma_f32_16x16x32_bf16 v[124:127], v[64:67], a[140:143], v[124:127]
    ds_read_b64_tr_b16 v[28:29], v11 offset:20576
    ds_read_b64_tr_b16 v[30:31], v11 offset:23136
    v_mfma_f32_16x16x32_bf16 v[108:111], v[68:71], a[136:139], v[108:111]
    ds_read_b64_tr_b16 v[32:33], v11 offset:20608
    ds_read_b64_tr_b16 v[34:35], v11 offset:23168
    v_mfma_f32_16x16x32_bf16 v[128:131], v[68:71], a[140:143], v[128:131]
    ds_read_b64_tr_b16 v[36:37], v11 offset:25600
    ds_read_b64_tr_b16 v[38:39], v11 offset:28160
    v_mfma_f32_16x16x32_bf16 v[112:115], v[72:75], a[136:139], v[112:115]
    ds_read_b64_tr_b16 v[40:41], v11 offset:25632
    ds_read_b64_tr_b16 v[42:43], v11 offset:28192
    v_mfma_f32_16x16x32_bf16 v[132:135], v[72:75], a[140:143], v[132:135]
    ds_read_b64_tr_b16 v[44:45], v11 offset:25664
    ds_read_b64_tr_b16 v[46:47], v11 offset:28224
    v_mfma_f32_16x16x32_bf16 v[136:139], a[136:139], v[76:79], v[136:139]
    ds_read_b64_tr_b16 v[48:49], v11 offset:25696
    ds_read_b64_tr_b16 v[50:51], v11 offset:28256
    v_mfma_f32_16x16x32_bf16 v[156:159], a[140:143], v[76:79], v[156:159]
    ds_read_b64_tr_b16 v[52:53], v11 offset:25728
    ds_read_b64_tr_b16 v[54:55], v11 offset:28288
    v_mfma_f32_16x16x32_bf16 v[140:143], a[136:139], v[80:83], v[140:143]
    v_mfma_f32_16x16x32_bf16 v[160:163], a[140:143], v[80:83], v[160:163]
    v_mfma_f32_16x16x32_bf16 v[144:147], a[136:139], v[84:87], v[144:147]
    v_mfma_f32_16x16x32_bf16 v[164:167], a[140:143], v[84:87], v[164:167]
    v_mfma_f32_16x16x32_bf16 v[148:151], a[136:139], v[88:91], v[148:151]
    v_mfma_f32_16x16x32_bf16 v[168:171], a[140:143], v[88:91], v[168:171]
    v_mfma_f32_16x16x32_bf16 v[152:155], a[136:139], v[92:95], v[152:155]
    v_mfma_f32_16x16x32_bf16 v[172:175], a[140:143], v[92:95], v[172:175]
    s_cmp_eq_u32 s27, 1
    s_cbranch_scc0 L_h17
    v_mfma_f32_16x16x32_bf16 v[216:219], v[56:59], a[176:179], v[216:219]
    v_mfma_f32_16x16x32_bf16 v[220:223], v[60:63], a[176:179], v[220:223]
    v_mfma_f32_16x16x32_bf16 v[224:227], v[64:67], a[176:179], v[224:227]
    v_mfma_f32_16x16x32_bf16 v[228:231], v[68:71], a[176:179], v[228:231]
    v_mfma_f32_16x16x32_bf16 v[232:235], v[72:75], a[176:179], v[232:235]
    v_mfma_f32_16x16x32_bf16 v[236:239], a[176:179], v[76:79], v[236:239]
    v_mfma_f32_16x16x32_bf16 v[240:243], a[176:179], v[80:83], v[240:243]
    v_mfma_f32_16x16x32_bf16 v[244:247], a[176:179], v[84:87], v[244:247]
    v_mfma_f32_16x16x32_bf16 v[248:251], a[176:179], v[88:91], v[248:251]
    v_mfma_f32_16x16x32_bf16 v[252:255], a[176:179], v[92:95], v[252:255]
    s_nop 7
L_h17:
    s_waitcnt lgkmcnt(0)
    v_mfma_f32_16x16x32_bf16 v[96:99], v[16:19], a[144:147], v[96:99]
    ds_read_b64_tr_b16 v[56:57], v11 offset:30720
    ds_read_b64_tr_b16 v[58:59], v11 offset:33280
    v_mfma_f32_16x16x32_bf16 v[116:119], v[16:19], a[148:151], v[116:119]
    ds_read_b64_tr_b16 v[60:61], v11 offset:30752
    ds_read_b64_tr_b16 v[62:63], v11 offset:33312
    v_mfma_f32_16x16x32_bf16 v[100:103], v[20:23], a[144:147], v[100:103]
    ds_read_b64_tr_b16 v[64:65], v11 offset:30784
    ds_read_b64_tr_b16 v[66:67], v11 offset:33344
    v_mfma_f32_16x16x32_bf16 v[120:123], v[20:23], a[148:151], v[120:123]
    ds_read_b64_tr_b16 v[68:69], v11 offset:30816
    ds_read_b64_tr_b16 v[70:71], v11 offset:33376
    v_mfma_f32_16x16x32_bf16 v[104:107], v[24:27], a[144:147], v[104:107]
    ds_read_b64_tr_b16 v[72:73], v11 offset:30848
    ds_read_b64_tr_b16 v[74:75], v11 offset:33408
    v_mfma_f32_16x16x32_bf16 v[124:127], v[24:27], a[148:151], v[124:127]
    ds_read_b64_tr_b16 v[76:77], v11 offset:35840
    ds_read_b64_tr_b16 v[78:79], v11 offset:38400
    v_mfma_f32_16x16x32_bf16 v[108:111], v[28:31], a[144:147], v[108:111]
    ds_read_b64_tr_b16 v[80:81], v11 offset:35872
    ds_read_b64_tr_b16 v[82:83], v11 offset:38432
    v_mfma_f32_16x16x32_bf16 v[128:131], v[28:31], a[148:151], v[128:131]
    ds_read_b64_tr_b16 v[84:85], v11 offset:35904
    ds_read_b64_tr_b16 v[86:87], v11 offset:38464
    v_mfma_f32_16x16x32_bf16 v[112:115], v[32:35], a[144:147], v[112:115]
    ds_read_b64_tr_b16 v[88:89], v11 offset:35936
    ds_read_b64_tr_b16 v[90:91], v11 offset:38496
    v_mfma_f32_16x16x32_bf16 v[132:135], v[32:35], a[148:151], v[132:135]
    ds_read_b64_tr_b16 v[92:93], v11 offset:35968
    ds_read_b64_tr_b16 v[94:95], v11 offset:38528
    v_mfma_f32_16x16x32_bf16 v[136:139], a[144:147], v[36:39], v[136:139]
    v_mfma_f32_16x16x32_bf16 v[156:159], a[148:151], v[36:39], v[156:159]
    v_mfma_f32_16x16x32_bf16 v[140:143], a[144:147], v[40:43], v[140:143]
    v_mfma_f32_16x16x32_bf16 v[160:163], a[148:151], v[40:43], v[160:163]
    v_mfma_f32_16x16x32_bf16 v[144:147], a[144:147], v[44:47], v[144:147]
    v_mfma_f32_16x16x32_bf16 v[164:167], a[148:151], v[44:47], v[164:167]
    v_mfma_f32_16x16x32_bf16 v[148:151], a[144:147], v[48:51], v[148:151]
    v_mfma_f32_16x16x32_bf16 v[168:171], a[148:151], v[48:51], v[168:171]
    v_mfma_f32_16x16x32_bf16 v[152:155], a[144:147], v[52:55], v[152:155]
    v_mfma_f32_16x16x32_bf16 v[172:175], a[148:151], v[52:55], v[172:175]
    s_cmp_eq_u32 s27, 2
    s_cbranch_scc0 L_h18
    v_mfma_f32_16x16x32_bf16 v[216:219], v[16:19], a[176:179], v[216:219]
    v_mfma_f32_16x16x32_bf16 v[220:223], v[20:23], a[176:179], v[220:223]
    v_mfma_f32_16x16x32_bf16 v[224:227], v[24:27], a[176:179], v[224:227]
    v_mfma_f32_16x16x32_bf16 v[228:231], v[28:31], a[176:179], v[228:231]
    v_mfma_f32_16x16x32_bf16 v[232:235], v[32:35], a[176:179], v[232:235]
    v_mfma_f32_16x16x32_bf16 v[236:239], a[176:179], v[36:39], v[236:239]
    v_mfma_f32_16x16x32_bf16 v[240:243], a[176:179], v[40:43], v[240:243]
    v_mfma_f32_16x16x32_bf16 v[244:247], a[176:179], v[44:47], v[244:247]
    v_mfma_f32_16x16x32_bf16 v[248:251], a[176:179], v[48:51], v[248:251]
    v_mfma_f32_16x16x32_bf16 v[252:255], a[176:179], v[52:55], v[252:255]
    s_nop 7
L_h18:
    s_waitcnt lgkmcnt(0)
    v_mfma_f32_16x16x32_bf16 v[96:99], v[56:59], a[152:155], v[96:99]
    v_mfma_f32_16x16x32_bf16 v[116:119], v[56:59], a[156:159], v[116:119]
    v_mfma_f32_16x16x32_bf16 v[100:103], v[60:63], a[152:155], v[100:103]
    v_mfma_f32_16x16x32_bf16 v[120:123], v[60:63], a[156:159], v[120:123]
    v_mfma_f32_16x16x32_bf16 v[104:107], v[64:67], a[152:155], v[104:107]
    v_mfma_f32_16x16x32_bf16 v[124:127], v[64:67], a[156:159], v[124:127]
    v_mfma_f32_16x16x32_bf16 v[108:111], v[68:71], a[152:155], v[108:111]
    v_mfma_f32_16x16x32_bf16 v[128:131], v[68:71], a[156:159], v[128:131]
    v_mfma_f32_16x16x32_bf16 v[112:115], v[72:75], a[152:155], v[112:115]
    v_mfma_f32_16x16x32_bf16 v[132:135], v[72:75], a[156:159], v[132:135]
    v_mfma_f32_16x16x32_bf16 v[136:139], a[152:155], v[76:79], v[136:139]
    v_mfma_f32_16x16x32_bf16 v[156:159], a[156:159], v[76:79], v[156:159]
    v_mfma_f32_16x16x32_bf16 v[140:143], a[152:155], v[80:83], v[140:143]
    v_mfma_f32_16x16x32_bf16 v[160:163], a[156:159], v[80:83], v[160:163]
    v_mfma_f32_16x16x32_bf16 v[144:147], a[152:155], v[84:87], v[144:147]
    v_mfma_f32_16x16x32_bf16 v[164:167], a[156:159], v[84:87], v[164:167]
    v_mfma_f32_16x16x32_bf16 v[148:151], a[152:155], v[88:91], v[148:151]
    v_mfma_f32_16x16x32_bf16 v[168:171], a[156:159], v[88:91], v[168:171]
    v_mfma_f32_16x16x32_bf16 v[152:155], a[152:155], v[92:95], v[152:155]
    v_mfma_f32_16x16x32_bf16 v[172:175], a[156:159], v[92:95], v[172:175]
    s_cmp_eq_u32 s27, 3
    s_cbranch_scc0 L_h19
    v_mfma_f32_16x16x32_bf16 v[216:219], v[56:59], a[176:179], v[216:219]
    v_mfma_f32_16x16x32_bf16 v[220:223], v[60:63], a[176:179], v[220:223]
    v_mfma_f32_16x16x32_bf16 v[224:227], v[64:67], a[176:179], v[224:227]
    v_mfma_f32_16x16x32_bf16 v[228:231], v[68:71], a[176:179], v[228:231]
    v_mfma_f32_16x16x32_bf16 v[232:235], v[72:75], a[176:179], v[232:235]
    v_mfma_f32_16x16x32_bf16 v[236:239], a[176:179], v[76:79], v[236:239]
    v_mfma_f32_16x16x32_bf16 v[240:243], a[176:179], v[80:83], v[240:243]
    v_mfma_f32_16x16x32_bf16 v[244:247], a[176:179], v[84:87], v[244:247]
    v_mfma_f32_16x16x32_bf16 v[248:251], a[176:179], v[88:91], v[248:251]
    v_mfma_f32_16x16x32_bf16 v[252:255], a[176:179], v[92:95], v[252:255]
    s_nop 7
L_h19:
    s_barrier
    s_add_u32 s28, s87, 12
    s_cmp_ge_u32 s28, 20
    s_cselect_b32 s101, 20, 0
    s_sub_u32 s28, s28, s101
    s_mul_i32 s28, s28, 122880
    s_add_u32 s28, s28, s25
    s_add_u32 m0, s26, 61440
    s_nop 0
    buffer_load_dwordx4 v5, s[8:11], s28 offen lds
    s_add_u32 m0, s26, 62464
    s_nop 0
    buffer_load_dwordx4 v6, s[8:11], s28 offen lds
    s_add_u32 m0, s26, 63488
    s_nop 0
    buffer_load_dwordx4 v7, s[8:11], s28 offen lds
    s_add_u32 m0, s26, 64512
    s_nop 0
    buffer_load_dwordx4 v8, s[8:11], s28 offen lds
    s_add_u32 m0, s26, 65536
    s_nop 0
    buffer_load_dwordx4 v9, s[8:11], s28 offen lds
    v_and_b32 v1, 63, v0
    s_lshr_b32 s28, s2, 3
    s_cmp_lt_u32 s28, 16
    s_cselect_b32 s96, s70, s76
    s_cselect_b32 s97, s71, s77
    s_mov_b32 s98, 819200
    s_mov_b32 s99, 0x00020000
    s_and_b32 s28, s28, 15
    s_mul_i32 s28, s28, 40
    s_mul_i32 s29, s27, 10
    s_add_u32 s28, s28, s29
    s_mul_i32 s28, s28, 1280
    s_and_b32 s29, s2, 1
    s_mul_i32 s29, s29, 640
    s_add_u32 s28, s28, s29
    v_lshlrev_b32 v14, 4, v1
    s_mov_b32 s100, -1
    s_mov_b32 s101, 0xff
    s_mov_b64 exec, s[100:101]
    buffer_load_dwordx4 a[240:243], v14, s[96:99], s28 offen
    s_add_u32 s28, s28, 1280
    buffer_load_dwordx4 a[240:243], v14, s[96:99], s28 offen
    s_add_u32 s28, s28, 1280
    buffer_load_dwordx4 a[240:243], v14, s[96:99], s28 offen
    s_add_u32 s28, s28, 1280
    buffer_load_dwordx4 a[240:243], v14, s[96:99], s28 offen
    s_add_u32 s28, s28, 1280
    buffer_load_dwordx4 a[240:243], v14, s[96:99], s28 offen
    s_add_u32 s28, s28, 1280
    buffer_load_dwordx4 a[240:243], v14, s[96:99], s28 offen
    s_add_u32 s28, s28, 1280
    buffer_load_dwordx4 a[240:243], v14, s[96:99], s28 offen
    s_add_u32 s28, s28, 1280
    buffer_load_dwordx4 a[240:243], v14, s[96:99], s28 offen
    s_add_u32 s28, s28, 1280
    buffer_load_dwordx4 a[240:243], v14, s[96:99], s28 offen
    s_add_u32 s28, s28, 1280
    buffer_load_dwordx4 a[240:243], v14, s[96:99], s28 offen
    s_add_u32 s28, s28, 1280
    s_mov_b64 exec, -1
    v_cvt_pk_bf16_f32 v186, v96, v97
    v_cvt_pk_bf16_f32 v187, v98, v99
    v_cvt_pk_bf16_f32 v16, v136, v137
    v_cvt_pk_bf16_f32 v17, v138, v139
    v_cvt_pk_bf16_f32 v188, v100, v101
    v_cvt_pk_bf16_f32 v189, v102, v103
    v_cvt_pk_bf16_f32 v18, v140, v141
    v_cvt_pk_bf16_f32 v19, v142, v143
    v_cvt_pk_bf16_f32 v190, v104, v105
    v_cvt_pk_bf16_f32 v191, v106, v107
    v_cvt_pk_bf16_f32 v20, v144, v145
    v_cvt_pk_bf16_f32 v21, v146, v147
    v_cvt_pk_bf16_f32 v192, v108, v109
    v_cvt_pk_bf16_f32 v193, v110, v111
    v_cvt_pk_bf16_f32 v22, v148, v149
    v_cvt_pk_bf16_f32 v23, v150, v151
    v_cvt_pk_bf16_f32 v194, v112, v113
    v_cvt_pk_bf16_f32 v195, v114, v115
    v_cvt_pk_bf16_f32 v24, v152, v153
    v_cvt_pk_bf16_f32 v25, v154, v155
    v_cvt_pk_bf16_f32 v196, v116, v117
    v_cvt_pk_bf16_f32 v197, v118, v119
    v_cvt_pk_bf16_f32 v26, v156, v157
    v_cvt_pk_bf16_f32 v27, v158, v159
    v_cvt_pk_bf16_f32 v198, v120, v121
    v_cvt_pk_bf16_f32 v199, v122, v123
    v_cvt_pk_bf16_f32 v28, v160, v161
    v_cvt_pk_bf16_f32 v29, v162, v163
    v_cvt_pk_bf16_f32 v200, v124, v125
    v_cvt_pk_bf16_f32 v201, v126, v127
    v_cvt_pk_bf16_f32 v30, v164, v165
    v_cvt_pk_bf16_f32 v31, v166, v167
    v_cvt_pk_bf16_f32 v202, v128, v129
    v_cvt_pk_bf16_f32 v203, v130, v131
    v_cvt_pk_bf16_f32 v32, v168, v169
    v_cvt_pk_bf16_f32 v33, v170, v171
    v_cvt_pk_bf16_f32 v204, v132, v133
    v_cvt_pk_bf16_f32 v205, v134, v135
    v_cvt_pk_bf16_f32 v34, v172, v173
    v_cvt_pk_bf16_f32 v35, v174, v175
    v_mov_b32 v138, v16
    v_mov_b32 v139, v17
    v_mov_b32 v144, v18
    v_mov_b32 v145, v19
    v_mov_b32 v150, v20
    v_mov_b32 v151, v21
    v_mov_b32 v156, v22
    v_mov_b32 v157, v23
    v_mov_b32 v162, v24
    v_mov_b32 v163, v25
    v_mov_b32 v140, v26
    v_mov_b32 v141, v27
    v_mov_b32 v146, v28
    v_mov_b32 v147, v29
    v_mov_b32 v152, v30
    v_mov_b32 v153, v31
    v_mov_b32 v158, v32
    v_mov_b32 v159, v33
    v_mov_b32 v164, v34
    v_mov_b32 v165, v35
    v_lshlrev_b32 v15, 3, v1
    s_mul_i32 s28, s27, 5120
    s_add_u32 s28, s28, 112640
    v_add_u32 v15, s28, v15
    ds_write_b64 v15, v[196:197] offset:0
    ds_write_b64 v15, v[140:141] offset:2560
    ds_write_b64 v15, v[198:199] offset:512
    ds_write_b64 v15, v[146:147] offset:3072
    ds_write_b64 v15, v[200:201] offset:1024
    ds_write_b64 v15, v[152:153] offset:3584
    ds_write_b64 v15, v[202:203] offset:1536
    ds_write_b64 v15, v[158:159] offset:4096
    ds_write_b64 v15, v[204:205] offset:2048
    ds_write_b64 v15, v[164:165] offset:4608
    v_lshlrev_b32 v14, 4, v1
    v_add_u32 v14, 81920, v14
    s_cmp_eq_u32 s27, 0
    s_cbranch_scc1 L_b_w0
    s_mul_i32 s28, s27, 10240
    s_sub_u32 s28, s28, 10240
    v_add_u32 v96, s28, v14
    ds_write_b128 v96, v[216:219] offset:0
    ds_write_b128 v96, v[220:223] offset:1024
    ds_write_b128 v96, v[224:227] offset:2048
    ds_write_b128 v96, v[228:231] offset:3072
    ds_write_b128 v96, v[232:235] offset:4096
    ds_write_b128 v96, v[236:239] offset:5120
    ds_write_b128 v96, v[240:243] offset:6144
    ds_write_b128 v96, v[244:247] offset:7168
    ds_write_b128 v96, v[248:251] offset:8192
    ds_write_b128 v96, v[252:255] offset:9216
L_b_w0:
    s_waitcnt lgkmcnt(0)
    s_barrier
    s_cmp_eq_u32 s27, 0
    s_cbranch_scc0 L_b_nw0
    ds_read_b128 v[96:99], v14 offset:0
    ds_read_b128 v[100:103], v14 offset:1024
    ds_read_b128 v[104:107], v14 offset:2048
    ds_read_b128 v[108:111], v14 offset:3072
    ds_read_b128 v[112:115], v14 offset:4096
    ds_read_b128 v[116:119], v14 offset:5120
    ds_read_b128 v[120:123], v14 offset:6144
    ds_read_b128 v[124:127], v14 offset:7168
    ds_read_b128 v[128:131], v14 offset:8192
    ds_read_b128 v[132:135], v14 offset:9216
    s_waitcnt lgkmcnt(0)
    v_add_f32 v216, v216, v96
    v_add_f32 v217, v217, v97
    v_add_f32 v218, v218, v98
    v_add_f32 v219, v219, v99
    v_add_f32 v220, v220, v100
    v_add_f32 v221, v221, v101
    v_add_f32 v222, v222, v102
    v_add_f32 v223, v223, v103
    v_add_f32 v224, v224, v104
    v_add_f32 v225, v225, v105
    v_add_f32 v226, v226, v106
    v_add_f32 v227, v227, v107
    v_add_f32 v228, v228, v108
    v_add_f32 v229, v229, v109
    v_add_f32 v230, v230, v110
    v_add_f32 v231, v231, v111
    v_add_f32 v232, v232, v112
    v_add_f32 v233, v233, v113
    v_add_f32 v234, v234, v114
    v_add_f32 v235, v235, v115
    v_add_f32 v236, v236, v116
    v_add_f32 v237, v237, v117
    v_add_f32 v238, v238, v118
    v_add_f32 v239, v239, v119
    v_add_f32 v240, v240, v120
    v_add_f32 v241, v241, v121
    v_add_f32 v242, v242, v122
    v_add_f32 v243, v243, v123
    v_add_f32 v244, v244, v124
    v_add_f32 v245, v245, v125
    v_add_f32 v246, v246, v126
    v_add_f32 v247, v247, v127
    v_add_f32 v248, v248, v128
    v_add_f32 v249, v249, v129
    v_add_f32 v250, v250, v130
    v_add_f32 v251, v251, v131
    v_add_f32 v252, v252, v132
    v_add_f32 v253, v253, v133
    v_add_f32 v254, v254, v134
    v_add_f32 v255, v255, v135
    ds_read_b128 v[96:99], v14 offset:10240
    ds_read_b128 v[100:103], v14 offset:11264
    ds_read_b128 v[104:107], v14 offset:12288
    ds_read_b128 v[108:111], v14 offset:13312
    ds_read_b128 v[112:115], v14 offset:14336
    ds_read_b128 v[116:119], v14 offset:15360
    ds_read_b128 v[120:123], v14 offset:16384
    ds_read_b128 v[124:127], v14 offset:17408
    ds_read_b128 v[128:131], v14 offset:18432
    ds_read_b128 v[132:135], v14 offset:19456
    s_waitcnt lgkmcnt(0)
    v_add_f32 v216, v216, v96
    v_add_f32 v217, v217, v97
    v_add_f32 v218, v218, v98
    v_add_f32 v219, v219, v99
    v_add_f32 v220, v220, v100
    v_add_f32 v221, v221, v101
    v_add_f32 v222, v222, v102
    v_add_f32 v223, v223, v103
    v_add_f32 v224, v224, v104
    v_add_f32 v225, v225, v105
    v_add_f32 v226, v226, v106
    v_add_f32 v227, v227, v107
    v_add_f32 v228, v228, v108
    v_add_f32 v229, v229, v109
    v_add_f32 v230, v230, v110
    v_add_f32 v231, v231, v111
    v_add_f32 v232, v232, v112
    v_add_f32 v233, v233, v113
    v_add_f32 v234, v234, v114
    v_add_f32 v235, v235, v115
    v_add_f32 v236, v236, v116
    v_add_f32 v237, v237, v117
    v_add_f32 v238, v238, v118
    v_add_f32 v239, v239, v119
    v_add_f32 v240, v240, v120
    v_add_f32 v241, v241, v121
    v_add_f32 v242, v242, v122
    v_add_f32 v243, v243, v123
    v_add_f32 v244, v244, v124
    v_add_f32 v245, v245, v125
    v_add_f32 v246, v246, v126
    v_add_f32 v247, v247, v127
    v_add_f32 v248, v248, v128
    v_add_f32 v249, v249, v129
    v_add_f32 v250, v250, v130
    v_add_f32 v251, v251, v131
    v_add_f32 v252, v252, v132
    v_add_f32 v253, v253, v133
    v_add_f32 v254, v254, v134
    v_add_f32 v255, v255, v135
    ds_read_b128 v[96:99], v14 offset:20480
    ds_read_b128 v[100:103], v14 offset:21504
    ds_read_b128 v[104:107], v14 offset:22528
    ds_read_b128 v[108:111], v14 offset:23552
    ds_read_b128 v[112:115], v14 offset:24576
    ds_read_b128 v[116:119], v14 offset:25600
    ds_read_b128 v[120:123], v14 offset:26624
    ds_read_b128 v[124:127], v14 offset:27648
    ds_read_b128 v[128:131], v14 offset:28672
    ds_read_b128 v[132:135], v14 offset:29696
    s_waitcnt lgkmcnt(0)
    v_add_f32 v216, v216, v96
    v_add_f32 v217, v217, v97
    v_add_f32 v218, v218, v98
    v_add_f32 v219, v219, v99
    v_add_f32 v220, v220, v100
    v_add_f32 v221, v221, v101
    v_add_f32 v222, v222, v102
    v_add_f32 v223, v223, v103
    v_add_f32 v224, v224, v104
    v_add_f32 v225, v225, v105
    v_add_f32 v226, v226, v106
    v_add_f32 v227, v227, v107
    v_add_f32 v228, v228, v108
    v_add_f32 v229, v229, v109
    v_add_f32 v230, v230, v110
    v_add_f32 v231, v231, v111
    v_add_f32 v232, v232, v112
    v_add_f32 v233, v233, v113
    v_add_f32 v234, v234, v114
    v_add_f32 v235, v235, v115
    v_add_f32 v236, v236, v116
    v_add_f32 v237, v237, v117
    v_add_f32 v238, v238, v118
    v_add_f32 v239, v239, v119
    v_add_f32 v240, v240, v120
    v_add_f32 v241, v241, v121
    v_add_f32 v242, v242, v122
    v_add_f32 v243, v243, v123
    v_add_f32 v244, v244, v124
    v_add_f32 v245, v245, v125
    v_add_f32 v246, v246, v126
    v_add_f32 v247, v247, v127
    v_add_f32 v248, v248, v128
    v_add_f32 v249, v249, v129
    v_add_f32 v250, v250, v130
    v_add_f32 v251, v251, v131
    v_add_f32 v252, v252, v132
    v_add_f32 v253, v253, v133
    v_add_f32 v254, v254, v134
    v_add_f32 v255, v255, v135
    v_cvt_pk_bf16_f32 v176, v216, v217
    v_cvt_pk_bf16_f32 v177, v218, v219
    v_cvt_pk_bf16_f32 v136, v236, v237
    v_cvt_pk_bf16_f32 v137, v238, v239
    v_cvt_pk_bf16_f32 v178, v220, v221
    v_cvt_pk_bf16_f32 v179, v222, v223
    v_cvt_pk_bf16_f32 v142, v240, v241
    v_cvt_pk_bf16_f32 v143, v242, v243
    v_cvt_pk_bf16_f32 v180, v224, v225
    v_cvt_pk_bf16_f32 v181, v226, v227
    v_cvt_pk_bf16_f32 v148, v244, v245
    v_cvt_pk_bf16_f32 v149, v246, v247
    v_cvt_pk_bf16_f32 v182, v228, v229
    v_cvt_pk_bf16_f32 v183, v230, v231
    v_cvt_pk_bf16_f32 v154, v248, v249
    v_cvt_pk_bf16_f32 v155, v250, v251
    v_cvt_pk_bf16_f32 v184, v232, v233
    v_cvt_pk_bf16_f32 v185, v234, v235
    v_cvt_pk_bf16_f32 v160, v252, v253
    v_cvt_pk_bf16_f32 v161, v254, v255
    s_branch L_b_j
    s_nop 3
L_b_nw0:
    v_subrev_u32 v15, 5120, v15
    ds_read_b64 v[176:177], v15 offset:0
    ds_read_b64 v[136:137], v15 offset:2560
    ds_read_b64 v[178:179], v15 offset:512
    ds_read_b64 v[142:143], v15 offset:3072
    ds_read_b64 v[180:181], v15 offset:1024
    ds_read_b64 v[148:149], v15 offset:3584
    ds_read_b64 v[182:183], v15 offset:1536
    ds_read_b64 v[154:155], v15 offset:4096
    ds_read_b64 v[184:185], v15 offset:2048
    ds_read_b64 v[160:161], v15 offset:4608
    s_waitcnt lgkmcnt(0)
    s_nop 0
L_b_j:
    s_waitcnt vmcnt(25)
    s_barrier
    ds_read_b64_tr_b16 v[56:57], v10 offset:0
    ds_read_b64_tr_b16 v[58:59], v10 offset:2560
    ds_read_b64_tr_b16 v[60:61], v10 offset:32
    ds_read_b64_tr_b16 v[62:63], v10 offset:2592
    ds_read_b64_tr_b16 v[64:65], v10 offset:64
    ds_read_b64_tr_b16 v[66:67], v10 offset:2624
    ds_read_b64_tr_b16 v[68:69], v10 offset:96
    ds_read_b64_tr_b16 v[70:71], v10 offset:2656
    ds_read_b64_tr_b16 v[72:73], v10 offset:128
    ds_read_b64_tr_b16 v[74:75], v10 offset:2688
    ds_read_b64_tr_b16 v[16:17], v10 offset:5120
    ds_read_b64_tr_b16 v[18:19], v10 offset:7680
    ds_read_b64_tr_b16 v[20:21], v10 offset:5152
    ds_read_b64_tr_b16 v[22:23], v10 offset:7712
    ds_read_b64_tr_b16 v[24:25], v10 offset:5184
    ds_read_b64_tr_b16 v[26:27], v10 offset:7744
    ds_read_b64_tr_b16 v[28:29], v10 offset:5216
    ds_read_b64_tr_b16 v[30:31], v10 offset:7776
    ds_read_b64_tr_b16 v[32:33], v10 offset:5248
    ds_read_b64_tr_b16 v[34:35], v10 offset:7808
    s_waitcnt lgkmcnt(10)
    v_mfma_f32_16x16x32_bf16 v[96:99], v[56:59], a[0:3], 0
    ds_read_b64_tr_b16 v[36:37], v10 offset:10240
    ds_read_b64_tr_b16 v[38:39], v10 offset:12800
    v_mfma_f32_16x16x32_bf16 v[116:119], v[56:59], a[4:7], 0
    ds_read_b64_tr_b16 v[40:41], v10 offset:10272
    ds_read_b64_tr_b16 v[42:43], v10 offset:12832
    v_mfma_f32_16x16x32_bf16 v[100:103], v[60:63], a[0:3], 0
    ds_read_b64_tr_b16 v[44:45], v10 offset:10304
    ds_read_b64_tr_b16 v[46:47], v10 offset:12864
    v_mfma_f32_16x16x32_bf16 v[120:123], v[60:63], a[4:7], 0
    ds_read_b64_tr_b16 v[48:49], v10 offset:10336
    ds_read_b64_tr_b16 v[50:51], v10 offset:12896
    v_mfma_f32_16x16x32_bf16 v[104:107], v[64:67], a[0:3], 0
    ds_read_b64_tr_b16 v[52:53], v10 offset:10368
    ds_read_b64_tr_b16 v[54:55], v10 offset:12928
    v_mfma_f32_16x16x32_bf16 v[124:127], v[64:67], a[4:7], 0
    v_mfma_f32_16x16x32_bf16 v[108:111], v[68:71], a[0:3], 0
    v_mfma_f32_16x16x32_bf16 v[128:131], v[68:71], a[4:7], 0
    v_mfma_f32_16x16x32_bf16 v[112:115], v[72:75], a[0:3], 0
    v_mfma_f32_16x16x32_bf16 v[132:135], v[72:75], a[4:7], 0
    s_waitcnt lgkmcnt(10)
    v_mfma_f32_16x16x32_bf16 v[96:99], v[16:19], a[8:11], v[96:99]
    ds_read_b64_tr_b16 v[56:57], v10 offset:15360
    ds_read_b64_tr_b16 v[58:59], v10 offset:17920
    v_mfma_f32_16x16x32_bf16 v[116:119], v[16:19], a[12:15], v[116:119]
    ds_read_b64_tr_b16 v[60:61], v10 offset:15392
    ds_read_b64_tr_b16 v[62:63], v10 offset:17952
    v_mfma_f32_16x16x32_bf16 v[100:103], v[20:23], a[8:11], v[100:103]
    ds_read_b64_tr_b16 v[64:65], v10 offset:15424
    ds_read_b64_tr_b16 v[66:67], v10 offset:17984
    v_mfma_f32_16x16x32_bf16 v[120:123], v[20:23], a[12:15], v[120:123]
    ds_read_b64_tr_b16 v[68:69], v10 offset:15456
    ds_read_b64_tr_b16 v[70:71], v10 offset:18016
    v_mfma_f32_16x16x32_bf16 v[104:107], v[24:27], a[8:11], v[104:107]
    ds_read_b64_tr_b16 v[72:73], v10 offset:15488
    ds_read_b64_tr_b16 v[74:75], v10 offset:18048
    v_mfma_f32_16x16x32_bf16 v[124:127], v[24:27], a[12:15], v[124:127]
    v_mfma_f32_16x16x32_bf16 v[108:111], v[28:31], a[8:11], v[108:111]
    v_mfma_f32_16x16x32_bf16 v[128:131], v[28:31], a[12:15], v[128:131]
    v_mfma_f32_16x16x32_bf16 v[112:115], v[32:35], a[8:11], v[112:115]
    v_mfma_f32_16x16x32_bf16 v[132:135], v[32:35], a[12:15], v[132:135]
    s_waitcnt lgkmcnt(10)
    s_waitcnt vmcnt(20)
    s_barrier
    v_mfma_f32_16x16x32_bf16 v[96:99], v[36:39], a[16:19], v[96:99]
    ds_read_b64_tr_b16 v[16:17], v10 offset:20480
    ds_read_b64_tr_b16 v[18:19], v10 offset:23040
    v_mfma_f32_16x16x32_bf16 v[116:119], v[36:39], a[20:23], v[116:119]
    ds_read_b64_tr_b16 v[20:21], v10 offset:20512
    ds_read_b64_tr_b16 v[22:23], v10 offset:23072
    v_mfma_f32_16x16x32_bf16 v[100:103], v[40:43], a[16:19], v[100:103]
    ds_read_b64_tr_b16 v[24:25], v10 offset:20544
    ds_read_b64_tr_b16 v[26:27], v10 offset:23104
    v_mfma_f32_16x16x32_bf16 v[120:123], v[40:43], a[20:23], v[120:123]
    ds_read_b64_tr_b16 v[28:29], v10 offset:20576
    ds_read_b64_tr_b16 v[30:31], v10 offset:23136
    v_mfma_f32_16x16x32_bf16 v[104:107], v[44:47], a[16:19], v[104:107]
    ds_read_b64_tr_b16 v[32:33], v10 offset:20608
    ds_read_b64_tr_b16 v[34:35], v10 offset:23168
    v_mfma_f32_16x16x32_bf16 v[124:127], v[44:47], a[20:23], v[124:127]
    v_mfma_f32_16x16x32_bf16 v[108:111], v[48:51], a[16:19], v[108:111]
    v_mfma_f32_16x16x32_bf16 v[128:131], v[48:51], a[20:23], v[128:131]
    v_mfma_f32_16x16x32_bf16 v[112:115], v[52:55], a[16:19], v[112:115]
    v_mfma_f32_16x16x32_bf16 v[132:135], v[52:55], a[20:23], v[132:135]
    s_waitcnt lgkmcnt(10)
    v_mfma_f32_16x16x32_bf16 v[96:99], v[56:59], a[24:27], v[96:99]
    ds_read_b64_tr_b16 v[36:37], v10 offset:25600
    ds_read_b64_tr_b16 v[38:39], v10 offset:28160
    v_mfma_f32_16x16x32_bf16 v[116:119], v[56:59], a[28:31], v[116:119]
    ds_read_b64_tr_b16 v[40:41], v10 offset:25632
    ds_read_b64_tr_b16 v[42:43], v10 offset:28192
    v_mfma_f32_16x16x32_bf16 v[100:103], v[60:63], a[24:27], v[100:103]
    ds_read_b64_tr_b16 v[44:45], v10 offset:25664
    ds_read_b64_tr_b16 v[46:47], v10 offset:28224
    v_mfma_f32_16x16x32_bf16 v[120:123], v[60:63], a[28:31], v[120:123]
    ds_read_b64_tr_b16 v[48:49], v10 offset:25696
    ds_read_b64_tr_b16 v[50:51], v10 offset:28256
    v_mfma_f32_16x16x32_bf16 v[104:107], v[64:67], a[24:27], v[104:107]
    ds_read_b64_tr_b16 v[52:53], v10 offset:25728
    ds_read_b64_tr_b16 v[54:55], v10 offset:28288
    v_mfma_f32_16x16x32_bf16 v[124:127], v[64:67], a[28:31], v[124:127]
    v_mfma_f32_16x16x32_bf16 v[108:111], v[68:71], a[24:27], v[108:111]
    v_mfma_f32_16x16x32_bf16 v[128:131], v[68:71], a[28:31], v[128:131]
    v_mfma_f32_16x16x32_bf16 v[112:115], v[72:75], a[24:27], v[112:115]
    v_mfma_f32_16x16x32_bf16 v[132:135], v[72:75], a[28:31], v[132:135]
    s_waitcnt lgkmcnt(10)
    v_mfma_f32_16x16x32_bf16 v[96:99], v[16:19], a[32:35], v[96:99]
    ds_read_b64_tr_b16 v[56:57], v10 offset:30720
    ds_read_b64_tr_b16 v[58:59], v10 offset:33280
    v_mfma_f32_16x16x32_bf16 v[116:119], v[16:19], a[36:39], v[116:119]
    ds_read_b64_tr_b16 v[60:61], v10 offset:30752
    ds_read_b64_tr_b16 v[62:63], v10 offset:33312
    v_mfma_f32_16x16x32_bf16 v[100:103], v[20:23], a[32:35], v[100:103]
    ds_read_b64_tr_b16 v[64:65], v10 offset:30784
    ds_read_b64_tr_b16 v[66:67], v10 offset:33344
    v_mfma_f32_16x16x32_bf16 v[120:123], v[20:23], a[36:39], v[120:123]
    ds_read_b64_tr_b16 v[68:69], v10 offset:30816
    ds_read_b64_tr_b16 v[70:71], v10 offset:33376
    v_mfma_f32_16x16x32_bf16 v[104:107], v[24:27], a[32:35], v[104:107]
    ds_read_b64_tr_b16 v[72:73], v10 offset:30848
    ds_read_b64_tr_b16 v[74:75], v10 offset:33408
    v_mfma_f32_16x16x32_bf16 v[124:127], v[24:27], a[36:39], v[124:127]
    v_mfma_f32_16x16x32_bf16 v[108:111], v[28:31], a[32:35], v[108:111]
    v_mfma_f32_16x16x32_bf16 v[128:131], v[28:31], a[36:39], v[128:131]
    v_mfma_f32_16x16x32_bf16 v[112:115], v[32:35], a[32:35], v[112:115]
    v_mfma_f32_16x16x32_bf16 v[132:135], v[32:35], a[36:39], v[132:135]
    s_waitcnt lgkmcnt(10)
    v_mfma_f32_16x16x32_bf16 v[96:99], v[36:39], a[40:43], v[96:99]
    ds_read_b64_tr_b16 v[16:17], v10 offset:35840
    ds_read_b64_tr_b16 v[18:19], v10 offset:38400
    v_mfma_f32_16x16x32_bf16 v[116:119], v[36:39], a[44:47], v[116:119]
    ds_read_b64_tr_b16 v[20:21], v10 offset:35872
    ds_read_b64_tr_b16 v[22:23], v10 offset:38432
    v_mfma_f32_16x16x32_bf16 v[100:103], v[40:43], a[40:43], v[100:103]
    ds_read_b64_tr_b16 v[24:25], v10 offset:35904
    ds_read_b64_tr_b16 v[26:27], v10 offset:38464
    v_mfma_f32_16x16x32_bf16 v[120:123], v[40:43], a[44:47], v[120:123]
    ds_read_b64_tr_b16 v[28:29], v10 offset:35936
    ds_read_b64_tr_b16 v[30:31], v10 offset:38496
    v_mfma_f32_16x16x32_bf16 v[104:107], v[44:47], a[40:43], v[104:107]
    ds_read_b64_tr_b16 v[32:33], v10 offset:35968
    ds_read_b64_tr_b16 v[34:35], v10 offset:38528
    v_mfma_f32_16x16x32_bf16 v[124:127], v[44:47], a[44:47], v[124:127]
    v_mfma_f32_16x16x32_bf16 v[108:111], v[48:51], a[40:43], v[108:111]
    v_mfma_f32_16x16x32_bf16 v[128:131], v[48:51], a[44:47], v[128:131]
    v_mfma_f32_16x16x32_bf16 v[112:115], v[52:55], a[40:43], v[112:115]
    v_mfma_f32_16x16x32_bf16 v[132:135], v[52:55], a[44:47], v[132:135]
    s_waitcnt lgkmcnt(10)
    s_waitcnt vmcnt(15)
    s_barrier
    s_add_u32 s28, s87, 16
    s_cmp_ge_u32 s28, 20
    s_cselect_b32 s101, 20, 0
    s_sub_u32 s28, s28, s101
    s_mul_i32 s28, s28, 122880
    s_add_u32 s28, s28, s25
    s_add_u32 m0, s26, 0
    s_nop 0
    buffer_load_dwordx4 v5, s[8:11], s28 offen lds
    s_add_u32 m0, s26, 1024
    s_nop 0
    buffer_load_dwordx4 v6, s[8:11], s28 offen lds
    s_add_u32 m0, s26, 2048
    s_nop 0
    buffer_load_dwordx4 v7, s[8:11], s28 offen lds
    s_add_u32 m0, s26, 3072
    s_nop 0
    buffer_load_dwordx4 v8, s[8:11], s28 offen lds
    s_add_u32 m0, s26, 4096
    s_nop 0
    buffer_load_dwordx4 v9, s[8:11], s28 offen lds
    v_mfma_f32_16x16x32_bf16 v[96:99], v[56:59], a[48:51], v[96:99]
    ds_read_b64_tr_b16 v[36:37], v10 offset:40960
    ds_read_b64_tr_b16 v[38:39], v10 offset:43520
    v_mfma_f32_16x16x32_bf16 v[116:119], v[56:59], a[52:55], v[116:119]
    ds_read_b64_tr_b16 v[40:41], v10 offset:40992
    ds_read_b64_tr_b16 v[42:43], v10 offset:43552
    v_mfma_f32_16x16x32_bf16 v[100:103], v[60:63], a[48:51], v[100:103]
    ds_read_b64_tr_b16 v[44:45], v10 offset:41024
    ds_read_b64_tr_b16 v[46:47], v10 offset:43584
    v_mfma_f32_16x16x32_bf16 v[120:123], v[60:63], a[52:55], v[120:123]
    ds_read_b64_tr_b16 v[48:49], v10 offset:41056
    ds_read_b64_tr_b16 v[50:51], v10 offset:43616
    v_mfma_f32_16x16x32_bf16 v[104:107], v[64:67], a[48:51], v[104:107]
    ds_read_b64_tr_b16 v[52:53], v10 offset:41088
    ds_read_b64_tr_b16 v[54:55], v10 offset:43648
    v_mfma_f32_16x16x32_bf16 v[124:127], v[64:67], a[52:55], v[124:127]
    v_mfma_f32_16x16x32_bf16 v[108:111], v[68:71], a[48:51], v[108:111]
    v_mfma_f32_16x16x32_bf16 v[128:131], v[68:71], a[52:55], v[128:131]
    v_mfma_f32_16x16x32_bf16 v[112:115], v[72:75], a[48:51], v[112:115]
    v_mfma_f32_16x16x32_bf16 v[132:135], v[72:75], a[52:55], v[132:135]
    s_waitcnt lgkmcnt(10)
    v_mfma_f32_16x16x32_bf16 v[96:99], v[16:19], a[56:59], v[96:99]
    ds_read_b64_tr_b16 v[56:57], v10 offset:46080
    ds_read_b64_tr_b16 v[58:59], v10 offset:48640
    v_mfma_f32_16x16x32_bf16 v[116:119], v[16:19], a[60:63], v[116:119]
    ds_read_b64_tr_b16 v[60:61], v10 offset:46112
    ds_read_b64_tr_b16 v[62:63], v10 offset:48672
    v_mfma_f32_16x16x32_bf16 v[100:103], v[20:23], a[56:59], v[100:103]
    ds_read_b64_tr_b16 v[64:65], v10 offset:46144
    ds_read_b64_tr_b16 v[66:67], v10 offset:48704
    v_mfma_f32_16x16x32_bf16 v[120:123], v[20:23], a[60:63], v[120:123]
    ds_read_b64_tr_b16 v[68:69], v10 offset:46176
    ds_read_b64_tr_b16 v[70:71], v10 offset:48736
    v_mfma_f32_16x16x32_bf16 v[104:107], v[24:27], a[56:59], v[104:107]
    ds_read_b64_tr_b16 v[72:73], v10 offset:46208
    ds_read_b64_tr_b16 v[74:75], v10 offset:48768
    v_mfma_f32_16x16x32_bf16 v[124:127], v[24:27], a[60:63], v[124:127]
    v_mfma_f32_16x16x32_bf16 v[108:111], v[28:31], a[56:59], v[108:111]
    v_mfma_f32_16x16x32_bf16 v[128:131], v[28:31], a[60:63], v[128:131]
    v_mfma_f32_16x16x32_bf16 v[112:115], v[32:35], a[56:59], v[112:115]
    v_mfma_f32_16x16x32_bf16 v[132:135], v[32:35], a[60:63], v[132:135]
    s_waitcnt lgkmcnt(10)
    v_mfma_f32_16x16x32_bf16 v[96:99], v[36:39], a[64:67], v[96:99]
    ds_read_b64_tr_b16 v[16:17], v10 offset:51200
    ds_read_b64_tr_b16 v[18:19], v10 offset:53760
    v_mfma_f32_16x16x32_bf16 v[116:119], v[36:39], a[68:71], v[116:119]
    ds_read_b64_tr_b16 v[20:21], v10 offset:51232
    ds_read_b64_tr_b16 v[22:23], v10 offset:53792
    v_mfma_f32_16x16x32_bf16 v[100:103], v[40:43], a[64:67], v[100:103]
    ds_read_b64_tr_b16 v[24:25], v10 offset:51264
    ds_read_b64_tr_b16 v[26:27], v10 offset:53824
    v_mfma_f32_16x16x32_bf16 v[120:123], v[40:43], a[68:71], v[120:123]
    ds_read_b64_tr_b16 v[28:29], v10 offset:51296
    ds_read_b64_tr_b16 v[30:31], v10 offset:53856
    v_mfma_f32_16x16x32_bf16 v[104:107], v[44:47], a[64:67], v[104:107]
    ds_read_b64_tr_b16 v[32:33], v10 offset:51328
    ds_read_b64_tr_b16 v[34:35], v10 offset:53888
    v_mfma_f32_16x16x32_bf16 v[124:127], v[44:47], a[68:71], v[124:127]
    v_mfma_f32_16x16x32_bf16 v[108:111], v[48:51], a[64:67], v[108:111]
    v_mfma_f32_16x16x32_bf16 v[128:131], v[48:51], a[68:71], v[128:131]
    v_mfma_f32_16x16x32_bf16 v[112:115], v[52:55], a[64:67], v[112:115]
    v_mfma_f32_16x16x32_bf16 v[132:135], v[52:55], a[68:71], v[132:135]
    s_waitcnt lgkmcnt(10)
    v_mfma_f32_16x16x32_bf16 v[96:99], v[56:59], a[72:75], v[96:99]
    ds_read_b64_tr_b16 v[36:37], v10 offset:56320
    ds_read_b64_tr_b16 v[38:39], v10 offset:58880
    v_mfma_f32_16x16x32_bf16 v[116:119], v[56:59], a[76:79], v[116:119]
    ds_read_b64_tr_b16 v[40:41], v10 offset:56352
    ds_read_b64_tr_b16 v[42:43], v10 offset:58912
    v_mfma_f32_16x16x32_bf16 v[100:103], v[60:63], a[72:75], v[100:103]
    ds_read_b64_tr_b16 v[44:45], v10 offset:56384
    ds_read_b64_tr_b16 v[46:47], v10 offset:58944
    v_mfma_f32_16x16x32_bf16 v[120:123], v[60:63], a[76:79], v[120:123]
    ds_read_b64_tr_b16 v[48:49], v10 offset:56416
    ds_read_b64_tr_b16 v[50:51], v10 offset:58976
    v_mfma_f32_16x16x32_bf16 v[104:107], v[64:67], a[72:75], v[104:107]
    ds_read_b64_tr_b16 v[52:53], v10 offset:56448
    ds_read_b64_tr_b16 v[54:55], v10 offset:59008
    v_mfma_f32_16x16x32_bf16 v[124:127], v[64:67], a[76:79], v[124:127]
    v_mfma_f32_16x16x32_bf16 v[108:111], v[68:71], a[72:75], v[108:111]
    v_mfma_f32_16x16x32_bf16 v[128:131], v[68:71], a[76:79], v[128:131]
    v_mfma_f32_16x16x32_bf16 v[112:115], v[72:75], a[72:75], v[112:115]
    v_mfma_f32_16x16x32_bf16 v[132:135], v[72:75], a[76:79], v[132:135]
    s_waitcnt lgkmcnt(10)
    s_waitcnt vmcnt(15)
    s_barrier
    v_mfma_f32_16x16x32_bf16 v[96:99], v[16:19], a[80:83], v[96:99]
    ds_read_b64_tr_b16 v[56:57], v11 offset:0
    ds_read_b64_tr_b16 v[58:59], v11 offset:2560
    v_mfma_f32_16x16x32_bf16 v[116:119], v[16:19], a[84:87], v[116:119]
    ds_read_b64_tr_b16 v[60:61], v11 offset:32
    ds_read_b64_tr_b16 v[62:63], v11 offset:2592
    v_mfma_f32_16x16x32_bf16 v[100:103], v[20:23], a[80:83], v[100:103]
    ds_read_b64_tr_b16 v[64:65], v11 offset:64
    ds_read_b64_tr_b16 v[66:67], v11 offset:2624
    v_mfma_f32_16x16x32_bf16 v[120:123], v[20:23], a[84:87], v[120:123]
    ds_read_b64_tr_b16 v[68:69], v11 offset:96
    ds_read_b64_tr_b16 v[70:71], v11 offset:2656
    v_mfma_f32_16x16x32_bf16 v[104:107], v[24:27], a[80:83], v[104:107]
    ds_read_b64_tr_b16 v[72:73], v11 offset:128
    ds_read_b64_tr_b16 v[74:75], v11 offset:2688
    v_mfma_f32_16x16x32_bf16 v[124:127], v[24:27], a[84:87], v[124:127]
    v_mfma_f32_16x16x32_bf16 v[108:111], v[28:31], a[80:83], v[108:111]
    v_mfma_f32_16x16x32_bf16 v[128:131], v[28:31], a[84:87], v[128:131]
    v_mfma_f32_16x16x32_bf16 v[112:115], v[32:35], a[80:83], v[112:115]
    v_mfma_f32_16x16x32_bf16 v[132:135], v[32:35], a[84:87], v[132:135]
    s_waitcnt lgkmcnt(10)
    v_mfma_f32_16x16x32_bf16 v[96:99], v[36:39], a[88:91], v[96:99]
    ds_read_b64_tr_b16 v[16:17], v11 offset:5120
    ds_read_b64_tr_b16 v[18:19], v11 offset:7680
    v_mfma_f32_16x16x32_bf16 v[116:119], v[36:39], a[92:95], v[116:119]
    ds_read_b64_tr_b16 v[20:21], v11 offset:5152
    ds_read_b64_tr_b16 v[22:23], v11 offset:7712
    v_mfma_f32_16x16x32_bf16 v[100:103], v[40:43], a[88:91], v[100:103]
    ds_read_b64_tr_b16 v[24:25], v11 offset:5184
    ds_read_b64_tr_b16 v[26:27], v11 offset:7744
    v_mfma_f32_16x16x32_bf16 v[120:123], v[40:43], a[92:95], v[120:123]
    ds_read_b64_tr_b16 v[28:29], v11 offset:5216
    ds_read_b64_tr_b16 v[30:31], v11 offset:7776
    v_mfma_f32_16x16x32_bf16 v[104:107], v[44:47], a[88:91], v[104:107]
    ds_read_b64_tr_b16 v[32:33], v11 offset:5248
    ds_read_b64_tr_b16 v[34:35], v11 offset:7808
    v_mfma_f32_16x16x32_bf16 v[124:127], v[44:47], a[92:95], v[124:127]
    v_mfma_f32_16x16x32_bf16 v[108:111], v[48:51], a[88:91], v[108:111]
    v_mfma_f32_16x16x32_bf16 v[128:131], v[48:51], a[92:95], v[128:131]
    v_mfma_f32_16x16x32_bf16 v[112:115], v[52:55], a[88:91], v[112:115]
    v_mfma_f32_16x16x32_bf16 v[132:135], v[52:55], a[92:95], v[132:135]
    s_waitcnt lgkmcnt(10)
    v_mfma_f32_16x16x32_bf16 v[96:99], v[56:59], a[96:99], v[96:99]
    ds_read_b64_tr_b16 v[36:37], v11 offset:10240
    ds_read_b64_tr_b16 v[38:39], v11 offset:12800
    v_mfma_f32_16x16x32_bf16 v[116:119], v[56:59], a[100:103], v[116:119]
    ds_read_b64_tr_b16 v[40:41], v11 offset:10272
    ds_read_b64_tr_b16 v[42:43], v11 offset:12832
    v_mfma_f32_16x16x32_bf16 v[100:103], v[60:63], a[96:99], v[100:103]
    ds_read_b64_tr_b16 v[44:45], v11 offset:10304
    ds_read_b64_tr_b16 v[46:47], v11 offset:12864
    v_mfma_f32_16x16x32_bf16 v[120:123], v[60:63], a[100:103], v[120:123]
    ds_read_b64_tr_b16 v[48:49], v11 offset:10336
    ds_read_b64_tr_b16 v[50:51], v11 offset:12896
    v_mfma_f32_16x16x32_bf16 v[104:107], v[64:67], a[96:99], v[104:107]
    ds_read_b64_tr_b16 v[52:53], v11 offset:10368
    ds_read_b64_tr_b16 v[54:55], v11 offset:12928
    v_mfma_f32_16x16x32_bf16 v[124:127], v[64:67], a[100:103], v[124:127]
    v_mfma_f32_16x16x32_bf16 v[108:111], v[68:71], a[96:99], v[108:111]
    v_mfma_f32_16x16x32_bf16 v[128:131], v[68:71], a[100:103], v[128:131]
    v_mfma_f32_16x16x32_bf16 v[112:115], v[72:75], a[96:99], v[112:115]
    v_mfma_f32_16x16x32_bf16 v[132:135], v[72:75], a[100:103], v[132:135]
    s_waitcnt lgkmcnt(10)
    v_mfma_f32_16x16x32_bf16 v[96:99], v[16:19], a[104:107], v[96:99]
    ds_read_b64_tr_b16 v[56:57], v11 offset:15360
    ds_read_b64_tr_b16 v[58:59], v11 offset:17920
    v_mfma_f32_16x16x32_bf16 v[116:119], v[16:19], a[108:111], v[116:119]
    ds_read_b64_tr_b16 v[60:61], v11 offset:15392
    ds_read_b64_tr_b16 v[62:63], v11 offset:17952
    v_mfma_f32_16x16x32_bf16 v[100:103], v[20:23], a[104:107], v[100:103]
    ds_read_b64_tr_b16 v[64:65], v11 offset:15424
    ds_read_b64_tr_b16 v[66:67], v11 offset:17984
    v_mfma_f32_16x16x32_bf16 v[120:123], v[20:23], a[108:111], v[120:123]
    ds_read_b64_tr_b16 v[68:69], v11 offset:15456
    ds_read_b64_tr_b16 v[70:71], v11 offset:18016
    v_mfma_f32_16x16x32_bf16 v[104:107], v[24:27], a[104:107], v[104:107]
    ds_read_b64_tr_b16 v[72:73], v11 offset:15488
    ds_read_b64_tr_b16 v[74:75], v11 offset:18048
    v_mfma_f32_16x16x32_bf16 v[124:127], v[24:27], a[108:111], v[124:127]
    v_mfma_f32_16x16x32_bf16 v[108:111], v[28:31], a[104:107], v[108:111]
    v_mfma_f32_16x16x32_bf16 v[128:131], v[28:31], a[108:111], v[128:131]
    v_mfma_f32_16x16x32_bf16 v[112:115], v[32:35], a[104:107], v[112:115]
    v_mfma_f32_16x16x32_bf16 v[132:135], v[32:35], a[108:111], v[132:135]
    s_waitcnt lgkmcnt(10)
    s_waitcnt vmcnt(0)
    s_barrier
    v_mfma_f32_16x16x32_bf16 v[96:99], v[36:39], a[112:115], v[96:99]
    ds_read_b64_tr_b16 v[16:17], v10 offset:0
    ds_read_b64_tr_b16 v[18:19], v10 offset:2560
    v_mfma_f32_16x16x32_bf16 v[116:119], v[36:39], a[116:119], v[116:119]
    ds_read_b64_tr_b16 v[20:21], v10 offset:32
    ds_read_b64_tr_b16 v[22:23], v10 offset:2592
    v_mfma_f32_16x16x32_bf16 v[100:103], v[40:43], a[112:115], v[100:103]
    ds_read_b64_tr_b16 v[24:25], v10 offset:64
    ds_read_b64_tr_b16 v[26:27], v10 offset:2624
    v_mfma_f32_16x16x32_bf16 v[120:123], v[40:43], a[116:119], v[120:123]
    ds_read_b64_tr_b16 v[28:29], v10 offset:96
    ds_read_b64_tr_b16 v[30:31], v10 offset:2656
    v_mfma_f32_16x16x32_bf16 v[104:107], v[44:47], a[112:115], v[104:107]
    ds_read_b64_tr_b16 v[32:33], v10 offset:128
    ds_read_b64_tr_b16 v[34:35], v10 offset:2688
    v_mfma_f32_16x16x32_bf16 v[124:127], v[44:47], a[116:119], v[124:127]
    v_mfma_f32_16x16x32_bf16 v[108:111], v[48:51], a[112:115], v[108:111]
    v_mfma_f32_16x16x32_bf16 v[128:131], v[48:51], a[116:119], v[128:131]
    v_mfma_f32_16x16x32_bf16 v[112:115], v[52:55], a[112:115], v[112:115]
    v_mfma_f32_16x16x32_bf16 v[132:135], v[52:55], a[116:119], v[132:135]
    s_waitcnt lgkmcnt(10)
    v_mfma_f32_16x16x32_bf16 v[96:99], v[56:59], a[120:123], v[96:99]
    ds_read_b64_tr_b16 v[36:37], v10 offset:5120
    ds_read_b64_tr_b16 v[38:39], v10 offset:7680
    v_mfma_f32_16x16x32_bf16 v[116:119], v[56:59], a[124:127], v[116:119]
    ds_read_b64_tr_b16 v[40:41], v10 offset:5152
    ds_read_b64_tr_b16 v[42:43], v10 offset:7712
    v_mfma_f32_16x16x32_bf16 v[100:103], v[60:63], a[120:123], v[100:103]
    ds_read_b64_tr_b16 v[44:45], v10 offset:5184
    ds_read_b64_tr_b16 v[46:47], v10 offset:7744
    v_mfma_f32_16x16x32_bf16 v[120:123], v[60:63], a[124:127], v[120:123]
    ds_read_b64_tr_b16 v[48:49], v10 offset:5216
    ds_read_b64_tr_b16 v[50:51], v10 offset:7776
    v_mfma_f32_16x16x32_bf16 v[104:107], v[64:67], a[120:123], v[104:107]
    ds_read_b64_tr_b16 v[52:53], v10 offset:5248
    ds_read_b64_tr_b16 v[54:55], v10 offset:7808
    v_mfma_f32_16x16x32_bf16 v[124:127], v[64:67], a[124:127], v[124:127]
    v_mfma_f32_16x16x32_bf16 v[108:111], v[68:71], a[120:123], v[108:111]
    v_mfma_f32_16x16x32_bf16 v[128:131], v[68:71], a[124:127], v[128:131]
    v_mfma_f32_16x16x32_bf16 v[112:115], v[72:75], a[120:123], v[112:115]
    v_mfma_f32_16x16x32_bf16 v[132:135], v[72:75], a[124:127], v[132:135]
    s_waitcnt lgkmcnt(10)
    v_mfma_f32_16x16x32_bf16 v[96:99], v[16:19], a[128:131], v[96:99]
    ds_read_b64_tr_b16 v[56:57], v10 offset:10240
    ds_read_b64_tr_b16 v[58:59], v10 offset:12800
    v_mfma_f32_16x16x32_bf16 v[116:119], v[16:19], a[132:135], v[116:119]
    ds_read_b64_tr_b16 v[60:61], v10 offset:10272
    ds_read_b64_tr_b16 v[62:63], v10 offset:12832
    v_mfma_f32_16x16x32_bf16 v[100:103], v[20:23], a[128:131], v[100:103]
    ds_read_b64_tr_b16 v[64:65], v10 offset:10304
    ds_read_b64_tr_b16 v[66:67], v10 offset:12864
    v_mfma_f32_16x16x32_bf16 v[120:123], v[20:23], a[132:135], v[120:123]
    ds_read_b64_tr_b16 v[68:69], v10 offset:10336
    ds_read_b64_tr_b16 v[70:71], v10 offset:12896
    v_mfma_f32_16x16x32_bf16 v[104:107], v[24:27], a[128:131], v[104:107]
    ds_read_b64_tr_b16 v[72:73], v10 offset:10368
    ds_read_b64_tr_b16 v[74:75], v10 offset:12928
    v_mfma_f32_16x16x32_bf16 v[124:127], v[24:27], a[132:135], v[124:127]
    v_mfma_f32_16x16x32_bf16 v[108:111], v[28:31], a[128:131], v[108:111]
    v_mfma_f32_16x16x32_bf16 v[128:131], v[28:31], a[132:135], v[128:131]
    v_mfma_f32_16x16x32_bf16 v[112:115], v[32:35], a[128:131], v[112:115]
    v_mfma_f32_16x16x32_bf16 v[132:135], v[32:35], a[132:135], v[132:135]
    s_waitcnt lgkmcnt(10)
    v_mfma_f32_16x16x32_bf16 v[96:99], v[36:39], a[136:139], v[96:99]
    ds_read_b64_tr_b16 v[16:17], v10 offset:15360
    ds_read_b64_tr_b16 v[18:19], v10 offset:17920
    v_mfma_f32_16x16x32_bf16 v[116:119], v[36:39], a[140:143], v[116:119]
    ds_read_b64_tr_b16 v[20:21], v10 offset:15392
    ds_read_b64_tr_b16 v[22:23], v10 offset:17952
    v_mfma_f32_16x16x32_bf16 v[100:103], v[40:43], a[136:139], v[100:103]
    ds_read_b64_tr_b16 v[24:25], v10 offset:15424
    ds_read_b64_tr_b16 v[26:27], v10 offset:17984
    v_mfma_f32_16x16x32_bf16 v[120:123], v[40:43], a[140:143], v[120:123]
    ds_read_b64_tr_b16 v[28:29], v10 offset:15456
    ds_read_b64_tr_b16 v[30:31], v10 offset:18016
    v_mfma_f32_16x16x32_bf16 v[104:107], v[44:47], a[136:139], v[104:107]
    ds_read_b64_tr_b16 v[32:33], v10 offset:15488
    ds_read_b64_tr_b16 v[34:35], v10 offset:18048
    v_mfma_f32_16x16x32_bf16 v[124:127], v[44:47], a[140:143], v[124:127]
    v_mfma_f32_16x16x32_bf16 v[108:111], v[48:51], a[136:139], v[108:111]
    v_mfma_f32_16x16x32_bf16 v[128:131], v[48:51], a[140:143], v[128:131]
    v_mfma_f32_16x16x32_bf16 v[112:115], v[52:55], a[136:139], v[112:115]
    v_mfma_f32_16x16x32_bf16 v[132:135], v[52:55], a[140:143], v[132:135]
    s_waitcnt lgkmcnt(10)
    v_mfma_f32_16x16x32_bf16 v[96:99], v[56:59], a[144:147], v[96:99]
    v_mfma_f32_16x16x32_bf16 v[116:119], v[56:59], a[148:151], v[116:119]
    v_mfma_f32_16x16x32_bf16 v[100:103], v[60:63], a[144:147], v[100:103]
    v_mfma_f32_16x16x32_bf16 v[120:123], v[60:63], a[148:151], v[120:123]
    v_mfma_f32_16x16x32_bf16 v[104:107], v[64:67], a[144:147], v[104:107]
    v_mfma_f32_16x16x32_bf16 v[124:127], v[64:67], a[148:151], v[124:127]
    v_mfma_f32_16x16x32_bf16 v[108:111], v[68:71], a[144:147], v[108:111]
    v_mfma_f32_16x16x32_bf16 v[128:131], v[68:71], a[148:151], v[128:131]
    v_mfma_f32_16x16x32_bf16 v[112:115], v[72:75], a[144:147], v[112:115]
    v_mfma_f32_16x16x32_bf16 v[132:135], v[72:75], a[148:151], v[132:135]
    s_waitcnt lgkmcnt(0)
    v_mfma_f32_16x16x32_bf16 v[96:99], v[16:19], a[152:155], v[96:99]
    v_mfma_f32_16x16x32_bf16 v[116:119], v[16:19], a[156:159], v[116:119]
    v_mfma_f32_16x16x32_bf16 v[100:103], v[20:23], a[152:155], v[100:103]
    v_mfma_f32_16x16x32_bf16 v[120:123], v[20:23], a[156:159], v[120:123]
    v_mfma_f32_16x16x32_bf16 v[104:107], v[24:27], a[152:155], v[104:107]
    v_mfma_f32_16x16x32_bf16 v[124:127], v[24:27], a[156:159], v[124:127]
    v_mfma_f32_16x16x32_bf16 v[108:111], v[28:31], a[152:155], v[108:111]
    v_mfma_f32_16x16x32_bf16 v[128:131], v[28:31], a[156:159], v[128:131]
    v_mfma_f32_16x16x32_bf16 v[112:115], v[32:35], a[152:155], v[112:115]
    v_mfma_f32_16x16x32_bf16 v[132:135], v[32:35], a[156:159], v[132:135]
    v_cvt_pk_bf16_f32 v76, v96, v97
    v_cvt_pk_bf16_f32 v77, v98, v99
    v_cvt_pk_bf16_f32 v78, v100, v101
    v_cvt_pk_bf16_f32 v79, v102, v103
    v_cvt_pk_bf16_f32 v80, v104, v105
    v_cvt_pk_bf16_f32 v81, v106, v107
    v_cvt_pk_bf16_f32 v82, v108, v109
    v_cvt_pk_bf16_f32 v83, v110, v111
    v_cvt_pk_bf16_f32 v84, v112, v113
    v_cvt_pk_bf16_f32 v85, v114, v115
    v_cvt_pk_bf16_f32 v86, v116, v117
    v_cvt_pk_bf16_f32 v87, v118, v119
    v_cvt_pk_bf16_f32 v88, v120, v121
    v_cvt_pk_bf16_f32 v89, v122, v123
    v_cvt_pk_bf16_f32 v90, v124, v125
    v_cvt_pk_bf16_f32 v91, v126, v127
    v_cvt_pk_bf16_f32 v92, v128, v129
    v_cvt_pk_bf16_f32 v93, v130, v131
    v_cvt_pk_bf16_f32 v94, v132, v133
    v_cvt_pk_bf16_f32 v95, v134, v135
    v_mov_b32 v14, 0xf149f2ca
    s_mov_b32 s30, 0x3e64f92e
    s_lshl_b32 s22, s20, 3
    s_lshl_b32 s28, s27, 1
    s_add_u32 s22, s22, s28
    s_mul_i32 s22, s22, 20480
    s_add_u32 s22, s22, 0x2c0000
    s_lshr_b32 s28, s21, 1
    s_mul_i32 s28, s28, 5120
    s_add_u32 s22, s22, s28
    s_add_u32 s23, s22, 2048
    s_and_b32 s28, s21, 1
    s_mul_i32 s29, s28, 3072
    s_add_u32 s22, s22, s29
    s_lshl_b32 s28, s28, 3
    s_add_u32 s23, s23, s28
    v_lshlrev_b32 v15, 4, v1
    v_mov_b32 v96, v76
    v_cndmask_b32 v98, v78, 0, s[56:57]
    v_mov_b32 v97, v77
    v_cndmask_b32 v99, v79, 0, s[56:57]
    v_cndmask_b32 v100, 0, v78, s[56:57]
    v_cndmask_b32 v102, v80, 0, s[58:59]
    v_cndmask_b32 v101, 0, v79, s[56:57]
    v_cndmask_b32 v103, v81, 0, s[58:59]
    v_cndmask_b32 v104, 0, v80, s[58:59]
    v_cndmask_b32 v106, v82, 0, s[60:61]
    v_cndmask_b32 v105, 0, v81, s[58:59]
    v_cndmask_b32 v107, v83, 0, s[60:61]
    v_cndmask_b32 v108, 0, v82, s[60:61]
    v_mov_b32 v110, v84
    v_cndmask_b32 v109, 0, v83, s[60:61]
    v_mov_b32 v111, v85
    v_mfma_f32_16x16x32_bf16 v[206:209], v[176:179], v[96:99], 0
    v_mfma_f32_16x16x32_bf16 v[210:213], v[186:189], v[96:99], 0
    v_mfma_f32_16x16x32_bf16 v[214:217], v[178:181], v[100:103], 0
    v_mfma_f32_16x16x32_bf16 v[218:221], v[188:191], v[100:103], 0
    v_mfma_f32_16x16x32_bf16 v[222:225], v[180:183], v[104:107], 0
    v_mfma_f32_16x16x32_bf16 v[226:229], v[190:193], v[104:107], 0
    v_mfma_f32_16x16x32_bf16 v[230:233], v[182:185], v[108:111], 0
    v_mfma_f32_16x16x32_bf16 v[234:237], v[192:195], v[108:111], 0
    s_nop 0
    v_cvt_pk_bf16_f32 v112, v206, v207
    v_cvt_pk_bf16_f32 v113, v208, v209
    v_cvt_pk_bf16_f32 v114, v210, v211
    v_cvt_pk_bf16_f32 v115, v212, v213
    v_cvt_pk_bf16_f32 v118, v214, v215
    v_cvt_pk_bf16_f32 v119, v216, v217
    v_cvt_pk_bf16_f32 v120, v218, v219
    v_cvt_pk_bf16_f32 v121, v220, v221
    v_cvt_pk_bf16_f32 v124, v222, v223
    v_cvt_pk_bf16_f32 v125, v224, v225
    v_cvt_pk_bf16_f32 v126, v226, v227
    v_cvt_pk_bf16_f32 v127, v228, v229
    v_cvt_pk_bf16_f32 v130, v230, v231
    v_cvt_pk_bf16_f32 v131, v232, v233
    v_cvt_pk_bf16_f32 v132, v234, v235
    v_cvt_pk_bf16_f32 v133, v236, v237
    v_lshlrev_b32 v206, 16, v112
    v_and_b32 v207, 0xffff0000, v112
    v_lshlrev_b32 v208, 16, v113
    v_and_b32 v209, 0xffff0000, v113
    v_lshlrev_b32 v210, 16, v114
    v_and_b32 v211, 0xffff0000, v114
    v_lshlrev_b32 v212, 16, v115
    v_and_b32 v213, 0xffff0000, v115
    v_lshlrev_b32 v214, 16, v118
    v_and_b32 v215, 0xffff0000, v118
    v_lshlrev_b32 v216, 16, v119
    v_and_b32 v217, 0xffff0000, v119
    v_lshlrev_b32 v218, 16, v120
    v_and_b32 v219, 0xffff0000, v120
    v_lshlrev_b32 v220, 16, v121
    v_and_b32 v221, 0xffff0000, v121
    v_lshlrev_b32 v222, 16, v124
    v_and_b32 v223, 0xffff0000, v124
    v_lshlrev_b32 v224, 16, v125
    v_and_b32 v225, 0xffff0000, v125
    v_lshlrev_b32 v226, 16, v126
    v_and_b32 v227, 0xffff0000, v126
    v_lshlrev_b32 v228, 16, v127
    v_and_b32 v229, 0xffff0000, v127
    v_lshlrev_b32 v230, 16, v130
    v_and_b32 v231, 0xffff0000, v130
    v_lshlrev_b32 v232, 16, v131
    v_and_b32 v233, 0xffff0000, v131
    v_lshlrev_b32 v234, 16, v132
    v_and_b32 v235, 0xffff0000, v132
    v_lshlrev_b32 v236, 16, v133
    v_and_b32 v237, 0xffff0000, v133
    v_mul_f32 v206, s30, v206
    v_mul_f32 v207, s30, v207
    v_mul_f32 v208, s30, v208
    v_mul_f32 v209, s30, v209
    v_mul_f32 v210, s30, v210
    v_mul_f32 v211, s30, v211
    v_mul_f32 v212, s30, v212
    v_mul_f32 v213, s30, v213
    v_mul_f32 v214, s30, v214
    v_mul_f32 v215, s30, v215
    v_mul_f32 v216, s30, v216
    v_mul_f32 v217, s30, v217
    v_mul_f32 v218, s30, v218
    v_mul_f32 v219, s30, v219
    v_mul_f32 v220, s30, v220
    v_mul_f32 v221, s30, v221
    v_mul_f32 v222, s30, v222
    v_mul_f32 v223, s30, v223
    v_mul_f32 v224, s30, v224
    v_mul_f32 v225, s30, v225
    v_mul_f32 v226, s30, v226
    v_mul_f32 v227, s30, v227
    v_mul_f32 v228, s30, v228
    v_mul_f32 v229, s30, v229
    v_mul_f32 v230, s30, v230
    v_mul_f32 v231, s30, v231
    v_mul_f32 v232, s30, v232
    v_mul_f32 v233, s30, v233
    v_mul_f32 v234, s30, v234
    v_mul_f32 v235, s30, v235
    v_mul_f32 v236, s30, v236
    v_mul_f32 v237, s30, v237
    v_cvt_pk_bf16_f32 v112, v206, v207
    v_cvt_pk_bf16_f32 v113, v208, v209
    v_cvt_pk_bf16_f32 v114, v210, v211
    v_cvt_pk_bf16_f32 v115, v212, v213
    v_cvt_pk_bf16_f32 v118, v214, v215
    v_cvt_pk_bf16_f32 v119, v216, v217
    v_cvt_pk_bf16_f32 v120, v218, v219
    v_cvt_pk_bf16_f32 v121, v220, v221
    v_cvt_pk_bf16_f32 v124, v222, v223
    v_cvt_pk_bf16_f32 v125, v224, v225
    v_cvt_pk_bf16_f32 v126, v226, v227
    v_cvt_pk_bf16_f32 v127, v228, v229
    v_cvt_pk_bf16_f32 v130, v230, v231
    v_cvt_pk_bf16_f32 v131, v232, v233
    v_cvt_pk_bf16_f32 v132, v234, v235
    v_cvt_pk_bf16_f32 v133, v236, v237
    v_lshlrev_b32 v206, 16, v112
    v_and_b32 v207, 0xffff0000, v112
    v_lshlrev_b32 v208, 16, v113
    v_and_b32 v209, 0xffff0000, v113
    v_lshlrev_b32 v210, 16, v114
    v_and_b32 v211, 0xffff0000, v114
    v_lshlrev_b32 v212, 16, v115
    v_and_b32 v213, 0xffff0000, v115
    v_lshlrev_b32 v214, 16, v118
    v_and_b32 v215, 0xffff0000, v118
    v_lshlrev_b32 v216, 16, v119
    v_and_b32 v217, 0xffff0000, v119
    v_lshlrev_b32 v218, 16, v120
    v_and_b32 v219, 0xffff0000, v120
    v_lshlrev_b32 v220, 16, v121
    v_and_b32 v221, 0xffff0000, v121
    v_lshlrev_b32 v222, 16, v124
    v_and_b32 v223, 0xffff0000, v124
    v_lshlrev_b32 v224, 16, v125
    v_and_b32 v225, 0xffff0000, v125
    v_lshlrev_b32 v226, 16, v126
    v_and_b32 v227, 0xffff0000, v126
    v_lshlrev_b32 v228, 16, v127
    v_and_b32 v229, 0xffff0000, v127
    v_lshlrev_b32 v230, 16, v130
    v_and_b32 v231, 0xffff0000, v130
    v_lshlrev_b32 v232, 16, v131
    v_and_b32 v233, 0xffff0000, v131
    v_lshlrev_b32 v234, 16, v132
    v_and_b32 v235, 0xffff0000, v132
    v_lshlrev_b32 v236, 16, v133
    v_and_b32 v237, 0xffff0000, v133
    v_cndmask_b32 v206, v14, v206, s[48:49]
    v_cndmask_b32 v210, v14, v210, s[32:33]
    v_cndmask_b32 v207, v14, v207, s[50:51]
    v_cndmask_b32 v211, v14, v211, s[34:35]
    v_cndmask_b32 v208, v14, v208, s[52:53]
    v_cndmask_b32 v212, v14, v212, s[36:37]
    v_cndmask_b32 v209, v14, v209, s[54:55]
    v_cndmask_b32 v213, v14, v213, s[38:39]
    v_cndmask_b32 v214, v14, v214, s[48:49]
    v_cndmask_b32 v218, v14, v218, s[32:33]
    v_cndmask_b32 v215, v14, v215, s[50:51]
    v_cndmask_b32 v219, v14, v219, s[34:35]
    v_cndmask_b32 v216, v14, v216, s[52:53]
    v_cndmask_b32 v220, v14, v220, s[36:37]
    v_cndmask_b32 v217, v14, v217, s[54:55]
    v_cndmask_b32 v221, v14, v221, s[38:39]
    v_cndmask_b32 v222, v14, v222, s[48:49]
    v_cndmask_b32 v226, v14, v226, s[32:33]
    v_cndmask_b32 v223, v14, v223, s[50:51]
    v_cndmask_b32 v227, v14, v227, s[34:35]
    v_cndmask_b32 v224, v14, v224, s[52:53]
    v_cndmask_b32 v228, v14, v228, s[36:37]
    v_cndmask_b32 v225, v14, v225, s[54:55]
    v_cndmask_b32 v229, v14, v229, s[38:39]
    v_cndmask_b32 v230, v14, v230, s[48:49]
    v_cndmask_b32 v234, v14, v234, s[32:33]
    v_cndmask_b32 v231, v14, v231, s[50:51]
    v_cndmask_b32 v235, v14, v235, s[34:35]
    v_cndmask_b32 v232, v14, v232, s[52:53]
    v_cndmask_b32 v236, v14, v236, s[36:37]
    v_cndmask_b32 v233, v14, v233, s[54:55]
    v_cndmask_b32 v237, v14, v237, s[38:39]
    v_max3_f32 v116, v206, v207, v208
    v_max3_f32 v116, v116, v209, v210
    v_max3_f32 v116, v116, v211, v212
    v_max_f32 v116, v116, v213
    v_max3_f32 v122, v214, v215, v216
    v_max3_f32 v122, v122, v217, v218
    v_max3_f32 v122, v122, v219, v220
    v_max_f32 v122, v122, v221
    v_max3_f32 v128, v222, v223, v224
    v_max3_f32 v128, v128, v225, v226
    v_max3_f32 v128, v128, v227, v228
    v_max_f32 v128, v128, v229
    v_max3_f32 v134, v230, v231, v232
    v_max3_f32 v134, v134, v233, v234
    v_max3_f32 v134, v134, v235, v236
    v_max_f32 v134, v134, v237
    v_mov_b32 v117, v116
    v_mov_b32 v123, v122
    v_mov_b32 v129, v128
    v_mov_b32 v135, v134
    v_permlane16_swap_b32 v116, v117
    v_permlane16_swap_b32 v122, v123
    v_permlane16_swap_b32 v128, v129
    v_permlane16_swap_b32 v134, v135
    v_max_f32 v116, v116, v117
    v_max_f32 v122, v122, v123
    v_max_f32 v128, v128, v129
    v_max_f32 v134, v134, v135
    v_mov_b32 v117, v116
    v_mov_b32 v123, v122
    v_mov_b32 v129, v128
    v_mov_b32 v135, v134
    v_permlane32_swap_b32 v116, v117
    v_permlane32_swap_b32 v122, v123
    v_permlane32_swap_b32 v128, v129
    v_permlane32_swap_b32 v134, v135
    v_max_f32 v116, v116, v117
    v_max_f32 v122, v122, v123
    v_max_f32 v128, v128, v129
    v_max_f32 v134, v134, v135
    v_mul_f32 v116, s31, v116
    v_mul_f32 v122, s31, v122
    v_mul_f32 v128, s31, v128
    v_mul_f32 v134, s31, v134
    v_fma_f32 v206, v206, s31, -v116
    v_fma_f32 v207, v207, s31, -v116
    v_fma_f32 v208, v208, s31, -v116
    v_fma_f32 v209, v209, s31, -v116
    v_fma_f32 v210, v210, s31, -v116
    v_fma_f32 v211, v211, s31, -v116
    v_fma_f32 v212, v212, s31, -v116
    v_fma_f32 v213, v213, s31, -v116
    v_fma_f32 v214, v214, s31, -v122
    v_fma_f32 v215, v215, s31, -v122
    v_fma_f32 v216, v216, s31, -v122
    v_fma_f32 v217, v217, s31, -v122
    v_fma_f32 v218, v218, s31, -v122
    v_fma_f32 v219, v219, s31, -v122
    v_fma_f32 v220, v220, s31, -v122
    v_fma_f32 v221, v221, s31, -v122
    v_fma_f32 v222, v222, s31, -v128
    v_fma_f32 v223, v223, s31, -v128
    v_fma_f32 v224, v224, s31, -v128
    v_fma_f32 v225, v225, s31, -v128
    v_fma_f32 v226, v226, s31, -v128
    v_fma_f32 v227, v227, s31, -v128
    v_fma_f32 v228, v228, s31, -v128
    v_fma_f32 v229, v229, s31, -v128
    v_fma_f32 v230, v230, s31, -v134
    v_fma_f32 v231, v231, s31, -v134
    v_fma_f32 v232, v232, s31, -v134
    v_fma_f32 v233, v233, s31, -v134
    v_fma_f32 v234, v234, s31, -v134
    v_fma_f32 v235, v235, s31, -v134
    v_fma_f32 v236, v236, s31, -v134
    v_fma_f32 v237, v237, s31, -v134
    v_exp_f32 v206, v206
    v_exp_f32 v207, v207
    v_exp_f32 v208, v208
    v_exp_f32 v209, v209
    v_exp_f32 v210, v210
    v_exp_f32 v211, v211
    v_exp_f32 v212, v212
    v_exp_f32 v213, v213
    v_exp_f32 v214, v214
    v_exp_f32 v215, v215
    v_exp_f32 v216, v216
    v_exp_f32 v217, v217
    v_exp_f32 v218, v218
    v_exp_f32 v219, v219
    v_exp_f32 v220, v220
    v_exp_f32 v221, v221
    v_exp_f32 v222, v222
    v_exp_f32 v223, v223
    v_exp_f32 v224, v224
    v_exp_f32 v225, v225
    v_exp_f32 v226, v226
    v_exp_f32 v227, v227
    v_exp_f32 v228, v228
    v_exp_f32 v229, v229
    v_exp_f32 v230, v230
    v_exp_f32 v231, v231
    v_exp_f32 v232, v232
    v_exp_f32 v233, v233
    v_exp_f32 v234, v234
    v_exp_f32 v235, v235
    v_exp_f32 v236, v236
    v_exp_f32 v237, v237
    v_add_f32 v116, v206, v207
    v_add_f32 v116, v116, v208
    v_add_f32 v116, v116, v209
    v_add_f32 v116, v116, v210
    v_add_f32 v116, v116, v211
    v_add_f32 v116, v116, v212
    v_add_f32 v116, v116, v213
    v_add_f32 v122, v214, v215
    v_add_f32 v122, v122, v216
    v_add_f32 v122, v122, v217
    v_add_f32 v122, v122, v218
    v_add_f32 v122, v122, v219
    v_add_f32 v122, v122, v220
    v_add_f32 v122, v122, v221
    v_add_f32 v128, v222, v223
    v_add_f32 v128, v128, v224
    v_add_f32 v128, v128, v225
    v_add_f32 v128, v128, v226
    v_add_f32 v128, v128, v227
    v_add_f32 v128, v128, v228
    v_add_f32 v128, v128, v229
    v_add_f32 v134, v230, v231
    v_add_f32 v134, v134, v232
    v_add_f32 v134, v134, v233
    v_add_f32 v134, v134, v234
    v_add_f32 v134, v134, v235
    v_add_f32 v134, v134, v236
    v_add_f32 v134, v134, v237
    v_mov_b32 v117, v116
    v_mov_b32 v123, v122
    v_mov_b32 v129, v128
    v_mov_b32 v135, v134
    v_permlane16_swap_b32 v116, v117
    v_permlane16_swap_b32 v122, v123
    v_permlane16_swap_b32 v128, v129
    v_permlane16_swap_b32 v134, v135
    v_add_f32 v116, v116, v117
    v_add_f32 v122, v122, v123
    v_add_f32 v128, v128, v129
    v_add_f32 v134, v134, v135
    v_mov_b32 v117, v116
    v_mov_b32 v123, v122
    v_mov_b32 v129, v128
    v_mov_b32 v135, v134
    v_permlane32_swap_b32 v116, v117
    v_permlane32_swap_b32 v122, v123
    v_permlane32_swap_b32 v128, v129
    v_permlane32_swap_b32 v134, v135
    v_add_f32 v116, v116, v117
    v_add_f32 v122, v122, v123
    v_add_f32 v128, v128, v129
    v_add_f32 v134, v134, v135
    v_rcp_f32 v116, v116
    v_rcp_f32 v122, v122
    v_rcp_f32 v128, v128
    v_rcp_f32 v134, v134
    v_mul_f32 v206, v206, v116
    v_mul_f32 v207, v207, v116
    v_mul_f32 v208, v208, v116
    v_mul_f32 v209, v209, v116
    v_mul_f32 v210, v210, v116
    v_mul_f32 v211, v211, v116
    v_mul_f32 v212, v212, v116
    v_mul_f32 v213, v213, v116
    v_mul_f32 v214, v214, v122
    v_mul_f32 v215, v215, v122
    v_mul_f32 v216, v216, v122
    v_mul_f32 v217, v217, v122
    v_mul_f32 v218, v218, v122
    v_mul_f32 v219, v219, v122
    v_mul_f32 v220, v220, v122
    v_mul_f32 v221, v221, v122
    v_mul_f32 v222, v222, v128
    v_mul_f32 v223, v223, v128
    v_mul_f32 v224, v224, v128
    v_mul_f32 v225, v225, v128
    v_mul_f32 v226, v226, v128
    v_mul_f32 v227, v227, v128
    v_mul_f32 v228, v228, v128
    v_mul_f32 v229, v229, v128
    v_mul_f32 v230, v230, v134
    v_mul_f32 v231, v231, v134
    v_mul_f32 v232, v232, v134
    v_mul_f32 v233, v233, v134
    v_mul_f32 v234, v234, v134
    v_mul_f32 v235, v235, v134
    v_mul_f32 v236, v236, v134
    v_mul_f32 v237, v237, v134
    v_cvt_pk_bf16_f32 v112, v206, v207
    v_cvt_pk_bf16_f32 v113, v208, v209
    v_cvt_pk_bf16_f32 v114, v210, v211
    v_cvt_pk_bf16_f32 v115, v212, v213
    v_cvt_pk_bf16_f32 v118, v214, v215
    v_cvt_pk_bf16_f32 v119, v216, v217
    v_cvt_pk_bf16_f32 v120, v218, v219
    v_cvt_pk_bf16_f32 v121, v220, v221
    v_cvt_pk_bf16_f32 v124, v222, v223
    v_cvt_pk_bf16_f32 v125, v224, v225
    v_cvt_pk_bf16_f32 v126, v226, v227
    v_cvt_pk_bf16_f32 v127, v228, v229
    v_cvt_pk_bf16_f32 v130, v230, v231
    v_cvt_pk_bf16_f32 v131, v232, v233
    v_cvt_pk_bf16_f32 v132, v234, v235
    v_cvt_pk_bf16_f32 v133, v236, v237
    v_mfma_f32_16x16x32_bf16 v[16:19], v[136:139], v[112:115], 0
    v_mfma_f32_16x16x32_bf16 v[20:23], v[142:145], v[112:115], 0
    v_mfma_f32_16x16x32_bf16 v[24:27], v[142:145], v[118:121], 0
    v_mfma_f32_16x16x32_bf16 v[28:31], v[148:151], v[118:121], 0
    v_mfma_f32_16x16x32_bf16 v[32:35], v[148:151], v[124:127], 0
    v_mfma_f32_16x16x32_bf16 v[36:39], v[154:157], v[124:127], 0
    v_mfma_f32_16x16x32_bf16 v[40:43], v[154:157], v[130:133], 0
    v_mfma_f32_16x16x32_bf16 v[44:47], v[160:163], v[130:133], 0
    s_nop 0
    v_cvt_pk_bf16_f32 v48, v16, v17
    v_cvt_pk_bf16_f32 v49, v18, v19
    v_cndmask_b32 v24, v20, v24, s[56:57]
    v_cndmask_b32 v25, v21, v25, s[56:57]
    v_cndmask_b32 v26, v22, v26, s[56:57]
    v_cndmask_b32 v27, v23, v27, s[56:57]
    v_cvt_pk_bf16_f32 v50, v24, v25
    v_cvt_pk_bf16_f32 v51, v26, v27
    v_cndmask_b32 v32, v28, v32, s[58:59]
    v_cndmask_b32 v33, v29, v33, s[58:59]
    v_cndmask_b32 v34, v30, v34, s[58:59]
    v_cndmask_b32 v35, v31, v35, s[58:59]
    v_cvt_pk_bf16_f32 v52, v32, v33
    v_cvt_pk_bf16_f32 v53, v34, v35
    v_cndmask_b32 v40, v36, v40, s[60:61]
    v_cndmask_b32 v41, v37, v41, s[60:61]
    v_cndmask_b32 v42, v38, v42, s[60:61]
    v_cndmask_b32 v43, v39, v43, s[60:61]
    v_cvt_pk_bf16_f32 v54, v40, v41
    v_cvt_pk_bf16_f32 v55, v42, v43
    v_cvt_pk_bf16_f32 v56, v44, v45
    v_cvt_pk_bf16_f32 v57, v46, v47
    buffer_store_dwordx4 v[48:51], v15, s[12:15], s22 offen offset:0 sc0 sc1
    buffer_store_dwordx4 v[52:55], v15, s[12:15], s22 offen offset:1024 sc0 sc1
    buffer_store_dwordx2 v[56:57], v15, s[12:15], s23 offen sc0 sc1
    s_add_u32 s22, s22, 20480
    s_add_u32 s23, s23, 20480
    v_mov_b32 v96, v86
    v_cndmask_b32 v98, v88, 0, s[56:57]
    v_mov_b32 v97, v87
    v_cndmask_b32 v99, v89, 0, s[56:57]
    v_cndmask_b32 v100, 0, v88, s[56:57]
    v_cndmask_b32 v102, v90, 0, s[58:59]
    v_cndmask_b32 v101, 0, v89, s[56:57]
    v_cndmask_b32 v103, v91, 0, s[58:59]
    v_cndmask_b32 v104, 0, v90, s[58:59]
    v_cndmask_b32 v106, v92, 0, s[60:61]
    v_cndmask_b32 v105, 0, v91, s[58:59]
    v_cndmask_b32 v107, v93, 0, s[60:61]
    v_cndmask_b32 v108, 0, v92, s[60:61]
    v_mov_b32 v110, v94
    v_cndmask_b32 v109, 0, v93, s[60:61]
    v_mov_b32 v111, v95
    v_mfma_f32_16x16x32_bf16 v[206:209], v[186:189], v[96:99], 0
    v_mfma_f32_16x16x32_bf16 v[210:213], v[196:199], v[96:99], 0
    v_mfma_f32_16x16x32_bf16 v[214:217], v[188:191], v[100:103], 0
    v_mfma_f32_16x16x32_bf16 v[218:221], v[198:201], v[100:103], 0
    v_mfma_f32_16x16x32_bf16 v[222:225], v[190:193], v[104:107], 0
    v_mfma_f32_16x16x32_bf16 v[226:229], v[200:203], v[104:107], 0
    v_mfma_f32_16x16x32_bf16 v[230:233], v[192:195], v[108:111], 0
    v_mfma_f32_16x16x32_bf16 v[234:237], v[202:205], v[108:111], 0
    s_nop 0
    v_cvt_pk_bf16_f32 v112, v206, v207
    v_cvt_pk_bf16_f32 v113, v208, v209
    v_cvt_pk_bf16_f32 v114, v210, v211
    v_cvt_pk_bf16_f32 v115, v212, v213
    v_cvt_pk_bf16_f32 v118, v214, v215
    v_cvt_pk_bf16_f32 v119, v216, v217
    v_cvt_pk_bf16_f32 v120, v218, v219
    v_cvt_pk_bf16_f32 v121, v220, v221
    v_cvt_pk_bf16_f32 v124, v222, v223
    v_cvt_pk_bf16_f32 v125, v224, v225
    v_cvt_pk_bf16_f32 v126, v226, v227
    v_cvt_pk_bf16_f32 v127, v228, v229
    v_cvt_pk_bf16_f32 v130, v230, v231
    v_cvt_pk_bf16_f32 v131, v232, v233
    v_cvt_pk_bf16_f32 v132, v234, v235
    v_cvt_pk_bf16_f32 v133, v236, v237
    v_lshlrev_b32 v206, 16, v112
    v_and_b32 v207, 0xffff0000, v112
    v_lshlrev_b32 v208, 16, v113
    v_and_b32 v209, 0xffff0000, v113
    v_lshlrev_b32 v210, 16, v114
    v_and_b32 v211, 0xffff0000, v114
    v_lshlrev_b32 v212, 16, v115
    v_and_b32 v213, 0xffff0000, v115
    v_lshlrev_b32 v214, 16, v118
    v_and_b32 v215, 0xffff0000, v118
    v_lshlrev_b32 v216, 16, v119
    v_and_b32 v217, 0xffff0000, v119
    v_lshlrev_b32 v218, 16, v120
    v_and_b32 v219, 0xffff0000, v120
    v_lshlrev_b32 v220, 16, v121
    v_and_b32 v221, 0xffff0000, v121
    v_lshlrev_b32 v222, 16, v124
    v_and_b32 v223, 0xffff0000, v124
    v_lshlrev_b32 v224, 16, v125
    v_and_b32 v225, 0xffff0000, v125
    v_lshlrev_b32 v226, 16, v126
    v_and_b32 v227, 0xffff0000, v126
    v_lshlrev_b32 v228, 16, v127
    v_and_b32 v229, 0xffff0000, v127
    v_lshlrev_b32 v230, 16, v130
    v_and_b32 v231, 0xffff0000, v130
    v_lshlrev_b32 v232, 16, v131
    v_and_b32 v233, 0xffff0000, v131
    v_lshlrev_b32 v234, 16, v132
    v_and_b32 v235, 0xffff0000, v132
    v_lshlrev_b32 v236, 16, v133
    v_and_b32 v237, 0xffff0000, v133
    v_mul_f32 v206, s30, v206
    v_mul_f32 v207, s30, v207
    v_mul_f32 v208, s30, v208
    v_mul_f32 v209, s30, v209
    v_mul_f32 v210, s30, v210
    v_mul_f32 v211, s30, v211
    v_mul_f32 v212, s30, v212
    v_mul_f32 v213, s30, v213
    v_mul_f32 v214, s30, v214
    v_mul_f32 v215, s30, v215
    v_mul_f32 v216, s30, v216
    v_mul_f32 v217, s30, v217
    v_mul_f32 v218, s30, v218
    v_mul_f32 v219, s30, v219
    v_mul_f32 v220, s30, v220
    v_mul_f32 v221, s30, v221
    v_mul_f32 v222, s30, v222
    v_mul_f32 v223, s30, v223
    v_mul_f32 v224, s30, v224
    v_mul_f32 v225, s30, v225
    v_mul_f32 v226, s30, v226
    v_mul_f32 v227, s30, v227
    v_mul_f32 v228, s30, v228
    v_mul_f32 v229, s30, v229
    v_mul_f32 v230, s30, v230
    v_mul_f32 v231, s30, v231
    v_mul_f32 v232, s30, v232
    v_mul_f32 v233, s30, v233
    v_mul_f32 v234, s30, v234
    v_mul_f32 v235, s30, v235
    v_mul_f32 v236, s30, v236
    v_mul_f32 v237, s30, v237
    v_cvt_pk_bf16_f32 v112, v206, v207
    v_cvt_pk_bf16_f32 v113, v208, v209
    v_cvt_pk_bf16_f32 v114, v210, v211
    v_cvt_pk_bf16_f32 v115, v212, v213
    v_cvt_pk_bf16_f32 v118, v214, v215
    v_cvt_pk_bf16_f32 v119, v216, v217
    v_cvt_pk_bf16_f32 v120, v218, v219
    v_cvt_pk_bf16_f32 v121, v220, v221
    v_cvt_pk_bf16_f32 v124, v222, v223
    v_cvt_pk_bf16_f32 v125, v224, v225
    v_cvt_pk_bf16_f32 v126, v226, v227
    v_cvt_pk_bf16_f32 v127, v228, v229
    v_cvt_pk_bf16_f32 v130, v230, v231
    v_cvt_pk_bf16_f32 v131, v232, v233
    v_cvt_pk_bf16_f32 v132, v234, v235
    v_cvt_pk_bf16_f32 v133, v236, v237
    v_lshlrev_b32 v206, 16, v112
    v_and_b32 v207, 0xffff0000, v112
    v_lshlrev_b32 v208, 16, v113
    v_and_b32 v209, 0xffff0000, v113
    v_lshlrev_b32 v210, 16, v114
    v_and_b32 v211, 0xffff0000, v114
    v_lshlrev_b32 v212, 16, v115
    v_and_b32 v213, 0xffff0000, v115
    v_lshlrev_b32 v214, 16, v118
    v_and_b32 v215, 0xffff0000, v118
    v_lshlrev_b32 v216, 16, v119
    v_and_b32 v217, 0xffff0000, v119
    v_lshlrev_b32 v218, 16, v120
    v_and_b32 v219, 0xffff0000, v120
    v_lshlrev_b32 v220, 16, v121
    v_and_b32 v221, 0xffff0000, v121
    v_lshlrev_b32 v222, 16, v124
    v_and_b32 v223, 0xffff0000, v124
    v_lshlrev_b32 v224, 16, v125
    v_and_b32 v225, 0xffff0000, v125
    v_lshlrev_b32 v226, 16, v126
    v_and_b32 v227, 0xffff0000, v126
    v_lshlrev_b32 v228, 16, v127
    v_and_b32 v229, 0xffff0000, v127
    v_lshlrev_b32 v230, 16, v130
    v_and_b32 v231, 0xffff0000, v130
    v_lshlrev_b32 v232, 16, v131
    v_and_b32 v233, 0xffff0000, v131
    v_lshlrev_b32 v234, 16, v132
    v_and_b32 v235, 0xffff0000, v132
    v_lshlrev_b32 v236, 16, v133
    v_and_b32 v237, 0xffff0000, v133
    v_cndmask_b32 v206, v14, v206, s[40:41]
    v_cndmask_b32 v210, v14, v210, s[32:33]
    v_cndmask_b32 v207, v14, v207, s[42:43]
    v_cndmask_b32 v211, v14, v211, s[34:35]
    v_cndmask_b32 v208, v14, v208, s[44:45]
    v_cndmask_b32 v212, v14, v212, s[36:37]
    v_cndmask_b32 v209, v14, v209, s[46:47]
    v_cndmask_b32 v213, v14, v213, s[38:39]
    v_cndmask_b32 v214, v14, v214, s[40:41]
    v_cndmask_b32 v218, v14, v218, s[32:33]
    v_cndmask_b32 v215, v14, v215, s[42:43]
    v_cndmask_b32 v219, v14, v219, s[34:35]
    v_cndmask_b32 v216, v14, v216, s[44:45]
    v_cndmask_b32 v220, v14, v220, s[36:37]
    v_cndmask_b32 v217, v14, v217, s[46:47]
    v_cndmask_b32 v221, v14, v221, s[38:39]
    v_cndmask_b32 v222, v14, v222, s[40:41]
    v_cndmask_b32 v226, v14, v226, s[32:33]
    v_cndmask_b32 v223, v14, v223, s[42:43]
    v_cndmask_b32 v227, v14, v227, s[34:35]
    v_cndmask_b32 v224, v14, v224, s[44:45]
    v_cndmask_b32 v228, v14, v228, s[36:37]
    v_cndmask_b32 v225, v14, v225, s[46:47]
    v_cndmask_b32 v229, v14, v229, s[38:39]
    v_cndmask_b32 v230, v14, v230, s[40:41]
    v_cndmask_b32 v234, v14, v234, s[32:33]
    v_cndmask_b32 v231, v14, v231, s[42:43]
    v_cndmask_b32 v235, v14, v235, s[34:35]
    v_cndmask_b32 v232, v14, v232, s[44:45]
    v_cndmask_b32 v236, v14, v236, s[36:37]
    v_cndmask_b32 v233, v14, v233, s[46:47]
    v_cndmask_b32 v237, v14, v237, s[38:39]
    v_max3_f32 v116, v206, v207, v208
    v_max3_f32 v116, v116, v209, v210
    v_max3_f32 v116, v116, v211, v212
    v_max_f32 v116, v116, v213
    v_max3_f32 v122, v214, v215, v216
    v_max3_f32 v122, v122, v217, v218
    v_max3_f32 v122, v122, v219, v220
    v_max_f32 v122, v122, v221
    v_max3_f32 v128, v222, v223, v224
    v_max3_f32 v128, v128, v225, v226
    v_max3_f32 v128, v128, v227, v228
    v_max_f32 v128, v128, v229
    v_max3_f32 v134, v230, v231, v232
    v_max3_f32 v134, v134, v233, v234
    v_max3_f32 v134, v134, v235, v236
    v_max_f32 v134, v134, v237
    v_mov_b32 v117, v116
    v_mov_b32 v123, v122
    v_mov_b32 v129, v128
    v_mov_b32 v135, v134
    v_permlane16_swap_b32 v116, v117
    v_permlane16_swap_b32 v122, v123
    v_permlane16_swap_b32 v128, v129
    v_permlane16_swap_b32 v134, v135
    v_max_f32 v116, v116, v117
    v_max_f32 v122, v122, v123
    v_max_f32 v128, v128, v129
    v_max_f32 v134, v134, v135
    v_mov_b32 v117, v116
    v_mov_b32 v123, v122
    v_mov_b32 v129, v128
    v_mov_b32 v135, v134
    v_permlane32_swap_b32 v116, v117
    v_permlane32_swap_b32 v122, v123
    v_permlane32_swap_b32 v128, v129
    v_permlane32_swap_b32 v134, v135
    v_max_f32 v116, v116, v117
    v_max_f32 v122, v122, v123
    v_max_f32 v128, v128, v129
    v_max_f32 v134, v134, v135
    v_mul_f32 v116, s31, v116
    v_mul_f32 v122, s31, v122
    v_mul_f32 v128, s31, v128
    v_mul_f32 v134, s31, v134
    v_fma_f32 v206, v206, s31, -v116
    v_fma_f32 v207, v207, s31, -v116
    v_fma_f32 v208, v208, s31, -v116
    v_fma_f32 v209, v209, s31, -v116
    v_fma_f32 v210, v210, s31, -v116
    v_fma_f32 v211, v211, s31, -v116
    v_fma_f32 v212, v212, s31, -v116
    v_fma_f32 v213, v213, s31, -v116
    v_fma_f32 v214, v214, s31, -v122
    v_fma_f32 v215, v215, s31, -v122
    v_fma_f32 v216, v216, s31, -v122
    v_fma_f32 v217, v217, s31, -v122
    v_fma_f32 v218, v218, s31, -v122
    v_fma_f32 v219, v219, s31, -v122
    v_fma_f32 v220, v220, s31, -v122
    v_fma_f32 v221, v221, s31, -v122
    v_fma_f32 v222, v222, s31, -v128
    v_fma_f32 v223, v223, s31, -v128
    v_fma_f32 v224, v224, s31, -v128
    v_fma_f32 v225, v225, s31, -v128
    v_fma_f32 v226, v226, s31, -v128
    v_fma_f32 v227, v227, s31, -v128
    v_fma_f32 v228, v228, s31, -v128
    v_fma_f32 v229, v229, s31, -v128
    v_fma_f32 v230, v230, s31, -v134
    v_fma_f32 v231, v231, s31, -v134
    v_fma_f32 v232, v232, s31, -v134
    v_fma_f32 v233, v233, s31, -v134
    v_fma_f32 v234, v234, s31, -v134
    v_fma_f32 v235, v235, s31, -v134
    v_fma_f32 v236, v236, s31, -v134
    v_fma_f32 v237, v237, s31, -v134
    v_exp_f32 v206, v206
    v_exp_f32 v207, v207
    v_exp_f32 v208, v208
    v_exp_f32 v209, v209
    v_exp_f32 v210, v210
    v_exp_f32 v211, v211
    v_exp_f32 v212, v212
    v_exp_f32 v213, v213
    v_exp_f32 v214, v214
    v_exp_f32 v215, v215
    v_exp_f32 v216, v216
    v_exp_f32 v217, v217
    v_exp_f32 v218, v218
    v_exp_f32 v219, v219
    v_exp_f32 v220, v220
    v_exp_f32 v221, v221
    v_exp_f32 v222, v222
    v_exp_f32 v223, v223
    v_exp_f32 v224, v224
    v_exp_f32 v225, v225
    v_exp_f32 v226, v226
    v_exp_f32 v227, v227
    v_exp_f32 v228, v228
    v_exp_f32 v229, v229
    v_exp_f32 v230, v230
    v_exp_f32 v231, v231
    v_exp_f32 v232, v232
    v_exp_f32 v233, v233
    v_exp_f32 v234, v234
    v_exp_f32 v235, v235
    v_exp_f32 v236, v236
    v_exp_f32 v237, v237
    v_add_f32 v116, v206, v207
    v_add_f32 v116, v116, v208
    v_add_f32 v116, v116, v209
    v_add_f32 v116, v116, v210
    v_add_f32 v116, v116, v211
    v_add_f32 v116, v116, v212
    v_add_f32 v116, v116, v213
    v_add_f32 v122, v214, v215
    v_add_f32 v122, v122, v216
    v_add_f32 v122, v122, v217
    v_add_f32 v122, v122, v218
    v_add_f32 v122, v122, v219
    v_add_f32 v122, v122, v220
    v_add_f32 v122, v122, v221
    v_add_f32 v128, v222, v223
    v_add_f32 v128, v128, v224
    v_add_f32 v128, v128, v225
    v_add_f32 v128, v128, v226
    v_add_f32 v128, v128, v227
    v_add_f32 v128, v128, v228
    v_add_f32 v128, v128, v229
    v_add_f32 v134, v230, v231
    v_add_f32 v134, v134, v232
    v_add_f32 v134, v134, v233
    v_add_f32 v134, v134, v234
    v_add_f32 v134, v134, v235
    v_add_f32 v134, v134, v236
    v_add_f32 v134, v134, v237
    v_mov_b32 v117, v116
    v_mov_b32 v123, v122
    v_mov_b32 v129, v128
    v_mov_b32 v135, v134
    v_permlane16_swap_b32 v116, v117
    v_permlane16_swap_b32 v122, v123
    v_permlane16_swap_b32 v128, v129
    v_permlane16_swap_b32 v134, v135
    v_add_f32 v116, v116, v117
    v_add_f32 v122, v122, v123
    v_add_f32 v128, v128, v129
    v_add_f32 v134, v134, v135
    v_mov_b32 v117, v116
    v_mov_b32 v123, v122
    v_mov_b32 v129, v128
    v_mov_b32 v135, v134
    v_permlane32_swap_b32 v116, v117
    v_permlane32_swap_b32 v122, v123
    v_permlane32_swap_b32 v128, v129
    v_permlane32_swap_b32 v134, v135
    v_add_f32 v116, v116, v117
    v_add_f32 v122, v122, v123
    v_add_f32 v128, v128, v129
    v_add_f32 v134, v134, v135
    v_rcp_f32 v116, v116
    v_rcp_f32 v122, v122
    v_rcp_f32 v128, v128
    v_rcp_f32 v134, v134
    v_mul_f32 v206, v206, v116
    v_mul_f32 v207, v207, v116
    v_mul_f32 v208, v208, v116
    v_mul_f32 v209, v209, v116
    v_mul_f32 v210, v210, v116
    v_mul_f32 v211, v211, v116
    v_mul_f32 v212, v212, v116
    v_mul_f32 v213, v213, v116
    v_mul_f32 v214, v214, v122
    v_mul_f32 v215, v215, v122
    v_mul_f32 v216, v216, v122
    v_mul_f32 v217, v217, v122
    v_mul_f32 v218, v218, v122
    v_mul_f32 v219, v219, v122
    v_mul_f32 v220, v220, v122
    v_mul_f32 v221, v221, v122
    v_mul_f32 v222, v222, v128
    v_mul_f32 v223, v223, v128
    v_mul_f32 v224, v224, v128
    v_mul_f32 v225, v225, v128
    v_mul_f32 v226, v226, v128
    v_mul_f32 v227, v227, v128
    v_mul_f32 v228, v228, v128
    v_mul_f32 v229, v229, v128
    v_mul_f32 v230, v230, v134
    v_mul_f32 v231, v231, v134
    v_mul_f32 v232, v232, v134
    v_mul_f32 v233, v233, v134
    v_mul_f32 v234, v234, v134
    v_mul_f32 v235, v235, v134
    v_mul_f32 v236, v236, v134
    v_mul_f32 v237, v237, v134
    v_cvt_pk_bf16_f32 v112, v206, v207
    v_cvt_pk_bf16_f32 v113, v208, v209
    v_cvt_pk_bf16_f32 v114, v210, v211
    v_cvt_pk_bf16_f32 v115, v212, v213
    v_cvt_pk_bf16_f32 v118, v214, v215
    v_cvt_pk_bf16_f32 v119, v216, v217
    v_cvt_pk_bf16_f32 v120, v218, v219
    v_cvt_pk_bf16_f32 v121, v220, v221
    v_cvt_pk_bf16_f32 v124, v222, v223
    v_cvt_pk_bf16_f32 v125, v224, v225
    v_cvt_pk_bf16_f32 v126, v226, v227
    v_cvt_pk_bf16_f32 v127, v228, v229
    v_cvt_pk_bf16_f32 v130, v230, v231
    v_cvt_pk_bf16_f32 v131, v232, v233
    v_cvt_pk_bf16_f32 v132, v234, v235
    v_cvt_pk_bf16_f32 v133, v236, v237
    v_mfma_f32_16x16x32_bf16 v[16:19], v[138:141], v[112:115], 0
    v_mfma_f32_16x16x32_bf16 v[20:23], v[144:147], v[112:115], 0
    v_mfma_f32_16x16x32_bf16 v[24:27], v[144:147], v[118:121], 0
    v_mfma_f32_16x16x32_bf16 v[28:31], v[150:153], v[118:121], 0
    v_mfma_f32_16x16x32_bf16 v[32:35], v[150:153], v[124:127], 0
    v_mfma_f32_16x16x32_bf16 v[36:39], v[156:159], v[124:127], 0
    v_mfma_f32_16x16x32_bf16 v[40:43], v[156:159], v[130:133], 0
    v_mfma_f32_16x16x32_bf16 v[44:47], v[162:165], v[130:133], 0
    s_nop 0
    v_cvt_pk_bf16_f32 v58, v16, v17
    v_cvt_pk_bf16_f32 v59, v18, v19
    v_cndmask_b32 v24, v20, v24, s[56:57]
    v_cndmask_b32 v25, v21, v25, s[56:57]
    v_cndmask_b32 v26, v22, v26, s[56:57]
    v_cndmask_b32 v27, v23, v27, s[56:57]
    v_cvt_pk_bf16_f32 v60, v24, v25
    v_cvt_pk_bf16_f32 v61, v26, v27
    v_cndmask_b32 v32, v28, v32, s[58:59]
    v_cndmask_b32 v33, v29, v33, s[58:59]
    v_cndmask_b32 v34, v30, v34, s[58:59]
    v_cndmask_b32 v35, v31, v35, s[58:59]
    v_cvt_pk_bf16_f32 v62, v32, v33
    v_cvt_pk_bf16_f32 v63, v34, v35
    v_cndmask_b32 v40, v36, v40, s[60:61]
    v_cndmask_b32 v41, v37, v41, s[60:61]
    v_cndmask_b32 v42, v38, v42, s[60:61]
    v_cndmask_b32 v43, v39, v43, s[60:61]
    v_cvt_pk_bf16_f32 v64, v40, v41
    v_cvt_pk_bf16_f32 v65, v42, v43
    v_cvt_pk_bf16_f32 v66, v44, v45
    v_cvt_pk_bf16_f32 v67, v46, v47
    buffer_store_dwordx4 v[58:61], v15, s[12:15], s22 offen offset:0 sc0 sc1
    buffer_store_dwordx4 v[62:65], v15, s[12:15], s22 offen offset:1024 sc0 sc1
    buffer_store_dwordx2 v[66:67], v15, s[12:15], s23 offen sc0 sc1
    s_nop 1
L_p2:
    s_lshl_b32 s37, s20, 2
    s_lshl_b32 s28, s3, 6
    s_sub_u32 s37, s37, s28
    s_add_u32 s37, s37, 64
    s_and_b32 s28, s2, 7
    s_lshr_b32 s29, s2, 3
    s_lshr_b32 s20, s28, 1
    s_lshl_b32 s20, s20, 3
    s_lshr_b32 s30, s29, 2
    s_add_u32 s20, s20, s30
    s_and_b32 s21, s28, 1
    s_lshl_b32 s21, s21, 2
    s_and_b32 s30, s29, 3
    s_add_u32 s21, s21, s30
    s_mul_i32 s23, s21, 160
    v_lshlrev_b32 v4, 4, v1
    v_add_u32 v26, 0, v1
    v_mul_u32_u24 v24, 0x199a, v26
    v_lshrrev_b32 v24, 16, v24
    v_mul_u32_u24 v25, 10, v24
    v_sub_u32 v25, v26, v25
    v_lshrrev_b32 v26, 4, v24
    v_bfe_u32 v27, v24, 2, 2
    v_and_b32 v28, 3, v24
    v_lshlrev_b32 v25, 4, v25
    v_mul_u32_u24 v31, 80, v26
    v_mul_u32_u24 v30, 1280, v24
    v_add_u32 v5, v25, v30
    v_lshl_add_u32 v29, v27, 2, v28
    v_add_u32 v30, v31, v29
    v_mul_u32_u24 v30, 1280, v30
    v_add_u32 v10, v25, v30
    v_mul_u32_u24 v29, 20, v27
    v_add_u32 v29, v29, v28
    v_lshl_add_u32 v30, v26, 2, v29
    v_mul_u32_u24 v30, 1280, v30
    v_add_u32 v216, v25, v30
    v_add_u32 v30, v31, v29
    v_mul_u32_u24 v30, 1280, v30
    v_add_u32 v221, v25, v30
    v_add_u32 v26, 64, v1
    v_mul_u32_u24 v24, 0x199a, v26
    v_lshrrev_b32 v24, 16, v24
    v_mul_u32_u24 v25, 10, v24
    v_sub_u32 v25, v26, v25
    v_lshrrev_b32 v26, 4, v24
    v_bfe_u32 v27, v24, 2, 2
    v_and_b32 v28, 3, v24
    v_lshlrev_b32 v25, 4, v25
    v_mul_u32_u24 v31, 80, v26
    v_mul_u32_u24 v30, 1280, v24
    v_add_u32 v6, v25, v30
    v_lshl_add_u32 v29, v27, 2, v28
    v_add_u32 v30, v31, v29
    v_mul_u32_u24 v30, 1280, v30
    v_add_u32 v11, v25, v30
    v_mul_u32_u24 v29, 20, v27
    v_add_u32 v29, v29, v28
    v_lshl_add_u32 v30, v26, 2, v29
    v_mul_u32_u24 v30, 1280, v30
    v_add_u32 v217, v25, v30
    v_add_u32 v30, v31, v29
    v_mul_u32_u24 v30, 1280, v30
    v_add_u32 v222, v25, v30
    v_add_u32 v26, 128, v1
    v_mul_u32_u24 v24, 0x199a, v26
    v_lshrrev_b32 v24, 16, v24
    v_mul_u32_u24 v25, 10, v24
    v_sub_u32 v25, v26, v25
    v_lshrrev_b32 v26, 4, v24
    v_bfe_u32 v27, v24, 2, 2
    v_and_b32 v28, 3, v24
    v_lshlrev_b32 v25, 4, v25
    v_mul_u32_u24 v31, 80, v26
    v_mul_u32_u24 v30, 1280, v24
    v_add_u32 v7, v25, v30
    v_lshl_add_u32 v29, v27, 2, v28
    v_add_u32 v30, v31, v29
    v_mul_u32_u24 v30, 1280, v30
    v_add_u32 v12, v25, v30
    v_mul_u32_u24 v29, 20, v27
    v_add_u32 v29, v29, v28
    v_lshl_add_u32 v30, v26, 2, v29
    v_mul_u32_u24 v30, 1280, v30
    v_add_u32 v218, v25, v30
    v_add_u32 v30, v31, v29
    v_mul_u32_u24 v30, 1280, v30
    v_add_u32 v223, v25, v30
    v_add_u32 v26, 192, v1
    v_mul_u32_u24 v24, 0x199a, v26
    v_lshrrev_b32 v24, 16, v24
    v_mul_u32_u24 v25, 10, v24
    v_sub_u32 v25, v26, v25
    v_lshrrev_b32 v26, 4, v24
    v_bfe_u32 v27, v24, 2, 2
    v_and_b32 v28, 3, v24
    v_lshlrev_b32 v25, 4, v25
    v_mul_u32_u24 v31, 80, v26
    v_mul_u32_u24 v30, 1280, v24
    v_add_u32 v8, v25, v30
    v_lshl_add_u32 v29, v27, 2, v28
    v_add_u32 v30, v31, v29
    v_mul_u32_u24 v30, 1280, v30
    v_add_u32 v13, v25, v30
    v_mul_u32_u24 v29, 20, v27
    v_add_u32 v29, v29, v28
    v_lshl_add_u32 v30, v26, 2, v29
    v_mul_u32_u24 v30, 1280, v30
    v_add_u32 v219, v25, v30
    v_add_u32 v30, v31, v29
    v_mul_u32_u24 v30, 1280, v30
    v_add_u32 v224, v25, v30
    v_add_u32 v26, 256, v1
    v_mul_u32_u24 v24, 0x199a, v26
    v_lshrrev_b32 v24, 16, v24
    v_mul_u32_u24 v25, 10, v24
    v_sub_u32 v25, v26, v25
    v_lshrrev_b32 v26, 4, v24
    v_bfe_u32 v27, v24, 2, 2
    v_and_b32 v28, 3, v24
    v_lshlrev_b32 v25, 4, v25
    v_mul_u32_u24 v31, 80, v26
    v_mul_u32_u24 v30, 1280, v24
    v_add_u32 v9, v25, v30
    v_lshl_add_u32 v29, v27, 2, v28
    v_add_u32 v30, v31, v29
    v_mul_u32_u24 v30, 1280, v30
    v_add_u32 v14, v25, v30
    v_mul_u32_u24 v29, 20, v27
    v_add_u32 v29, v29, v28
    v_lshl_add_u32 v30, v26, 2, v29
    v_mul_u32_u24 v30, 1280, v30
    v_add_u32 v220, v25, v30
    v_add_u32 v30, v31, v29
    v_mul_u32_u24 v30, 1280, v30
    v_add_u32 v225, v25, v30
    s_waitcnt vmcnt(0)
    s_barrier
    s_cmp_lg_u32 s27, 0
    s_cbranch_scc1 L_p2_ns
    v_mov_b32 v24, 1
    s_mov_b64 exec, 1
    buffer_atomic_add v24, off, s[16:19], s37 offset:64
    s_mov_b64 exec, -1
    s_nop 1
L_p2_ns:
    s_mov_b32 s8, s76
    s_mov_b32 s9, s77
    s_mov_b32 s10, 0xc8000
    s_mov_b32 s11, 0x00020000
    s_mov_b32 s40, s70
    s_mov_b32 s41, s71
    s_mov_b32 s42, 0xc8000
    s_mov_b32 s43, 0x00020000
    s_mov_b32 s32, s80
    s_mov_b32 s33, s81
    s_mov_b32 s34, 0x280000
    s_mov_b32 s35, 0x00020000
    s_lshl_b32 s22, s20, 2
    s_add_u32 s22, s22, s27
    s_mul_i32 s22, s22, 20480
    s_add_u32 s28, s27, 0
    s_mul_i32 s29, s28, 13
    s_lshr_b32 s29, s29, 6
    s_mul_i32 s36, s29, 5
    s_sub_u32 s28, s28, s36
    s_mul_i32 s29, s29, 160
    s_cmp_ge_u32 s28, 3
    s_cselect_b32 s36, 80, 0
    s_cselect_b32 s38, 3, 0
    s_add_u32 s29, s29, s36
    s_sub_u32 s36, s28, s38
    s_mul_i32 s36, s36, 32
    s_add_u32 s29, s29, s36
    s_mul_i32 s29, s29, 1280
    s_add_u32 s29, s29, s23
    s_cmp_eq_u32 s28, 2
    s_cbranch_scc1 L_p2y0
    s_add_u32 m0, s26, 0
    s_nop 0
    buffer_load_dwordx4 v5, s[8:11], s29 offen lds
    s_add_u32 m0, s26, 1024
    s_nop 0
    buffer_load_dwordx4 v6, s[8:11], s29 offen lds
    s_add_u32 m0, s26, 2048
    s_nop 0
    buffer_load_dwordx4 v7, s[8:11], s29 offen lds
    s_add_u32 m0, s26, 3072
    s_nop 0
    buffer_load_dwordx4 v8, s[8:11], s29 offen lds
    s_add_u32 m0, s26, 4096
    s_nop 0
    buffer_load_dwordx4 v9, s[8:11], s29 offen lds
    s_branch L_p2j0
    s_nop 0
L_p2y0:
    s_add_u32 m0, s26, 0
    s_nop 0
    buffer_load_dwordx4 v10, s[8:11], s29 offen lds
    s_add_u32 m0, s26, 1024
    s_nop 0
    buffer_load_dwordx4 v11, s[8:11], s29 offen lds
    s_add_u32 m0, s26, 2048
    s_nop 0
    buffer_load_dwordx4 v12, s[8:11], s29 offen lds
    s_add_u32 m0, s26, 3072
    s_nop 0
    buffer_load_dwordx4 v13, s[8:11], s29 offen lds
    s_add_u32 m0, s26, 4096
    s_nop 0
    buffer_load_dwordx4 v14, s[8:11], s29 offen lds
L_p2j0:
    s_add_u32 s28, s27, 4
    s_mul_i32 s29, s28, 13
    s_lshr_b32 s29, s29, 6
    s_mul_i32 s36, s29, 5
    s_sub_u32 s28, s28, s36
    s_mul_i32 s29, s29, 160
    s_cmp_ge_u32 s28, 3
    s_cselect_b32 s36, 80, 0
    s_cselect_b32 s38, 3, 0
    s_add_u32 s29, s29, s36
    s_sub_u32 s36, s28, s38
    s_mul_i32 s36, s36, 32
    s_add_u32 s29, s29, s36
    s_mul_i32 s29, s29, 1280
    s_add_u32 s29, s29, s23
    s_cmp_eq_u32 s28, 2
    s_cbranch_scc1 L_p2y1
    s_add_u32 m0, s26, 20480
    s_nop 0
    buffer_load_dwordx4 v5, s[8:11], s29 offen lds
    s_add_u32 m0, s26, 21504
    s_nop 0
    buffer_load_dwordx4 v6, s[8:11], s29 offen lds
    s_add_u32 m0, s26, 22528
    s_nop 0
    buffer_load_dwordx4 v7, s[8:11], s29 offen lds
    s_add_u32 m0, s26, 23552
    s_nop 0
    buffer_load_dwordx4 v8, s[8:11], s29 offen lds
    s_add_u32 m0, s26, 24576
    s_nop 0
    buffer_load_dwordx4 v9, s[8:11], s29 offen lds
    s_branch L_p2j1
    s_nop 0
L_p2y1:
    s_add_u32 m0, s26, 20480
    s_nop 0
    buffer_load_dwordx4 v10, s[8:11], s29 offen lds
    s_add_u32 m0, s26, 21504
    s_nop 0
    buffer_load_dwordx4 v11, s[8:11], s29 offen lds
    s_add_u32 m0, s26, 22528
    s_nop 0
    buffer_load_dwordx4 v12, s[8:11], s29 offen lds
    s_add_u32 m0, s26, 23552
    s_nop 0
    buffer_load_dwordx4 v13, s[8:11], s29 offen lds
    s_add_u32 m0, s26, 24576
    s_nop 0
    buffer_load_dwordx4 v14, s[8:11], s29 offen lds
L_p2j1:
    s_add_u32 s28, s27, 8
    s_mul_i32 s29, s28, 13
    s_lshr_b32 s29, s29, 6
    s_mul_i32 s36, s29, 5
    s_sub_u32 s28, s28, s36
    s_mul_i32 s29, s29, 160
    s_cmp_ge_u32 s28, 3
    s_cselect_b32 s36, 80, 0
    s_cselect_b32 s38, 3, 0
    s_add_u32 s29, s29, s36
    s_sub_u32 s36, s28, s38
    s_mul_i32 s36, s36, 32
    s_add_u32 s29, s29, s36
    s_mul_i32 s29, s29, 1280
    s_add_u32 s29, s29, s23
    s_cmp_eq_u32 s28, 2
    s_cbranch_scc1 L_p2y2
    s_add_u32 m0, s26, 40960
    s_nop 0
    buffer_load_dwordx4 v5, s[8:11], s29 offen lds
    s_add_u32 m0, s26, 41984
    s_nop 0
    buffer_load_dwordx4 v6, s[8:11], s29 offen lds
    s_add_u32 m0, s26, 43008
    s_nop 0
    buffer_load_dwordx4 v7, s[8:11], s29 offen lds
    s_add_u32 m0, s26, 44032
    s_nop 0
    buffer_load_dwordx4 v8, s[8:11], s29 offen lds
    s_add_u32 m0, s26, 45056
    s_nop 0
    buffer_load_dwordx4 v9, s[8:11], s29 offen lds
    s_branch L_p2j2
    s_nop 0
L_p2y2:
    s_add_u32 m0, s26, 40960
    s_nop 0
    buffer_load_dwordx4 v10, s[8:11], s29 offen lds
    s_add_u32 m0, s26, 41984
    s_nop 0
    buffer_load_dwordx4 v11, s[8:11], s29 offen lds
    s_add_u32 m0, s26, 43008
    s_nop 0
    buffer_load_dwordx4 v12, s[8:11], s29 offen lds
    s_add_u32 m0, s26, 44032
    s_nop 0
    buffer_load_dwordx4 v13, s[8:11], s29 offen lds
    s_add_u32 m0, s26, 45056
    s_nop 0
    buffer_load_dwordx4 v14, s[8:11], s29 offen lds
L_p2j2:
    s_add_u32 s28, s27, 12
    s_mul_i32 s29, s28, 13
    s_lshr_b32 s29, s29, 6
    s_mul_i32 s36, s29, 5
    s_sub_u32 s28, s28, s36
    s_mul_i32 s29, s29, 160
    s_cmp_ge_u32 s28, 3
    s_cselect_b32 s36, 80, 0
    s_cselect_b32 s38, 3, 0
    s_add_u32 s29, s29, s36
    s_sub_u32 s36, s28, s38
    s_mul_i32 s36, s36, 32
    s_add_u32 s29, s29, s36
    s_mul_i32 s29, s29, 1280
    s_add_u32 s29, s29, s23
    s_cmp_eq_u32 s28, 2
    s_cbranch_scc1 L_p2y3
    s_add_u32 m0, s26, 61440
    s_nop 0
    buffer_load_dwordx4 v5, s[8:11], s29 offen lds
    s_add_u32 m0, s26, 62464
    s_nop 0
    buffer_load_dwordx4 v6, s[8:11], s29 offen lds
    s_add_u32 m0, s26, 63488
    s_nop 0
    buffer_load_dwordx4 v7, s[8:11], s29 offen lds
    s_add_u32 m0, s26, 64512
    s_nop 0
    buffer_load_dwordx4 v8, s[8:11], s29 offen lds
    s_add_u32 m0, s26, 65536
    s_nop 0
    buffer_load_dwordx4 v9, s[8:11], s29 offen lds
    s_branch L_p2j3
    s_nop 0
L_p2y3:
    s_add_u32 m0, s26, 61440
    s_nop 0
    buffer_load_dwordx4 v10, s[8:11], s29 offen lds
    s_add_u32 m0, s26, 62464
    s_nop 0
    buffer_load_dwordx4 v11, s[8:11], s29 offen lds
    s_add_u32 m0, s26, 63488
    s_nop 0
    buffer_load_dwordx4 v12, s[8:11], s29 offen lds
    s_add_u32 m0, s26, 64512
    s_nop 0
    buffer_load_dwordx4 v13, s[8:11], s29 offen lds
    s_add_u32 m0, s26, 65536
    s_nop 0
    buffer_load_dwordx4 v14, s[8:11], s29 offen lds
L_p2j3:
    s_lshr_b32 s30, s20, 1
    s_lshl_b32 s30, s30, 2
    s_cmp_lg_u32 s27, 0
    s_cbranch_scc1 L_prb_w
    s_mov_b32 s29, 0x20000
    s_nop 0
L_prb:
    buffer_load_dword v23, off, s[16:19], s30 offset:64 sc1
    s_waitcnt vmcnt(0)
    v_readfirstlane_b32 s28, v23
    s_nop 0
    s_cmp_ge_u32 s28, 8
    s_cbranch_scc1 L_prb_done
    s_sleep 4
    s_sub_u32 s29, s29, 1
    s_cmp_lg_u32 s29, 0
    s_cbranch_scc1 L_prb
    s_nop 0
L_prb_done:
L_prb_w:
    s_barrier
    s_add_u32 s28, s22, 0x2c0000
    buffer_load_dwordx4 a[0:3], v4, s[12:15], s28 offen
    s_add_u32 s28, s28, 1024
    buffer_load_dwordx4 a[4:7], v4, s[12:15], s28 offen
    s_add_u32 s28, s28, 1024
    buffer_load_dwordx4 a[8:11], v4, s[12:15], s28 offen
    s_add_u32 s28, s28, 1024
    buffer_load_dwordx4 a[12:15], v4, s[12:15], s28 offen
    s_add_u32 s28, s28, 1024
    buffer_load_dwordx4 a[16:19], v4, s[12:15], s28 offen
    s_add_u32 s28, s28, 1024
    buffer_load_dwordx4 a[20:23], v4, s[12:15], s28 offen
    s_add_u32 s28, s28, 1024
    buffer_load_dwordx4 a[24:27], v4, s[12:15], s28 offen
    s_add_u32 s28, s28, 1024
    buffer_load_dwordx4 a[28:31], v4, s[12:15], s28 offen
    s_add_u32 s28, s28, 1024
    buffer_load_dwordx4 a[32:35], v4, s[12:15], s28 offen
    s_add_u32 s28, s28, 1024
    buffer_load_dwordx4 a[36:39], v4, s[12:15], s28 offen
    s_add_u32 s28, s28, 1024
    buffer_load_dwordx4 a[40:43], v4, s[12:15], s28 offen
    s_add_u32 s28, s28, 1024
    buffer_load_dwordx4 a[44:47], v4, s[12:15], s28 offen
    s_add_u32 s28, s28, 1024
    buffer_load_dwordx4 a[48:51], v4, s[12:15], s28 offen
    s_add_u32 s28, s28, 1024
    buffer_load_dwordx4 a[52:55], v4, s[12:15], s28 offen
    s_add_u32 s28, s28, 1024
    buffer_load_dwordx4 a[56:59], v4, s[12:15], s28 offen
    s_add_u32 s28, s28, 1024
    buffer_load_dwordx4 a[60:63], v4, s[12:15], s28 offen
    s_add_u32 s28, s28, 1024
    buffer_load_dwordx4 a[64:67], v4, s[12:15], s28 offen
    s_add_u32 s28, s28, 1024
    buffer_load_dwordx4 a[68:71], v4, s[12:15], s28 offen
    s_add_u32 s28, s28, 1024
    buffer_load_dwordx4 a[72:75], v4, s[12:15], s28 offen
    s_add_u32 s28, s28, 1024
    buffer_load_dwordx4 a[76:79], v4, s[12:15], s28 offen
    s_add_u32 s28, s28, 1024
    s_lshl_b32 s28, s20, 6
    s_lshl_b32 s29, s27, 4
    s_add_u32 s28, s28, s29
    v_add_u32 v16, s28, v3
    v_lshlrev_b32 v17, 2, v16
    s_mov_b32 s29, 0x20000
    buffer_load_dword v18, v17, s[12:15], s29 offen
    v_lshrrev_b32 v24, 2, v3
    v_and_b32 v25, 3, v3
    v_lshl_add_u32 v24, v2, 2, v24
    v_mul_u32_u24 v24, 160, v24
    v_lshl_add_u32 v20, v25, 3, v24
    v_add_u32 v21, 61440, v20
    v_add_u32 v22, 61440, v21
    s_waitcnt vmcnt(36)
    s_barrier
    s_add_u32 s28, s27, 16
    s_mul_i32 s29, s28, 13
    s_lshr_b32 s29, s29, 6
    s_mul_i32 s36, s29, 5
    s_sub_u32 s28, s28, s36
    s_mul_i32 s29, s29, 160
    s_cmp_ge_u32 s28, 3
    s_cselect_b32 s36, 80, 0
    s_cselect_b32 s38, 3, 0
    s_add_u32 s29, s29, s36
    s_sub_u32 s36, s28, s38
    s_mul_i32 s36, s36, 32
    s_add_u32 s29, s29, s36
    s_mul_i32 s29, s29, 1280
    s_add_u32 s29, s29, s23
    s_cmp_eq_u32 s28, 2
    s_cbranch_scc1 L_p2y4
    s_add_u32 m0, s26, 81920
    s_nop 0
    buffer_load_dwordx4 v5, s[8:11], s29 offen lds
    s_add_u32 m0, s26, 82944
    s_nop 0
    buffer_load_dwordx4 v6, s[8:11], s29 offen lds
    s_add_u32 m0, s26, 83968
    s_nop 0
    buffer_load_dwordx4 v7, s[8:11], s29 offen lds
    s_add_u32 m0, s26, 84992
    s_nop 0
    buffer_load_dwordx4 v8, s[8:11], s29 offen lds
    s_add_u32 m0, s26, 86016
    s_nop 0
    buffer_load_dwordx4 v9, s[8:11], s29 offen lds
    s_branch L_p2j4
    s_nop 0
L_p2y4:
    s_add_u32 m0, s26, 81920
    s_nop 0
    buffer_load_dwordx4 v10, s[8:11], s29 offen lds
    s_add_u32 m0, s26, 82944
    s_nop 0
    buffer_load_dwordx4 v11, s[8:11], s29 offen lds
    s_add_u32 m0, s26, 83968
    s_nop 0
    buffer_load_dwordx4 v12, s[8:11], s29 offen lds
    s_add_u32 m0, s26, 84992
    s_nop 0
    buffer_load_dwordx4 v13, s[8:11], s29 offen lds
    s_add_u32 m0, s26, 86016
    s_nop 0
    buffer_load_dwordx4 v14, s[8:11], s29 offen lds
L_p2j4:
    ds_read_b64_tr_b16 v[24:25], v20 offset:0
    ds_read_b64_tr_b16 v[26:27], v20 offset:2560
    ds_read_b64_tr_b16 v[28:29], v20 offset:32
    ds_read_b64_tr_b16 v[30:31], v20 offset:2592
    ds_read_b64_tr_b16 v[32:33], v20 offset:64
    ds_read_b64_tr_b16 v[34:35], v20 offset:2624
    ds_read_b64_tr_b16 v[36:37], v20 offset:96
    ds_read_b64_tr_b16 v[38:39], v20 offset:2656
    ds_read_b64_tr_b16 v[40:41], v20 offset:128
    ds_read_b64_tr_b16 v[42:43], v20 offset:2688
    ds_read_b64_tr_b16 v[44:45], v20 offset:5120
    ds_read_b64_tr_b16 v[46:47], v20 offset:7680
    ds_read_b64_tr_b16 v[48:49], v20 offset:5152
    ds_read_b64_tr_b16 v[50:51], v20 offset:7712
    ds_read_b64_tr_b16 v[52:53], v20 offset:5184
    ds_read_b64_tr_b16 v[54:55], v20 offset:7744
    ds_read_b64_tr_b16 v[56:57], v20 offset:5216
    ds_read_b64_tr_b16 v[58:59], v20 offset:7776
    ds_read_b64_tr_b16 v[60:61], v20 offset:5248
    ds_read_b64_tr_b16 v[62:63], v20 offset:7808
    s_waitcnt lgkmcnt(10)
    s_waitcnt vmcnt(25)
    v_mfma_f32_16x16x32_bf16 v[96:99], v[24:27], a[0:3], 0
    ds_read_b64_tr_b16 v[64:65], v20 offset:10240
    ds_read_b64_tr_b16 v[66:67], v20 offset:12800
    v_mfma_f32_16x16x32_bf16 v[100:103], v[28:31], a[0:3], 0
    ds_read_b64_tr_b16 v[68:69], v20 offset:10272
    ds_read_b64_tr_b16 v[70:71], v20 offset:12832
    v_mfma_f32_16x16x32_bf16 v[104:107], v[32:35], a[0:3], 0
    ds_read_b64_tr_b16 v[72:73], v20 offset:10304
    ds_read_b64_tr_b16 v[74:75], v20 offset:12864
    v_mfma_f32_16x16x32_bf16 v[108:111], v[36:39], a[0:3], 0
    ds_read_b64_tr_b16 v[76:77], v20 offset:10336
    ds_read_b64_tr_b16 v[78:79], v20 offset:12896
    v_mfma_f32_16x16x32_bf16 v[112:115], v[40:43], a[0:3], 0
    ds_read_b64_tr_b16 v[80:81], v20 offset:10368
    ds_read_b64_tr_b16 v[82:83], v20 offset:12928
    s_waitcnt lgkmcnt(10)
    s_waitcnt vmcnt(24)
    v_mfma_f32_16x16x32_bf16 v[96:99], v[44:47], a[4:7], v[96:99]
    ds_read_b64_tr_b16 v[24:25], v20 offset:15360
    ds_read_b64_tr_b16 v[26:27], v20 offset:17920
    v_mfma_f32_16x16x32_bf16 v[100:103], v[48:51], a[4:7], v[100:103]
    ds_read_b64_tr_b16 v[28:29], v20 offset:15392
    ds_read_b64_tr_b16 v[30:31], v20 offset:17952
    v_mfma_f32_16x16x32_bf16 v[104:107], v[52:55], a[4:7], v[104:107]
    ds_read_b64_tr_b16 v[32:33], v20 offset:15424
    ds_read_b64_tr_b16 v[34:35], v20 offset:17984
    v_mfma_f32_16x16x32_bf16 v[108:111], v[56:59], a[4:7], v[108:111]
    ds_read_b64_tr_b16 v[36:37], v20 offset:15456
    ds_read_b64_tr_b16 v[38:39], v20 offset:18016
    v_mfma_f32_16x16x32_bf16 v[112:115], v[60:63], a[4:7], v[112:115]
    ds_read_b64_tr_b16 v[40:41], v20 offset:15488
    ds_read_b64_tr_b16 v[42:43], v20 offset:18048
    s_waitcnt lgkmcnt(10)
    s_waitcnt vmcnt(23)
    s_barrier
    s_add_u32 s28, s27, 0
    s_mul_i32 s29, s28, 13
    s_lshr_b32 s29, s29, 6
    s_mul_i32 s36, s29, 5
    s_sub_u32 s28, s28, s36
    s_mul_i32 s29, s29, 160
    s_cmp_ge_u32 s28, 3
    s_cselect_b32 s36, 80, 0
    s_cselect_b32 s38, 3, 0
    s_add_u32 s29, s29, s36
    s_sub_u32 s36, s28, s38
    s_mul_i32 s36, s36, 8
    s_add_u32 s29, s29, s36
    s_mul_i32 s29, s29, 1280
    s_add_u32 s29, s29, s23
    s_cmp_eq_u32 s28, 2
    s_cbranch_scc1 L_p2y5
    s_add_u32 m0, s26, 102400
    s_nop 0
    buffer_load_dwordx4 v216, s[40:43], s29 offen lds
    s_add_u32 m0, s26, 103424
    s_nop 0
    buffer_load_dwordx4 v217, s[40:43], s29 offen lds
    s_add_u32 m0, s26, 104448
    s_nop 0
    buffer_load_dwordx4 v218, s[40:43], s29 offen lds
    s_add_u32 m0, s26, 105472
    s_nop 0
    buffer_load_dwordx4 v219, s[40:43], s29 offen lds
    s_add_u32 m0, s26, 106496
    s_nop 0
    buffer_load_dwordx4 v220, s[40:43], s29 offen lds
    s_branch L_p2j5
    s_nop 0
L_p2y5:
    s_add_u32 m0, s26, 102400
    s_nop 0
    buffer_load_dwordx4 v221, s[40:43], s29 offen lds
    s_add_u32 m0, s26, 103424
    s_nop 0
    buffer_load_dwordx4 v222, s[40:43], s29 offen lds
    s_add_u32 m0, s26, 104448
    s_nop 0
    buffer_load_dwordx4 v223, s[40:43], s29 offen lds
    s_add_u32 m0, s26, 105472
    s_nop 0
    buffer_load_dwordx4 v224, s[40:43], s29 offen lds
    s_add_u32 m0, s26, 106496
    s_nop 0
    buffer_load_dwordx4 v225, s[40:43], s29 offen lds
L_p2j5:
    v_mfma_f32_16x16x32_bf16 v[96:99], v[64:67], a[8:11], v[96:99]
    ds_read_b64_tr_b16 v[44:45], v20 offset:20480
    ds_read_b64_tr_b16 v[46:47], v20 offset:23040
    v_mfma_f32_16x16x32_bf16 v[100:103], v[68:71], a[8:11], v[100:103]
    ds_read_b64_tr_b16 v[48:49], v20 offset:20512
    ds_read_b64_tr_b16 v[50:51], v20 offset:23072
    v_mfma_f32_16x16x32_bf16 v[104:107], v[72:75], a[8:11], v[104:107]
    ds_read_b64_tr_b16 v[52:53], v20 offset:20544
    ds_read_b64_tr_b16 v[54:55], v20 offset:23104
    v_mfma_f32_16x16x32_bf16 v[108:111], v[76:79], a[8:11], v[108:111]
    ds_read_b64_tr_b16 v[56:57], v20 offset:20576
    ds_read_b64_tr_b16 v[58:59], v20 offset:23136
    v_mfma_f32_16x16x32_bf16 v[112:115], v[80:83], a[8:11], v[112:115]
    ds_read_b64_tr_b16 v[60:61], v20 offset:20608
    ds_read_b64_tr_b16 v[62:63], v20 offset:23168
    s_waitcnt lgkmcnt(10)
    s_waitcnt vmcnt(27)
    v_mfma_f32_16x16x32_bf16 v[96:99], v[24:27], a[12:15], v[96:99]
    ds_read_b64_tr_b16 v[64:65], v20 offset:25600
    ds_read_b64_tr_b16 v[66:67], v20 offset:28160
    v_mfma_f32_16x16x32_bf16 v[100:103], v[28:31], a[12:15], v[100:103]
    ds_read_b64_tr_b16 v[68:69], v20 offset:25632
    ds_read_b64_tr_b16 v[70:71], v20 offset:28192
    v_mfma_f32_16x16x32_bf16 v[104:107], v[32:35], a[12:15], v[104:107]
    ds_read_b64_tr_b16 v[72:73], v20 offset:25664
    ds_read_b64_tr_b16 v[74:75], v20 offset:28224
    v_mfma_f32_16x16x32_bf16 v[108:111], v[36:39], a[12:15], v[108:111]
    ds_read_b64_tr_b16 v[76:77], v20 offset:25696
    ds_read_b64_tr_b16 v[78:79], v20 offset:28256
    v_mfma_f32_16x16x32_bf16 v[112:115], v[40:43], a[12:15], v[112:115]
    ds_read_b64_tr_b16 v[80:81], v20 offset:25728
    ds_read_b64_tr_b16 v[82:83], v20 offset:28288
    s_waitcnt lgkmcnt(10)
    s_waitcnt vmcnt(26)
    v_mfma_f32_16x16x32_bf16 v[96:99], v[44:47], a[16:19], v[96:99]
    ds_read_b64_tr_b16 v[24:25], v20 offset:30720
    ds_read_b64_tr_b16 v[26:27], v20 offset:33280
    v_mfma_f32_16x16x32_bf16 v[100:103], v[48:51], a[16:19], v[100:103]
    ds_read_b64_tr_b16 v[28:29], v20 offset:30752
    ds_read_b64_tr_b16 v[30:31], v20 offset:33312
    v_mfma_f32_16x16x32_bf16 v[104:107], v[52:55], a[16:19], v[104:107]
    ds_read_b64_tr_b16 v[32:33], v20 offset:30784
    ds_read_b64_tr_b16 v[34:35], v20 offset:33344
    v_mfma_f32_16x16x32_bf16 v[108:111], v[56:59], a[16:19], v[108:111]
    ds_read_b64_tr_b16 v[36:37], v20 offset:30816
    ds_read_b64_tr_b16 v[38:39], v20 offset:33376
    v_mfma_f32_16x16x32_bf16 v[112:115], v[60:63], a[16:19], v[112:115]
    ds_read_b64_tr_b16 v[40:41], v20 offset:30848
    ds_read_b64_tr_b16 v[42:43], v20 offset:33408
    s_waitcnt lgkmcnt(10)
    s_waitcnt vmcnt(25)
    v_mfma_f32_16x16x32_bf16 v[96:99], v[64:67], a[20:23], v[96:99]
    ds_read_b64_tr_b16 v[44:45], v20 offset:35840
    ds_read_b64_tr_b16 v[46:47], v20 offset:38400
    v_mfma_f32_16x16x32_bf16 v[100:103], v[68:71], a[20:23], v[100:103]
    ds_read_b64_tr_b16 v[48:49], v20 offset:35872
    ds_read_b64_tr_b16 v[50:51], v20 offset:38432
    v_mfma_f32_16x16x32_bf16 v[104:107], v[72:75], a[20:23], v[104:107]
    ds_read_b64_tr_b16 v[52:53], v20 offset:35904
    ds_read_b64_tr_b16 v[54:55], v20 offset:38464
    v_mfma_f32_16x16x32_bf16 v[108:111], v[76:79], a[20:23], v[108:111]
    ds_read_b64_tr_b16 v[56:57], v20 offset:35936
    ds_read_b64_tr_b16 v[58:59], v20 offset:38496
    v_mfma_f32_16x16x32_bf16 v[112:115], v[80:83], a[20:23], v[112:115]
    ds_read_b64_tr_b16 v[60:61], v20 offset:35968
    ds_read_b64_tr_b16 v[62:63], v20 offset:38528
    s_waitcnt lgkmcnt(10)
    s_waitcnt vmcnt(24)
    s_barrier
    s_add_u32 s28, s27, 4
    s_mul_i32 s29, s28, 13
    s_lshr_b32 s29, s29, 6
    s_mul_i32 s36, s29, 5
    s_sub_u32 s28, s28, s36
    s_mul_i32 s29, s29, 160
    s_cmp_ge_u32 s28, 3
    s_cselect_b32 s36, 80, 0
    s_cselect_b32 s38, 3, 0
    s_add_u32 s29, s29, s36
    s_sub_u32 s36, s28, s38
    s_mul_i32 s36, s36, 8
    s_add_u32 s29, s29, s36
    s_mul_i32 s29, s29, 1280
    s_add_u32 s29, s29, s23
    s_cmp_eq_u32 s28, 2
    s_cbranch_scc1 L_p2y6
    s_add_u32 m0, s26, 122880
    s_nop 0
    buffer_load_dwordx4 v216, s[40:43], s29 offen lds
    s_add_u32 m0, s26, 123904
    s_nop 0
    buffer_load_dwordx4 v217, s[40:43], s29 offen lds
    s_add_u32 m0, s26, 124928
    s_nop 0
    buffer_load_dwordx4 v218, s[40:43], s29 offen lds
    s_add_u32 m0, s26, 125952
    s_nop 0
    buffer_load_dwordx4 v219, s[40:43], s29 offen lds
    s_add_u32 m0, s26, 126976
    s_nop 0
    buffer_load_dwordx4 v220, s[40:43], s29 offen lds
    s_branch L_p2j6
    s_nop 0
L_p2y6:
    s_add_u32 m0, s26, 122880
    s_nop 0
    buffer_load_dwordx4 v221, s[40:43], s29 offen lds
    s_add_u32 m0, s26, 123904
    s_nop 0
    buffer_load_dwordx4 v222, s[40:43], s29 offen lds
    s_add_u32 m0, s26, 124928
    s_nop 0
    buffer_load_dwordx4 v223, s[40:43], s29 offen lds
    s_add_u32 m0, s26, 125952
    s_nop 0
    buffer_load_dwordx4 v224, s[40:43], s29 offen lds
    s_add_u32 m0, s26, 126976
    s_nop 0
    buffer_load_dwordx4 v225, s[40:43], s29 offen lds
L_p2j6:
    v_mfma_f32_16x16x32_bf16 v[96:99], v[24:27], a[24:27], v[96:99]
    ds_read_b64_tr_b16 v[64:65], v20 offset:40960
    ds_read_b64_tr_b16 v[66:67], v20 offset:43520
    v_mfma_f32_16x16x32_bf16 v[100:103], v[28:31], a[24:27], v[100:103]
    ds_read_b64_tr_b16 v[68:69], v20 offset:40992
    ds_read_b64_tr_b16 v[70:71], v20 offset:43552
    v_mfma_f32_16x16x32_bf16 v[104:107], v[32:35], a[24:27], v[104:107]
    ds_read_b64_tr_b16 v[72:73], v20 offset:41024
    ds_read_b64_tr_b16 v[74:75], v20 offset:43584
    v_mfma_f32_16x16x32_bf16 v[108:111], v[36:39], a[24:27], v[108:111]
    ds_read_b64_tr_b16 v[76:77], v20 offset:41056
    ds_read_b64_tr_b16 v[78:79], v20 offset:43616
    v_mfma_f32_16x16x32_bf16 v[112:115], v[40:43], a[24:27], v[112:115]
    ds_read_b64_tr_b16 v[80:81], v20 offset:41088
    ds_read_b64_tr_b16 v[82:83], v20 offset:43648
    s_waitcnt lgkmcnt(10)
    s_waitcnt vmcnt(28)
    v_mfma_f32_16x16x32_bf16 v[96:99], v[44:47], a[28:31], v[96:99]
    ds_read_b64_tr_b16 v[24:25], v20 offset:46080
    ds_read_b64_tr_b16 v[26:27], v20 offset:48640
    v_mfma_f32_16x16x32_bf16 v[100:103], v[48:51], a[28:31], v[100:103]
    ds_read_b64_tr_b16 v[28:29], v20 offset:46112
    ds_read_b64_tr_b16 v[30:31], v20 offset:48672
    v_mfma_f32_16x16x32_bf16 v[104:107], v[52:55], a[28:31], v[104:107]
    ds_read_b64_tr_b16 v[32:33], v20 offset:46144
    ds_read_b64_tr_b16 v[34:35], v20 offset:48704
    v_mfma_f32_16x16x32_bf16 v[108:111], v[56:59], a[28:31], v[108:111]
    ds_read_b64_tr_b16 v[36:37], v20 offset:46176
    ds_read_b64_tr_b16 v[38:39], v20 offset:48736
    v_mfma_f32_16x16x32_bf16 v[112:115], v[60:63], a[28:31], v[112:115]
    ds_read_b64_tr_b16 v[40:41], v20 offset:46208
    ds_read_b64_tr_b16 v[42:43], v20 offset:48768
    s_waitcnt lgkmcnt(10)
    s_waitcnt vmcnt(27)
    v_mfma_f32_16x16x32_bf16 v[96:99], v[64:67], a[32:35], v[96:99]
    ds_read_b64_tr_b16 v[44:45], v20 offset:51200
    ds_read_b64_tr_b16 v[46:47], v20 offset:53760
    v_mfma_f32_16x16x32_bf16 v[100:103], v[68:71], a[32:35], v[100:103]
    ds_read_b64_tr_b16 v[48:49], v20 offset:51232
    ds_read_b64_tr_b16 v[50:51], v20 offset:53792
    v_mfma_f32_16x16x32_bf16 v[104:107], v[72:75], a[32:35], v[104:107]
    ds_read_b64_tr_b16 v[52:53], v20 offset:51264
    ds_read_b64_tr_b16 v[54:55], v20 offset:53824
    v_mfma_f32_16x16x32_bf16 v[108:111], v[76:79], a[32:35], v[108:111]
    ds_read_b64_tr_b16 v[56:57], v20 offset:51296
    ds_read_b64_tr_b16 v[58:59], v20 offset:53856
    v_mfma_f32_16x16x32_bf16 v[112:115], v[80:83], a[32:35], v[112:115]
    ds_read_b64_tr_b16 v[60:61], v20 offset:51328
    ds_read_b64_tr_b16 v[62:63], v20 offset:53888
    s_waitcnt lgkmcnt(10)
    s_waitcnt vmcnt(26)
    v_mfma_f32_16x16x32_bf16 v[96:99], v[24:27], a[36:39], v[96:99]
    ds_read_b64_tr_b16 v[64:65], v20 offset:56320
    ds_read_b64_tr_b16 v[66:67], v20 offset:58880
    v_mfma_f32_16x16x32_bf16 v[100:103], v[28:31], a[36:39], v[100:103]
    ds_read_b64_tr_b16 v[68:69], v20 offset:56352
    ds_read_b64_tr_b16 v[70:71], v20 offset:58912
    v_mfma_f32_16x16x32_bf16 v[104:107], v[32:35], a[36:39], v[104:107]
    ds_read_b64_tr_b16 v[72:73], v20 offset:56384
    ds_read_b64_tr_b16 v[74:75], v20 offset:58944
    v_mfma_f32_16x16x32_bf16 v[108:111], v[36:39], a[36:39], v[108:111]
    ds_read_b64_tr_b16 v[76:77], v20 offset:56416
    ds_read_b64_tr_b16 v[78:79], v20 offset:58976
    v_mfma_f32_16x16x32_bf16 v[112:115], v[40:43], a[36:39], v[112:115]
    ds_read_b64_tr_b16 v[80:81], v20 offset:56448
    ds_read_b64_tr_b16 v[82:83], v20 offset:59008
    s_waitcnt lgkmcnt(10)
    s_waitcnt vmcnt(25)
    s_barrier
    s_add_u32 s28, s27, 8
    s_mul_i32 s29, s28, 13
    s_lshr_b32 s29, s29, 6
    s_mul_i32 s36, s29, 5
    s_sub_u32 s28, s28, s36
    s_mul_i32 s29, s29, 160
    s_cmp_ge_u32 s28, 3
    s_cselect_b32 s36, 80, 0
    s_cselect_b32 s38, 3, 0
    s_add_u32 s29, s29, s36
    s_sub_u32 s36, s28, s38
    s_mul_i32 s36, s36, 8
    s_add_u32 s29, s29, s36
    s_mul_i32 s29, s29, 1280
    s_add_u32 s29, s29, s23
    s_cmp_eq_u32 s28, 2
    s_cbranch_scc1 L_p2y7
    s_add_u32 m0, s26, 143360
    s_nop 0
    buffer_load_dwordx4 v216, s[40:43], s29 offen lds
    s_add_u32 m0, s26, 144384
    s_nop 0
    buffer_load_dwordx4 v217, s[40:43], s29 offen lds
    s_add_u32 m0, s26, 145408
    s_nop 0
    buffer_load_dwordx4 v218, s[40:43], s29 offen lds
    s_add_u32 m0, s26, 146432
    s_nop 0
    buffer_load_dwordx4 v219, s[40:43], s29 offen lds
    s_add_u32 m0, s26, 147456
    s_nop 0
    buffer_load_dwordx4 v220, s[40:43], s29 offen lds
    s_branch L_p2j7
    s_nop 0
L_p2y7:
    s_add_u32 m0, s26, 143360
    s_nop 0
    buffer_load_dwordx4 v221, s[40:43], s29 offen lds
    s_add_u32 m0, s26, 144384
    s_nop 0
    buffer_load_dwordx4 v222, s[40:43], s29 offen lds
    s_add_u32 m0, s26, 145408
    s_nop 0
    buffer_load_dwordx4 v223, s[40:43], s29 offen lds
    s_add_u32 m0, s26, 146432
    s_nop 0
    buffer_load_dwordx4 v224, s[40:43], s29 offen lds
    s_add_u32 m0, s26, 147456
    s_nop 0
    buffer_load_dwordx4 v225, s[40:43], s29 offen lds
L_p2j7:
    v_mfma_f32_16x16x32_bf16 v[96:99], v[44:47], a[40:43], v[96:99]
    ds_read_b64_tr_b16 v[24:25], v21 offset:0
    ds_read_b64_tr_b16 v[26:27], v21 offset:2560
    v_mfma_f32_16x16x32_bf16 v[100:103], v[48:51], a[40:43], v[100:103]
    ds_read_b64_tr_b16 v[28:29], v21 offset:32
    ds_read_b64_tr_b16 v[30:31], v21 offset:2592
    v_mfma_f32_16x16x32_bf16 v[104:107], v[52:55], a[40:43], v[104:107]
    ds_read_b64_tr_b16 v[32:33], v21 offset:64
    ds_read_b64_tr_b16 v[34:35], v21 offset:2624
    v_mfma_f32_16x16x32_bf16 v[108:111], v[56:59], a[40:43], v[108:111]
    ds_read_b64_tr_b16 v[36:37], v21 offset:96
    ds_read_b64_tr_b16 v[38:39], v21 offset:2656
    v_mfma_f32_16x16x32_bf16 v[112:115], v[60:63], a[40:43], v[112:115]
    ds_read_b64_tr_b16 v[40:41], v21 offset:128
    ds_read_b64_tr_b16 v[42:43], v21 offset:2688
    s_waitcnt lgkmcnt(10)
    s_waitcnt vmcnt(29)
    v_mfma_f32_16x16x32_bf16 v[96:99], v[64:67], a[44:47], v[96:99]
    ds_read_b64_tr_b16 v[44:45], v21 offset:5120
    ds_read_b64_tr_b16 v[46:47], v21 offset:7680
    v_mfma_f32_16x16x32_bf16 v[100:103], v[68:71], a[44:47], v[100:103]
    ds_read_b64_tr_b16 v[48:49], v21 offset:5152
    ds_read_b64_tr_b16 v[50:51], v21 offset:7712
    v_mfma_f32_16x16x32_bf16 v[104:107], v[72:75], a[44:47], v[104:107]
    ds_read_b64_tr_b16 v[52:53], v21 offset:5184
    ds_read_b64_tr_b16 v[54:55], v21 offset:7744
    v_mfma_f32_16x16x32_bf16 v[108:111], v[76:79], a[44:47], v[108:111]
    ds_read_b64_tr_b16 v[56:57], v21 offset:5216
    ds_read_b64_tr_b16 v[58:59], v21 offset:7776
    v_mfma_f32_16x16x32_bf16 v[112:115], v[80:83], a[44:47], v[112:115]
    ds_read_b64_tr_b16 v[60:61], v21 offset:5248
    ds_read_b64_tr_b16 v[62:63], v21 offset:7808
    s_waitcnt lgkmcnt(10)
    s_cmp_lg_u32 s27, 0
    s_cbranch_scc1 L_pra_w
    s_mov_b32 s29, 0x20000
    s_nop 1
L_pra:
    buffer_load_dword v23, off, s[16:19], s30 offset:128 sc1
    s_waitcnt vmcnt(0)
    v_readfirstlane_b32 s28, v23
    s_nop 0
    s_cmp_ge_u32 s28, 8
    s_cbranch_scc1 L_pra_done
    s_sleep 4
    s_sub_u32 s29, s29, 1
    s_cmp_lg_u32 s29, 0
    s_cbranch_scc1 L_pra
    s_nop 0
L_pra_done:
L_pra_w:
    s_barrier
    s_add_u32 s28, s22, 0x40000
    buffer_load_dwordx4 a[80:83], v4, s[12:15], s28 offen
    s_add_u32 s28, s28, 1024
    buffer_load_dwordx4 a[84:87], v4, s[12:15], s28 offen
    s_add_u32 s28, s28, 1024
    buffer_load_dwordx4 a[88:91], v4, s[12:15], s28 offen
    s_add_u32 s28, s28, 1024
    buffer_load_dwordx4 a[92:95], v4, s[12:15], s28 offen
    s_add_u32 s28, s28, 1024
    buffer_load_dwordx4 a[96:99], v4, s[12:15], s28 offen
    s_add_u32 s28, s28, 1024
    buffer_load_dwordx4 a[100:103], v4, s[12:15], s28 offen
    s_add_u32 s28, s28, 1024
    buffer_load_dwordx4 a[104:107], v4, s[12:15], s28 offen
    s_add_u32 s28, s28, 1024
    buffer_load_dwordx4 a[108:111], v4, s[12:15], s28 offen
    s_add_u32 s28, s28, 1024
    buffer_load_dwordx4 a[112:115], v4, s[12:15], s28 offen
    s_add_u32 s28, s28, 1024
    buffer_load_dwordx4 a[116:119], v4, s[12:15], s28 offen
    s_add_u32 s28, s28, 1024
    buffer_load_dwordx4 a[120:123], v4, s[12:15], s28 offen
    s_add_u32 s28, s28, 1024
    buffer_load_dwordx4 a[124:127], v4, s[12:15], s28 offen
    s_add_u32 s28, s28, 1024
    buffer_load_dwordx4 a[128:131], v4, s[12:15], s28 offen
    s_add_u32 s28, s28, 1024
    buffer_load_dwordx4 a[132:135], v4, s[12:15], s28 offen
    s_add_u32 s28, s28, 1024
    buffer_load_dwordx4 a[136:139], v4, s[12:15], s28 offen
    s_add_u32 s28, s28, 1024
    buffer_load_dwordx4 a[140:143], v4, s[12:15], s28 offen
    s_add_u32 s28, s28, 1024
    buffer_load_dwordx4 a[144:147], v4, s[12:15], s28 offen
    s_add_u32 s28, s28, 1024
    buffer_load_dwordx4 a[148:151], v4, s[12:15], s28 offen
    s_add_u32 s28, s28, 1024
    buffer_load_dwordx4 a[152:155], v4, s[12:15], s28 offen
    s_add_u32 s28, s28, 1024
    buffer_load_dwordx4 a[156:159], v4, s[12:15], s28 offen
    s_add_u32 s28, s28, 1024
    s_waitcnt vmcnt(48)
    v_mfma_f32_16x16x32_bf16 v[96:99], v[24:27], a[48:51], v[96:99]
    ds_read_b64_tr_b16 v[64:65], v21 offset:10240
    ds_read_b64_tr_b16 v[66:67], v21 offset:12800
    v_mfma_f32_16x16x32_bf16 v[100:103], v[28:31], a[48:51], v[100:103]
    ds_read_b64_tr_b16 v[68:69], v21 offset:10272
    ds_read_b64_tr_b16 v[70:71], v21 offset:12832
    v_mfma_f32_16x16x32_bf16 v[104:107], v[32:35], a[48:51], v[104:107]
    ds_read_b64_tr_b16 v[72:73], v21 offset:10304
    ds_read_b64_tr_b16 v[74:75], v21 offset:12864
    v_mfma_f32_16x16x32_bf16 v[108:111], v[36:39], a[48:51], v[108:111]
    ds_read_b64_tr_b16 v[76:77], v21 offset:10336
    ds_read_b64_tr_b16 v[78:79], v21 offset:12896
    v_mfma_f32_16x16x32_bf16 v[112:115], v[40:43], a[48:51], v[112:115]
    ds_read_b64_tr_b16 v[80:81], v21 offset:10368
    ds_read_b64_tr_b16 v[82:83], v21 offset:12928
    s_waitcnt lgkmcnt(10)
    s_waitcnt vmcnt(47)
    v_mfma_f32_16x16x32_bf16 v[96:99], v[44:47], a[52:55], v[96:99]
    ds_read_b64_tr_b16 v[24:25], v21 offset:15360
    ds_read_b64_tr_b16 v[26:27], v21 offset:17920
    v_mfma_f32_16x16x32_bf16 v[100:103], v[48:51], a[52:55], v[100:103]
    ds_read_b64_tr_b16 v[28:29], v21 offset:15392
    ds_read_b64_tr_b16 v[30:31], v21 offset:17952
    v_mfma_f32_16x16x32_bf16 v[104:107], v[52:55], a[52:55], v[104:107]
    ds_read_b64_tr_b16 v[32:33], v21 offset:15424
    ds_read_b64_tr_b16 v[34:35], v21 offset:17984
    v_mfma_f32_16x16x32_bf16 v[108:111], v[56:59], a[52:55], v[108:111]
    ds_read_b64_tr_b16 v[36:37], v21 offset:15456
    ds_read_b64_tr_b16 v[38:39], v21 offset:18016
    v_mfma_f32_16x16x32_bf16 v[112:115], v[60:63], a[52:55], v[112:115]
    ds_read_b64_tr_b16 v[40:41], v21 offset:15488
    ds_read_b64_tr_b16 v[42:43], v21 offset:18048
    s_waitcnt lgkmcnt(10)
    s_waitcnt vmcnt(46)
    s_waitcnt vmcnt(35)
    s_barrier
    s_add_u32 s28, s27, 12
    s_mul_i32 s29, s28, 13
    s_lshr_b32 s29, s29, 6
    s_mul_i32 s36, s29, 5
    s_sub_u32 s28, s28, s36
    s_mul_i32 s29, s29, 160
    s_cmp_ge_u32 s28, 3
    s_cselect_b32 s36, 80, 0
    s_cselect_b32 s38, 3, 0
    s_add_u32 s29, s29, s36
    s_sub_u32 s36, s28, s38
    s_mul_i32 s36, s36, 8
    s_add_u32 s29, s29, s36
    s_mul_i32 s29, s29, 1280
    s_add_u32 s29, s29, s23
    s_cmp_eq_u32 s28, 2
    s_cbranch_scc1 L_p2y8
    s_add_u32 m0, s26, 0
    s_nop 0
    buffer_load_dwordx4 v216, s[40:43], s29 offen lds
    s_add_u32 m0, s26, 1024
    s_nop 0
    buffer_load_dwordx4 v217, s[40:43], s29 offen lds
    s_add_u32 m0, s26, 2048
    s_nop 0
    buffer_load_dwordx4 v218, s[40:43], s29 offen lds
    s_add_u32 m0, s26, 3072
    s_nop 0
    buffer_load_dwordx4 v219, s[40:43], s29 offen lds
    s_add_u32 m0, s26, 4096
    s_nop 0
    buffer_load_dwordx4 v220, s[40:43], s29 offen lds
    s_branch L_p2j8
    s_nop 0
L_p2y8:
    s_add_u32 m0, s26, 0
    s_nop 0
    buffer_load_dwordx4 v221, s[40:43], s29 offen lds
    s_add_u32 m0, s26, 1024
    s_nop 0
    buffer_load_dwordx4 v222, s[40:43], s29 offen lds
    s_add_u32 m0, s26, 2048
    s_nop 0
    buffer_load_dwordx4 v223, s[40:43], s29 offen lds
    s_add_u32 m0, s26, 3072
    s_nop 0
    buffer_load_dwordx4 v224, s[40:43], s29 offen lds
    s_add_u32 m0, s26, 4096
    s_nop 0
    buffer_load_dwordx4 v225, s[40:43], s29 offen lds
L_p2j8:
    v_mfma_f32_16x16x32_bf16 v[96:99], v[64:67], a[56:59], v[96:99]
    ds_read_b64_tr_b16 v[44:45], v21 offset:20480
    ds_read_b64_tr_b16 v[46:47], v21 offset:23040
    v_mfma_f32_16x16x32_bf16 v[100:103], v[68:71], a[56:59], v[100:103]
    ds_read_b64_tr_b16 v[48:49], v21 offset:20512
    ds_read_b64_tr_b16 v[50:51], v21 offset:23072
    v_mfma_f32_16x16x32_bf16 v[104:107], v[72:75], a[56:59], v[104:107]
    ds_read_b64_tr_b16 v[52:53], v21 offset:20544
    ds_read_b64_tr_b16 v[54:55], v21 offset:23104
    v_mfma_f32_16x16x32_bf16 v[108:111], v[76:79], a[56:59], v[108:111]
    ds_read_b64_tr_b16 v[56:57], v21 offset:20576
    ds_read_b64_tr_b16 v[58:59], v21 offset:23136
    v_mfma_f32_16x16x32_bf16 v[112:115], v[80:83], a[56:59], v[112:115]
    ds_read_b64_tr_b16 v[60:61], v21 offset:20608
    ds_read_b64_tr_b16 v[62:63], v21 offset:23168
    s_waitcnt lgkmcnt(10)
    v_mfma_f32_16x16x32_bf16 v[96:99], v[24:27], a[60:63], v[96:99]
    ds_read_b64_tr_b16 v[64:65], v21 offset:25600
    ds_read_b64_tr_b16 v[66:67], v21 offset:28160
    v_mfma_f32_16x16x32_bf16 v[100:103], v[28:31], a[60:63], v[100:103]
    ds_read_b64_tr_b16 v[68:69], v21 offset:25632
    ds_read_b64_tr_b16 v[70:71], v21 offset:28192
    v_mfma_f32_16x16x32_bf16 v[104:107], v[32:35], a[60:63], v[104:107]
    ds_read_b64_tr_b16 v[72:73], v21 offset:25664
    ds_read_b64_tr_b16 v[74:75], v21 offset:28224
    v_mfma_f32_16x16x32_bf16 v[108:111], v[36:39], a[60:63], v[108:111]
    ds_read_b64_tr_b16 v[76:77], v21 offset:25696
    ds_read_b64_tr_b16 v[78:79], v21 offset:28256
    v_mfma_f32_16x16x32_bf16 v[112:115], v[40:43], a[60:63], v[112:115]
    ds_read_b64_tr_b16 v[80:81], v21 offset:25728
    ds_read_b64_tr_b16 v[82:83], v21 offset:28288
    s_waitcnt lgkmcnt(10)
    v_mfma_f32_16x16x32_bf16 v[96:99], v[44:47], a[64:67], v[96:99]
    ds_read_b64_tr_b16 v[24:25], v21 offset:30720
    ds_read_b64_tr_b16 v[26:27], v21 offset:33280
    v_mfma_f32_16x16x32_bf16 v[100:103], v[48:51], a[64:67], v[100:103]
    ds_read_b64_tr_b16 v[28:29], v21 offset:30752
    ds_read_b64_tr_b16 v[30:31], v21 offset:33312
    v_mfma_f32_16x16x32_bf16 v[104:107], v[52:55], a[64:67], v[104:107]
    ds_read_b64_tr_b16 v[32:33], v21 offset:30784
    ds_read_b64_tr_b16 v[34:35], v21 offset:33344
    v_mfma_f32_16x16x32_bf16 v[108:111], v[56:59], a[64:67], v[108:111]
    ds_read_b64_tr_b16 v[36:37], v21 offset:30816
    ds_read_b64_tr_b16 v[38:39], v21 offset:33376
    v_mfma_f32_16x16x32_bf16 v[112:115], v[60:63], a[64:67], v[112:115]
    ds_read_b64_tr_b16 v[40:41], v21 offset:30848
    ds_read_b64_tr_b16 v[42:43], v21 offset:33408
    s_waitcnt lgkmcnt(10)
    v_mfma_f32_16x16x32_bf16 v[96:99], v[64:67], a[68:71], v[96:99]
    ds_read_b64_tr_b16 v[44:45], v21 offset:35840
    ds_read_b64_tr_b16 v[46:47], v21 offset:38400
    v_mfma_f32_16x16x32_bf16 v[100:103], v[68:71], a[68:71], v[100:103]
    ds_read_b64_tr_b16 v[48:49], v21 offset:35872
    ds_read_b64_tr_b16 v[50:51], v21 offset:38432
    v_mfma_f32_16x16x32_bf16 v[104:107], v[72:75], a[68:71], v[104:107]
    ds_read_b64_tr_b16 v[52:53], v21 offset:35904
    ds_read_b64_tr_b16 v[54:55], v21 offset:38464
    v_mfma_f32_16x16x32_bf16 v[108:111], v[76:79], a[68:71], v[108:111]
    ds_read_b64_tr_b16 v[56:57], v21 offset:35936
    ds_read_b64_tr_b16 v[58:59], v21 offset:38496
    v_mfma_f32_16x16x32_bf16 v[112:115], v[80:83], a[68:71], v[112:115]
    ds_read_b64_tr_b16 v[60:61], v21 offset:35968
    ds_read_b64_tr_b16 v[62:63], v21 offset:38528
    s_waitcnt lgkmcnt(10)
    s_waitcnt vmcnt(35)
    s_barrier
    s_add_u32 s28, s27, 16
    s_mul_i32 s29, s28, 13
    s_lshr_b32 s29, s29, 6
    s_mul_i32 s36, s29, 5
    s_sub_u32 s28, s28, s36
    s_mul_i32 s29, s29, 160
    s_cmp_ge_u32 s28, 3
    s_cselect_b32 s36, 80, 0
    s_cselect_b32 s38, 3, 0
    s_add_u32 s29, s29, s36
    s_sub_u32 s36, s28, s38
    s_mul_i32 s36, s36, 8
    s_add_u32 s29, s29, s36
    s_mul_i32 s29, s29, 1280
    s_add_u32 s29, s29, s23
    s_cmp_eq_u32 s28, 2
    s_cbranch_scc1 L_p2y9
    s_add_u32 m0, s26, 20480
    s_nop 0
    buffer_load_dwordx4 v216, s[40:43], s29 offen lds
    s_add_u32 m0, s26, 21504
    s_nop 0
    buffer_load_dwordx4 v217, s[40:43], s29 offen lds
    s_add_u32 m0, s26, 22528
    s_nop 0
    buffer_load_dwordx4 v218, s[40:43], s29 offen lds
    s_add_u32 m0, s26, 23552
    s_nop 0
    buffer_load_dwordx4 v219, s[40:43], s29 offen lds
    s_add_u32 m0, s26, 24576
    s_nop 0
    buffer_load_dwordx4 v220, s[40:43], s29 offen lds
    s_branch L_p2j9
    s_nop 0
L_p2y9:
    s_add_u32 m0, s26, 20480
    s_nop 0
    buffer_load_dwordx4 v221, s[40:43], s29 offen lds
    s_add_u32 m0, s26, 21504
    s_nop 0
    buffer_load_dwordx4 v222, s[40:43], s29 offen lds
    s_add_u32 m0, s26, 22528
    s_nop 0
    buffer_load_dwordx4 v223, s[40:43], s29 offen lds
    s_add_u32 m0, s26, 23552
    s_nop 0
    buffer_load_dwordx4 v224, s[40:43], s29 offen lds
    s_add_u32 m0, s26, 24576
    s_nop 0
    buffer_load_dwordx4 v225, s[40:43], s29 offen lds
L_p2j9:
    v_mfma_f32_16x16x32_bf16 v[96:99], v[24:27], a[72:75], v[96:99]
    ds_read_b64_tr_b16 v[64:65], v21 offset:40960
    ds_read_b64_tr_b16 v[66:67], v21 offset:43520
    v_mfma_f32_16x16x32_bf16 v[100:103], v[28:31], a[72:75], v[100:103]
    ds_read_b64_tr_b16 v[68:69], v21 offset:40992
    ds_read_b64_tr_b16 v[70:71], v21 offset:43552
    v_mfma_f32_16x16x32_bf16 v[104:107], v[32:35], a[72:75], v[104:107]
    ds_read_b64_tr_b16 v[72:73], v21 offset:41024
    ds_read_b64_tr_b16 v[74:75], v21 offset:43584
    v_mfma_f32_16x16x32_bf16 v[108:111], v[36:39], a[72:75], v[108:111]
    ds_read_b64_tr_b16 v[76:77], v21 offset:41056
    ds_read_b64_tr_b16 v[78:79], v21 offset:43616
    v_mfma_f32_16x16x32_bf16 v[112:115], v[40:43], a[72:75], v[112:115]
    ds_read_b64_tr_b16 v[80:81], v21 offset:41088
    ds_read_b64_tr_b16 v[82:83], v21 offset:43648
    s_waitcnt lgkmcnt(10)
    v_mfma_f32_16x16x32_bf16 v[96:99], v[44:47], a[76:79], v[96:99]
    ds_read_b64_tr_b16 v[24:25], v21 offset:46080
    ds_read_b64_tr_b16 v[26:27], v21 offset:48640
    v_mfma_f32_16x16x32_bf16 v[100:103], v[48:51], a[76:79], v[100:103]
    ds_read_b64_tr_b16 v[28:29], v21 offset:46112
    ds_read_b64_tr_b16 v[30:31], v21 offset:48672
    v_mfma_f32_16x16x32_bf16 v[104:107], v[52:55], a[76:79], v[104:107]
    ds_read_b64_tr_b16 v[32:33], v21 offset:46144
    ds_read_b64_tr_b16 v[34:35], v21 offset:48704
    v_mfma_f32_16x16x32_bf16 v[108:111], v[56:59], a[76:79], v[108:111]
    ds_read_b64_tr_b16 v[36:37], v21 offset:46176
    ds_read_b64_tr_b16 v[38:39], v21 offset:48736
    v_mfma_f32_16x16x32_bf16 v[112:115], v[60:63], a[76:79], v[112:115]
    ds_read_b64_tr_b16 v[40:41], v21 offset:46208
    ds_read_b64_tr_b16 v[42:43], v21 offset:48768
    s_waitcnt lgkmcnt(10)
    s_waitcnt vmcnt(29)
    v_mfma_f32_16x16x32_bf16 v[116:119], v[64:67], a[80:83], 0
    ds_read_b64_tr_b16 v[44:45], v21 offset:51200
    ds_read_b64_tr_b16 v[46:47], v21 offset:53760
    v_mfma_f32_16x16x32_bf16 v[120:123], v[68:71], a[80:83], 0
    ds_read_b64_tr_b16 v[48:49], v21 offset:51232
    ds_read_b64_tr_b16 v[50:51], v21 offset:53792
    v_mfma_f32_16x16x32_bf16 v[124:127], v[72:75], a[80:83], 0
    ds_read_b64_tr_b16 v[52:53], v21 offset:51264
    ds_read_b64_tr_b16 v[54:55], v21 offset:53824
    v_mfma_f32_16x16x32_bf16 v[128:131], v[76:79], a[80:83], 0
    ds_read_b64_tr_b16 v[56:57], v21 offset:51296
    ds_read_b64_tr_b16 v[58:59], v21 offset:53856
    v_mfma_f32_16x16x32_bf16 v[132:135], v[80:83], a[80:83], 0
    ds_read_b64_tr_b16 v[60:61], v21 offset:51328
    ds_read_b64_tr_b16 v[62:63], v21 offset:53888
    s_waitcnt lgkmcnt(10)
    s_waitcnt vmcnt(28)
    v_mfma_f32_16x16x32_bf16 v[116:119], v[24:27], a[84:87], v[116:119]
    ds_read_b64_tr_b16 v[64:65], v21 offset:56320
    ds_read_b64_tr_b16 v[66:67], v21 offset:58880
    v_mfma_f32_16x16x32_bf16 v[120:123], v[28:31], a[84:87], v[120:123]
    ds_read_b64_tr_b16 v[68:69], v21 offset:56352
    ds_read_b64_tr_b16 v[70:71], v21 offset:58912
    v_mfma_f32_16x16x32_bf16 v[124:127], v[32:35], a[84:87], v[124:127]
    ds_read_b64_tr_b16 v[72:73], v21 offset:56384
    ds_read_b64_tr_b16 v[74:75], v21 offset:58944
    v_mfma_f32_16x16x32_bf16 v[128:131], v[36:39], a[84:87], v[128:131]
    ds_read_b64_tr_b16 v[76:77], v21 offset:56416
    ds_read_b64_tr_b16 v[78:79], v21 offset:58976
    v_mfma_f32_16x16x32_bf16 v[132:135], v[40:43], a[84:87], v[132:135]
    ds_read_b64_tr_b16 v[80:81], v21 offset:56448
    ds_read_b64_tr_b16 v[82:83], v21 offset:59008
    s_waitcnt lgkmcnt(10)
    s_waitcnt vmcnt(27)
    s_barrier
    v_mfma_f32_16x16x32_bf16 v[116:119], v[44:47], a[88:91], v[116:119]
    ds_read_b64_tr_b16 v[24:25], v22 offset:0
    ds_read_b64_tr_b16 v[26:27], v22 offset:2560
    v_mfma_f32_16x16x32_bf16 v[120:123], v[48:51], a[88:91], v[120:123]
    ds_read_b64_tr_b16 v[28:29], v22 offset:32
    ds_read_b64_tr_b16 v[30:31], v22 offset:2592
    v_mfma_f32_16x16x32_bf16 v[124:127], v[52:55], a[88:91], v[124:127]
    ds_read_b64_tr_b16 v[32:33], v22 offset:64
    ds_read_b64_tr_b16 v[34:35], v22 offset:2624
    v_mfma_f32_16x16x32_bf16 v[128:131], v[56:59], a[88:91], v[128:131]
    ds_read_b64_tr_b16 v[36:37], v22 offset:96
    ds_read_b64_tr_b16 v[38:39], v22 offset:2656
    v_mfma_f32_16x16x32_bf16 v[132:135], v[60:63], a[88:91], v[132:135]
    ds_read_b64_tr_b16 v[40:41], v22 offset:128
    ds_read_b64_tr_b16 v[42:43], v22 offset:2688
    s_waitcnt lgkmcnt(10)
    s_waitcnt vmcnt(26)
    v_mfma_f32_16x16x32_bf16 v[116:119], v[64:67], a[92:95], v[116:119]
    ds_read_b64_tr_b16 v[44:45], v22 offset:5120
    ds_read_b64_tr_b16 v[46:47], v22 offset:7680
    v_mfma_f32_16x16x32_bf16 v[120:123], v[68:71], a[92:95], v[120:123]
    ds_read_b64_tr_b16 v[48:49], v22 offset:5152
    ds_read_b64_tr_b16 v[50:51], v22 offset:7712
    v_mfma_f32_16x16x32_bf16 v[124:127], v[72:75], a[92:95], v[124:127]
    ds_read_b64_tr_b16 v[52:53], v22 offset:5184
    ds_read_b64_tr_b16 v[54:55], v22 offset:7744
    v_mfma_f32_16x16x32_bf16 v[128:131], v[76:79], a[92:95], v[128:131]
    ds_read_b64_tr_b16 v[56:57], v22 offset:5216
    ds_read_b64_tr_b16 v[58:59], v22 offset:7776
    v_mfma_f32_16x16x32_bf16 v[132:135], v[80:83], a[92:95], v[132:135]
    ds_read_b64_tr_b16 v[60:61], v22 offset:5248
    ds_read_b64_tr_b16 v[62:63], v22 offset:7808
    s_waitcnt lgkmcnt(10)
    s_waitcnt vmcnt(25)
    v_mfma_f32_16x16x32_bf16 v[116:119], v[24:27], a[96:99], v[116:119]
    ds_read_b64_tr_b16 v[64:65], v22 offset:10240
    ds_read_b64_tr_b16 v[66:67], v22 offset:12800
    v_mfma_f32_16x16x32_bf16 v[120:123], v[28:31], a[96:99], v[120:123]
    ds_read_b64_tr_b16 v[68:69], v22 offset:10272
    ds_read_b64_tr_b16 v[70:71], v22 offset:12832
    v_mfma_f32_16x16x32_bf16 v[124:127], v[32:35], a[96:99], v[124:127]
    ds_read_b64_tr_b16 v[72:73], v22 offset:10304
    ds_read_b64_tr_b16 v[74:75], v22 offset:12864
    v_mfma_f32_16x16x32_bf16 v[128:131], v[36:39], a[96:99], v[128:131]
    ds_read_b64_tr_b16 v[76:77], v22 offset:10336
    ds_read_b64_tr_b16 v[78:79], v22 offset:12896
    v_mfma_f32_16x16x32_bf16 v[132:135], v[40:43], a[96:99], v[132:135]
    ds_read_b64_tr_b16 v[80:81], v22 offset:10368
    ds_read_b64_tr_b16 v[82:83], v22 offset:12928
    s_waitcnt lgkmcnt(10)
    s_waitcnt vmcnt(24)
    v_mfma_f32_16x16x32_bf16 v[116:119], v[44:47], a[100:103], v[116:119]
    ds_read_b64_tr_b16 v[24:25], v22 offset:15360
    ds_read_b64_tr_b16 v[26:27], v22 offset:17920
    v_mfma_f32_16x16x32_bf16 v[120:123], v[48:51], a[100:103], v[120:123]
    ds_read_b64_tr_b16 v[28:29], v22 offset:15392
    ds_read_b64_tr_b16 v[30:31], v22 offset:17952
    v_mfma_f32_16x16x32_bf16 v[124:127], v[52:55], a[100:103], v[124:127]
    ds_read_b64_tr_b16 v[32:33], v22 offset:15424
    ds_read_b64_tr_b16 v[34:35], v22 offset:17984
    v_mfma_f32_16x16x32_bf16 v[128:131], v[56:59], a[100:103], v[128:131]
    ds_read_b64_tr_b16 v[36:37], v22 offset:15456
    ds_read_b64_tr_b16 v[38:39], v22 offset:18016
    v_mfma_f32_16x16x32_bf16 v[132:135], v[60:63], a[100:103], v[132:135]
    ds_read_b64_tr_b16 v[40:41], v22 offset:15488
    ds_read_b64_tr_b16 v[42:43], v22 offset:18048
    s_waitcnt lgkmcnt(10)
    s_waitcnt vmcnt(23)
    s_barrier
    v_mfma_f32_16x16x32_bf16 v[116:119], v[64:67], a[104:107], v[116:119]
    ds_read_b64_tr_b16 v[44:45], v22 offset:20480
    ds_read_b64_tr_b16 v[46:47], v22 offset:23040
    v_mfma_f32_16x16x32_bf16 v[120:123], v[68:71], a[104:107], v[120:123]
    ds_read_b64_tr_b16 v[48:49], v22 offset:20512
    ds_read_b64_tr_b16 v[50:51], v22 offset:23072
    v_mfma_f32_16x16x32_bf16 v[124:127], v[72:75], a[104:107], v[124:127]
    ds_read_b64_tr_b16 v[52:53], v22 offset:20544
    ds_read_b64_tr_b16 v[54:55], v22 offset:23104
    v_mfma_f32_16x16x32_bf16 v[128:131], v[76:79], a[104:107], v[128:131]
    ds_read_b64_tr_b16 v[56:57], v22 offset:20576
    ds_read_b64_tr_b16 v[58:59], v22 offset:23136
    v_mfma_f32_16x16x32_bf16 v[132:135], v[80:83], a[104:107], v[132:135]
    ds_read_b64_tr_b16 v[60:61], v22 offset:20608
    ds_read_b64_tr_b16 v[62:63], v22 offset:23168
    s_waitcnt lgkmcnt(10)
    s_waitcnt vmcnt(22)
    v_mfma_f32_16x16x32_bf16 v[116:119], v[24:27], a[108:111], v[116:119]
    ds_read_b64_tr_b16 v[64:65], v22 offset:25600
    ds_read_b64_tr_b16 v[66:67], v22 offset:28160
    v_mfma_f32_16x16x32_bf16 v[120:123], v[28:31], a[108:111], v[120:123]
    ds_read_b64_tr_b16 v[68:69], v22 offset:25632
    ds_read_b64_tr_b16 v[70:71], v22 offset:28192
    v_mfma_f32_16x16x32_bf16 v[124:127], v[32:35], a[108:111], v[124:127]
    ds_read_b64_tr_b16 v[72:73], v22 offset:25664
    ds_read_b64_tr_b16 v[74:75], v22 offset:28224
    v_mfma_f32_16x16x32_bf16 v[128:131], v[36:39], a[108:111], v[128:131]
    ds_read_b64_tr_b16 v[76:77], v22 offset:25696
    ds_read_b64_tr_b16 v[78:79], v22 offset:28256
    v_mfma_f32_16x16x32_bf16 v[132:135], v[40:43], a[108:111], v[132:135]
    ds_read_b64_tr_b16 v[80:81], v22 offset:25728
    ds_read_b64_tr_b16 v[82:83], v22 offset:28288
    s_waitcnt lgkmcnt(10)
    s_waitcnt vmcnt(21)
    v_mfma_f32_16x16x32_bf16 v[116:119], v[44:47], a[112:115], v[116:119]
    ds_read_b64_tr_b16 v[24:25], v22 offset:30720
    ds_read_b64_tr_b16 v[26:27], v22 offset:33280
    v_mfma_f32_16x16x32_bf16 v[120:123], v[48:51], a[112:115], v[120:123]
    ds_read_b64_tr_b16 v[28:29], v22 offset:30752
    ds_read_b64_tr_b16 v[30:31], v22 offset:33312
    v_mfma_f32_16x16x32_bf16 v[124:127], v[52:55], a[112:115], v[124:127]
    ds_read_b64_tr_b16 v[32:33], v22 offset:30784
    ds_read_b64_tr_b16 v[34:35], v22 offset:33344
    v_mfma_f32_16x16x32_bf16 v[128:131], v[56:59], a[112:115], v[128:131]
    ds_read_b64_tr_b16 v[36:37], v22 offset:30816
    ds_read_b64_tr_b16 v[38:39], v22 offset:33376
    v_mfma_f32_16x16x32_bf16 v[132:135], v[60:63], a[112:115], v[132:135]
    ds_read_b64_tr_b16 v[40:41], v22 offset:30848
    ds_read_b64_tr_b16 v[42:43], v22 offset:33408
    s_waitcnt lgkmcnt(10)
    s_waitcnt vmcnt(20)
    v_mfma_f32_16x16x32_bf16 v[116:119], v[64:67], a[116:119], v[116:119]
    ds_read_b64_tr_b16 v[44:45], v22 offset:35840
    ds_read_b64_tr_b16 v[46:47], v22 offset:38400
    v_mfma_f32_16x16x32_bf16 v[120:123], v[68:71], a[116:119], v[120:123]
    ds_read_b64_tr_b16 v[48:49], v22 offset:35872
    ds_read_b64_tr_b16 v[50:51], v22 offset:38432
    v_mfma_f32_16x16x32_bf16 v[124:127], v[72:75], a[116:119], v[124:127]
    ds_read_b64_tr_b16 v[52:53], v22 offset:35904
    ds_read_b64_tr_b16 v[54:55], v22 offset:38464
    v_mfma_f32_16x16x32_bf16 v[128:131], v[76:79], a[116:119], v[128:131]
    ds_read_b64_tr_b16 v[56:57], v22 offset:35936
    ds_read_b64_tr_b16 v[58:59], v22 offset:38496
    v_mfma_f32_16x16x32_bf16 v[132:135], v[80:83], a[116:119], v[132:135]
    ds_read_b64_tr_b16 v[60:61], v22 offset:35968
    ds_read_b64_tr_b16 v[62:63], v22 offset:38528
    s_waitcnt lgkmcnt(10)
    s_waitcnt vmcnt(19)
    s_waitcnt vmcnt(5)
    s_barrier
    v_mfma_f32_16x16x32_bf16 v[116:119], v[24:27], a[120:123], v[116:119]
    ds_read_b64_tr_b16 v[64:65], v20 offset:0
    ds_read_b64_tr_b16 v[66:67], v20 offset:2560
    v_mfma_f32_16x16x32_bf16 v[120:123], v[28:31], a[120:123], v[120:123]
    ds_read_b64_tr_b16 v[68:69], v20 offset:32
    ds_read_b64_tr_b16 v[70:71], v20 offset:2592
    v_mfma_f32_16x16x32_bf16 v[124:127], v[32:35], a[120:123], v[124:127]
    ds_read_b64_tr_b16 v[72:73], v20 offset:64
    ds_read_b64_tr_b16 v[74:75], v20 offset:2624
    v_mfma_f32_16x16x32_bf16 v[128:131], v[36:39], a[120:123], v[128:131]
    ds_read_b64_tr_b16 v[76:77], v20 offset:96
    ds_read_b64_tr_b16 v[78:79], v20 offset:2656
    v_mfma_f32_16x16x32_bf16 v[132:135], v[40:43], a[120:123], v[132:135]
    ds_read_b64_tr_b16 v[80:81], v20 offset:128
    ds_read_b64_tr_b16 v[82:83], v20 offset:2688
    s_waitcnt lgkmcnt(10)
    v_mfma_f32_16x16x32_bf16 v[116:119], v[44:47], a[124:127], v[116:119]
    ds_read_b64_tr_b16 v[24:25], v20 offset:5120
    ds_read_b64_tr_b16 v[26:27], v20 offset:7680
    v_mfma_f32_16x16x32_bf16 v[120:123], v[48:51], a[124:127], v[120:123]
    ds_read_b64_tr_b16 v[28:29], v20 offset:5152
    ds_read_b64_tr_b16 v[30:31], v20 offset:7712
    v_mfma_f32_16x16x32_bf16 v[124:127], v[52:55], a[124:127], v[124:127]
    ds_read_b64_tr_b16 v[32:33], v20 offset:5184
    ds_read_b64_tr_b16 v[34:35], v20 offset:7744
    v_mfma_f32_16x16x32_bf16 v[128:131], v[56:59], a[124:127], v[128:131]
    ds_read_b64_tr_b16 v[36:37], v20 offset:5216
    ds_read_b64_tr_b16 v[38:39], v20 offset:7776
    v_mfma_f32_16x16x32_bf16 v[132:135], v[60:63], a[124:127], v[132:135]
    ds_read_b64_tr_b16 v[40:41], v20 offset:5248
    ds_read_b64_tr_b16 v[42:43], v20 offset:7808
    s_waitcnt lgkmcnt(10)
    v_mfma_f32_16x16x32_bf16 v[116:119], v[64:67], a[128:131], v[116:119]
    ds_read_b64_tr_b16 v[44:45], v20 offset:10240
    ds_read_b64_tr_b16 v[46:47], v20 offset:12800
    v_mfma_f32_16x16x32_bf16 v[120:123], v[68:71], a[128:131], v[120:123]
    ds_read_b64_tr_b16 v[48:49], v20 offset:10272
    ds_read_b64_tr_b16 v[50:51], v20 offset:12832
    v_mfma_f32_16x16x32_bf16 v[124:127], v[72:75], a[128:131], v[124:127]
    ds_read_b64_tr_b16 v[52:53], v20 offset:10304
    ds_read_b64_tr_b16 v[54:55], v20 offset:12864
    v_mfma_f32_16x16x32_bf16 v[128:131], v[76:79], a[128:131], v[128:131]
    ds_read_b64_tr_b16 v[56:57], v20 offset:10336
    ds_read_b64_tr_b16 v[58:59], v20 offset:12896
    v_mfma_f32_16x16x32_bf16 v[132:135], v[80:83], a[128:131], v[132:135]
    ds_read_b64_tr_b16 v[60:61], v20 offset:10368
    ds_read_b64_tr_b16 v[62:63], v20 offset:12928
    s_waitcnt lgkmcnt(10)
    v_mfma_f32_16x16x32_bf16 v[116:119], v[24:27], a[132:135], v[116:119]
    ds_read_b64_tr_b16 v[64:65], v20 offset:15360
    ds_read_b64_tr_b16 v[66:67], v20 offset:17920
    v_mfma_f32_16x16x32_bf16 v[120:123], v[28:31], a[132:135], v[120:123]
    ds_read_b64_tr_b16 v[68:69], v20 offset:15392
    ds_read_b64_tr_b16 v[70:71], v20 offset:17952
    v_mfma_f32_16x16x32_bf16 v[124:127], v[32:35], a[132:135], v[124:127]
    ds_read_b64_tr_b16 v[72:73], v20 offset:15424
    ds_read_b64_tr_b16 v[74:75], v20 offset:17984
    v_mfma_f32_16x16x32_bf16 v[128:131], v[36:39], a[132:135], v[128:131]
    ds_read_b64_tr_b16 v[76:77], v20 offset:15456
    ds_read_b64_tr_b16 v[78:79], v20 offset:18016
    v_mfma_f32_16x16x32_bf16 v[132:135], v[40:43], a[132:135], v[132:135]
    ds_read_b64_tr_b16 v[80:81], v20 offset:15488
    ds_read_b64_tr_b16 v[82:83], v20 offset:18048
    s_waitcnt lgkmcnt(10)
    s_waitcnt vmcnt(0)
    s_barrier
    v_mfma_f32_16x16x32_bf16 v[116:119], v[44:47], a[136:139], v[116:119]
    ds_read_b64_tr_b16 v[24:25], v20 offset:20480
    ds_read_b64_tr_b16 v[26:27], v20 offset:23040
    v_mfma_f32_16x16x32_bf16 v[120:123], v[48:51], a[136:139], v[120:123]
    ds_read_b64_tr_b16 v[28:29], v20 offset:20512
    ds_read_b64_tr_b16 v[30:31], v20 offset:23072
    v_mfma_f32_16x16x32_bf16 v[124:127], v[52:55], a[136:139], v[124:127]
    ds_read_b64_tr_b16 v[32:33], v20 offset:20544
    ds_read_b64_tr_b16 v[34:35], v20 offset:23104
    v_mfma_f32_16x16x32_bf16 v[128:131], v[56:59], a[136:139], v[128:131]
    ds_read_b64_tr_b16 v[36:37], v20 offset:20576
    ds_read_b64_tr_b16 v[38:39], v20 offset:23136
    v_mfma_f32_16x16x32_bf16 v[132:135], v[60:63], a[136:139], v[132:135]
    ds_read_b64_tr_b16 v[40:41], v20 offset:20608
    ds_read_b64_tr_b16 v[42:43], v20 offset:23168
    s_waitcnt lgkmcnt(10)
    v_mfma_f32_16x16x32_bf16 v[116:119], v[64:67], a[140:143], v[116:119]
    ds_read_b64_tr_b16 v[44:45], v20 offset:25600
    ds_read_b64_tr_b16 v[46:47], v20 offset:28160
    v_mfma_f32_16x16x32_bf16 v[120:123], v[68:71], a[140:143], v[120:123]
    ds_read_b64_tr_b16 v[48:49], v20 offset:25632
    ds_read_b64_tr_b16 v[50:51], v20 offset:28192
    v_mfma_f32_16x16x32_bf16 v[124:127], v[72:75], a[140:143], v[124:127]
    ds_read_b64_tr_b16 v[52:53], v20 offset:25664
    ds_read_b64_tr_b16 v[54:55], v20 offset:28224
    v_mfma_f32_16x16x32_bf16 v[128:131], v[76:79], a[140:143], v[128:131]
    ds_read_b64_tr_b16 v[56:57], v20 offset:25696
    ds_read_b64_tr_b16 v[58:59], v20 offset:28256
    v_mfma_f32_16x16x32_bf16 v[132:135], v[80:83], a[140:143], v[132:135]
    ds_read_b64_tr_b16 v[60:61], v20 offset:25728
    ds_read_b64_tr_b16 v[62:63], v20 offset:28288
    s_waitcnt lgkmcnt(10)
    v_mfma_f32_16x16x32_bf16 v[116:119], v[24:27], a[144:147], v[116:119]
    ds_read_b64_tr_b16 v[64:65], v20 offset:30720
    ds_read_b64_tr_b16 v[66:67], v20 offset:33280
    v_mfma_f32_16x16x32_bf16 v[120:123], v[28:31], a[144:147], v[120:123]
    ds_read_b64_tr_b16 v[68:69], v20 offset:30752
    ds_read_b64_tr_b16 v[70:71], v20 offset:33312
    v_mfma_f32_16x16x32_bf16 v[124:127], v[32:35], a[144:147], v[124:127]
    ds_read_b64_tr_b16 v[72:73], v20 offset:30784
    ds_read_b64_tr_b16 v[74:75], v20 offset:33344
    v_mfma_f32_16x16x32_bf16 v[128:131], v[36:39], a[144:147], v[128:131]
    ds_read_b64_tr_b16 v[76:77], v20 offset:30816
    ds_read_b64_tr_b16 v[78:79], v20 offset:33376
    v_mfma_f32_16x16x32_bf16 v[132:135], v[40:43], a[144:147], v[132:135]
    ds_read_b64_tr_b16 v[80:81], v20 offset:30848
    ds_read_b64_tr_b16 v[82:83], v20 offset:33408
    s_waitcnt lgkmcnt(10)
    v_mfma_f32_16x16x32_bf16 v[116:119], v[44:47], a[148:151], v[116:119]
    ds_read_b64_tr_b16 v[24:25], v20 offset:35840
    ds_read_b64_tr_b16 v[26:27], v20 offset:38400
    v_mfma_f32_16x16x32_bf16 v[120:123], v[48:51], a[148:151], v[120:123]
    ds_read_b64_tr_b16 v[28:29], v20 offset:35872
    ds_read_b64_tr_b16 v[30:31], v20 offset:38432
    v_mfma_f32_16x16x32_bf16 v[124:127], v[52:55], a[148:151], v[124:127]
    ds_read_b64_tr_b16 v[32:33], v20 offset:35904
    ds_read_b64_tr_b16 v[34:35], v20 offset:38464
    v_mfma_f32_16x16x32_bf16 v[128:131], v[56:59], a[148:151], v[128:131]
    ds_read_b64_tr_b16 v[36:37], v20 offset:35936
    ds_read_b64_tr_b16 v[38:39], v20 offset:38496
    v_mfma_f32_16x16x32_bf16 v[132:135], v[60:63], a[148:151], v[132:135]
    ds_read_b64_tr_b16 v[40:41], v20 offset:35968
    ds_read_b64_tr_b16 v[42:43], v20 offset:38528
    s_waitcnt lgkmcnt(10)
    v_mfma_f32_16x16x32_bf16 v[116:119], v[64:67], a[152:155], v[116:119]
    v_mfma_f32_16x16x32_bf16 v[120:123], v[68:71], a[152:155], v[120:123]
    v_mfma_f32_16x16x32_bf16 v[124:127], v[72:75], a[152:155], v[124:127]
    v_mfma_f32_16x16x32_bf16 v[128:131], v[76:79], a[152:155], v[128:131]
    v_mfma_f32_16x16x32_bf16 v[132:135], v[80:83], a[152:155], v[132:135]
    s_waitcnt lgkmcnt(0)
    v_mfma_f32_16x16x32_bf16 v[116:119], v[24:27], a[156:159], v[116:119]
    v_mfma_f32_16x16x32_bf16 v[120:123], v[28:31], a[156:159], v[120:123]
    v_mfma_f32_16x16x32_bf16 v[124:127], v[32:35], a[156:159], v[124:127]
    v_mfma_f32_16x16x32_bf16 v[128:131], v[36:39], a[156:159], v[128:131]
    v_mfma_f32_16x16x32_bf16 v[132:135], v[40:43], a[156:159], v[132:135]
    v_mul_u32_u24 v16, 1280, v16
    v_lshl_add_u32 v16, v2, 3, v16
    v_sub_f32 v19, 1.0, v18
    v_cvt_pk_bf16_f32 v19, v19, v19
    v_lshlrev_b32 v19, 16, v19
    v_cvt_pk_bf16_f32 v28, v116, v117
    v_cvt_pk_bf16_f32 v29, v118, v119
    v_lshlrev_b32 v116, 16, v28
    v_and_b32 v117, 0xffff0000, v28
    v_lshlrev_b32 v118, 16, v29
    v_and_b32 v119, 0xffff0000, v29
    v_mul_f32 v116, v116, v18
    v_mul_f32 v117, v117, v18
    v_mul_f32 v118, v118, v18
    v_mul_f32 v119, v119, v18
    v_cvt_pk_bf16_f32 v28, v116, v117
    v_cvt_pk_bf16_f32 v29, v118, v119
    v_lshlrev_b32 v116, 16, v28
    v_and_b32 v117, 0xffff0000, v28
    v_lshlrev_b32 v118, 16, v29
    v_and_b32 v119, 0xffff0000, v29
    v_cvt_pk_bf16_f32 v28, v96, v97
    v_cvt_pk_bf16_f32 v29, v98, v99
    v_lshlrev_b32 v96, 16, v28
    v_and_b32 v97, 0xffff0000, v28
    v_lshlrev_b32 v98, 16, v29
    v_and_b32 v99, 0xffff0000, v29
    v_mul_f32 v96, v96, v19
    v_mul_f32 v97, v97, v19
    v_mul_f32 v98, v98, v19
    v_mul_f32 v99, v99, v19
    v_cvt_pk_bf16_f32 v28, v96, v97
    v_cvt_pk_bf16_f32 v29, v98, v99
    v_lshlrev_b32 v96, 16, v28
    v_and_b32 v97, 0xffff0000, v28
    v_lshlrev_b32 v98, 16, v29
    v_and_b32 v99, 0xffff0000, v29
    v_add_f32 v116, v116, v96
    v_add_f32 v117, v117, v97
    v_add_f32 v118, v118, v98
    v_add_f32 v119, v119, v99
    v_cvt_pk_bf16_f32 v96, v116, v117
    v_cvt_pk_bf16_f32 v97, v118, v119
    buffer_store_dwordx2 v[96:97], v16, s[32:35], s23 offen offset:0
    v_cvt_pk_bf16_f32 v28, v120, v121
    v_cvt_pk_bf16_f32 v29, v122, v123
    v_lshlrev_b32 v120, 16, v28
    v_and_b32 v121, 0xffff0000, v28
    v_lshlrev_b32 v122, 16, v29
    v_and_b32 v123, 0xffff0000, v29
    v_mul_f32 v120, v120, v18
    v_mul_f32 v121, v121, v18
    v_mul_f32 v122, v122, v18
    v_mul_f32 v123, v123, v18
    v_cvt_pk_bf16_f32 v28, v120, v121
    v_cvt_pk_bf16_f32 v29, v122, v123
    v_lshlrev_b32 v120, 16, v28
    v_and_b32 v121, 0xffff0000, v28
    v_lshlrev_b32 v122, 16, v29
    v_and_b32 v123, 0xffff0000, v29
    v_cvt_pk_bf16_f32 v28, v100, v101
    v_cvt_pk_bf16_f32 v29, v102, v103
    v_lshlrev_b32 v100, 16, v28
    v_and_b32 v101, 0xffff0000, v28
    v_lshlrev_b32 v102, 16, v29
    v_and_b32 v103, 0xffff0000, v29
    v_mul_f32 v100, v100, v19
    v_mul_f32 v101, v101, v19
    v_mul_f32 v102, v102, v19
    v_mul_f32 v103, v103, v19
    v_cvt_pk_bf16_f32 v28, v100, v101
    v_cvt_pk_bf16_f32 v29, v102, v103
    v_lshlrev_b32 v100, 16, v28
    v_and_b32 v101, 0xffff0000, v28
    v_lshlrev_b32 v102, 16, v29
    v_and_b32 v103, 0xffff0000, v29
    v_add_f32 v120, v120, v100
    v_add_f32 v121, v121, v101
    v_add_f32 v122, v122, v102
    v_add_f32 v123, v123, v103
    v_cvt_pk_bf16_f32 v100, v120, v121
    v_cvt_pk_bf16_f32 v101, v122, v123
    buffer_store_dwordx2 v[100:101], v16, s[32:35], s23 offen offset:32
    v_cvt_pk_bf16_f32 v28, v124, v125
    v_cvt_pk_bf16_f32 v29, v126, v127
    v_lshlrev_b32 v124, 16, v28
    v_and_b32 v125, 0xffff0000, v28
    v_lshlrev_b32 v126, 16, v29
    v_and_b32 v127, 0xffff0000, v29
    v_mul_f32 v124, v124, v18
    v_mul_f32 v125, v125, v18
    v_mul_f32 v126, v126, v18
    v_mul_f32 v127, v127, v18
    v_cvt_pk_bf16_f32 v28, v124, v125
    v_cvt_pk_bf16_f32 v29, v126, v127
    v_lshlrev_b32 v124, 16, v28
    v_and_b32 v125, 0xffff0000, v28
    v_lshlrev_b32 v126, 16, v29
    v_and_b32 v127, 0xffff0000, v29
    v_cvt_pk_bf16_f32 v28, v104, v105
    v_cvt_pk_bf16_f32 v29, v106, v107
    v_lshlrev_b32 v104, 16, v28
    v_and_b32 v105, 0xffff0000, v28
    v_lshlrev_b32 v106, 16, v29
    v_and_b32 v107, 0xffff0000, v29
    v_mul_f32 v104, v104, v19
    v_mul_f32 v105, v105, v19
    v_mul_f32 v106, v106, v19
    v_mul_f32 v107, v107, v19
    v_cvt_pk_bf16_f32 v28, v104, v105
    v_cvt_pk_bf16_f32 v29, v106, v107
    v_lshlrev_b32 v104, 16, v28
    v_and_b32 v105, 0xffff0000, v28
    v_lshlrev_b32 v106, 16, v29
    v_and_b32 v107, 0xffff0000, v29
    v_add_f32 v124, v124, v104
    v_add_f32 v125, v125, v105
    v_add_f32 v126, v126, v106
    v_add_f32 v127, v127, v107
    v_cvt_pk_bf16_f32 v104, v124, v125
    v_cvt_pk_bf16_f32 v105, v126, v127
    buffer_store_dwordx2 v[104:105], v16, s[32:35], s23 offen offset:64
    v_cvt_pk_bf16_f32 v28, v128, v129
    v_cvt_pk_bf16_f32 v29, v130, v131
    v_lshlrev_b32 v128, 16, v28
    v_and_b32 v129, 0xffff0000, v28
    v_lshlrev_b32 v130, 16, v29
    v_and_b32 v131, 0xffff0000, v29
    v_mul_f32 v128, v128, v18
    v_mul_f32 v129, v129, v18
    v_mul_f32 v130, v130, v18
    v_mul_f32 v131, v131, v18
    v_cvt_pk_bf16_f32 v28, v128, v129
    v_cvt_pk_bf16_f32 v29, v130, v131
    v_lshlrev_b32 v128, 16, v28
    v_and_b32 v129, 0xffff0000, v28
    v_lshlrev_b32 v130, 16, v29
    v_and_b32 v131, 0xffff0000, v29
    v_cvt_pk_bf16_f32 v28, v108, v109
    v_cvt_pk_bf16_f32 v29, v110, v111
    v_lshlrev_b32 v108, 16, v28
    v_and_b32 v109, 0xffff0000, v28
    v_lshlrev_b32 v110, 16, v29
    v_and_b32 v111, 0xffff0000, v29
    v_mul_f32 v108, v108, v19
    v_mul_f32 v109, v109, v19
    v_mul_f32 v110, v110, v19
    v_mul_f32 v111, v111, v19
    v_cvt_pk_bf16_f32 v28, v108, v109
    v_cvt_pk_bf16_f32 v29, v110, v111
    v_lshlrev_b32 v108, 16, v28
    v_and_b32 v109, 0xffff0000, v28
    v_lshlrev_b32 v110, 16, v29
    v_and_b32 v111, 0xffff0000, v29
    v_add_f32 v128, v128, v108
    v_add_f32 v129, v129, v109
    v_add_f32 v130, v130, v110
    v_add_f32 v131, v131, v111
    v_cvt_pk_bf16_f32 v108, v128, v129
    v_cvt_pk_bf16_f32 v109, v130, v131
    buffer_store_dwordx2 v[108:109], v16, s[32:35], s23 offen offset:96
    v_cvt_pk_bf16_f32 v28, v132, v133
    v_cvt_pk_bf16_f32 v29, v134, v135
    v_lshlrev_b32 v132, 16, v28
    v_and_b32 v133, 0xffff0000, v28
    v_lshlrev_b32 v134, 16, v29
    v_and_b32 v135, 0xffff0000, v29
    v_mul_f32 v132, v132, v18
    v_mul_f32 v133, v133, v18
    v_mul_f32 v134, v134, v18
    v_mul_f32 v135, v135, v18
    v_cvt_pk_bf16_f32 v28, v132, v133
    v_cvt_pk_bf16_f32 v29, v134, v135
    v_lshlrev_b32 v132, 16, v28
    v_and_b32 v133, 0xffff0000, v28
    v_lshlrev_b32 v134, 16, v29
    v_and_b32 v135, 0xffff0000, v29
    v_cvt_pk_bf16_f32 v28, v112, v113
    v_cvt_pk_bf16_f32 v29, v114, v115
    v_lshlrev_b32 v112, 16, v28
    v_and_b32 v113, 0xffff0000, v28
    v_lshlrev_b32 v114, 16, v29
    v_and_b32 v115, 0xffff0000, v29
    v_mul_f32 v112, v112, v19
    v_mul_f32 v113, v113, v19
    v_mul_f32 v114, v114, v19
    v_mul_f32 v115, v115, v19
    v_cvt_pk_bf16_f32 v28, v112, v113
    v_cvt_pk_bf16_f32 v29, v114, v115
    v_lshlrev_b32 v112, 16, v28
    v_and_b32 v113, 0xffff0000, v28
    v_lshlrev_b32 v114, 16, v29
    v_and_b32 v115, 0xffff0000, v29
    v_add_f32 v132, v132, v112
    v_add_f32 v133, v133, v113
    v_add_f32 v134, v134, v114
    v_add_f32 v135, v135, v115
    v_cvt_pk_bf16_f32 v112, v132, v133
    v_cvt_pk_bf16_f32 v113, v134, v135
    buffer_store_dwordx2 v[112:113], v16, s[32:35], s23 offen offset:128
    s_nop 3
L_k1_end:
    s_endpgm
.section .rodata,"a"
.p2align 6
.amdhsa_kernel gated_mix__linear_kernel_hedgehog__sliding_local_dilated__prompt_kernel
  .amdhsa_next_free_vgpr 512
  .amdhsa_next_free_sgpr 102
  .amdhsa_accum_offset 256
  .amdhsa_group_segment_fixed_size 0
  .amdhsa_kernarg_size 88
  .amdhsa_user_sgpr_count 2
  .amdhsa_user_sgpr_kernarg_segment_ptr 1
  .amdhsa_system_sgpr_workgroup_id_x 1
.end_amdhsa_kernel
```
